```python
import torch

def _softmax(x, axis=-1):
    return torch.softmax(x, dim=axis)

def _gelu(x):
    return torch.nn.functional.gelu(x, approximate='tanh')

def _silu(x):
    return torch.nn.functional.silu(x)

def _sigmoid(x):
    return torch.sigmoid(x)

def _layernorm(x, axis=-1, eps=1e-05):
    m = x.mean(dim=axis, keepdim=True)
    v = x.var(dim=axis, keepdim=True, unbiased=False)
    return (x - m) / torch.sqrt(v + eps)

def _scatter_add(tgt, idx, src, axis=0):
    return tgt.clone().index_add_(axis, idx, src)

def _segment_sum(src, seg, n):
    out = torch.zeros((n,) + src.shape[1:], dtype=src.dtype)
    return out.index_add_(0, seg, src)

def _pad(x, pw):
    flat = tuple((v for pair in reversed(pw) for v in pair))
    return torch.nn.functional.pad(x, flat)
kernel_name = 'standalone__window_attn_twins__vision'

def setup_inputs():

    _w = lambda a: (lambda t: t.to(torch.bfloat16) if t.is_floating_point() else t)(torch.as_tensor(a))
    H = W = 384 // 8 * 8
    C = 96
    return {'x': _w((lambda *s: torch.randn(*s, dtype=torch.bfloat16) * 0.8)(1, H, W, C)), 'wq': _w((lambda *s: torch.randn(*s, dtype=torch.bfloat16) * 0.8)(C, C)), 'wkv': _w((lambda *s: torch.randn(*s, dtype=torch.bfloat16) * 0.8)(C, 2 * C)), 'wo': _w((lambda *s: torch.randn(*s, dtype=torch.bfloat16) * 0.05)(C, C))}

def reference(x, wq, wkv, wo):
    B, H, W, C = x.shape
    win = 8
    nh, nw = (H // win, W // win)
    xs = x.reshape(B, nh, win, nw, win, C).mean(axis=(2, 4)).reshape(B, nh * nw, C)
    q = x.reshape(B, H * W, C) @ wq
    kv = xs @ wkv
    k, v = (kv[..., :C].clone(), kv[..., C:].clone())
    scale = C ** (-0.5)
    p = _softmax(torch.einsum('bqc,bkc->bqk', q, k) * scale, axis=-1)
    o = torch.einsum('bqk,bkc->bqc', p, v) @ wo
    return o.reshape(B, H, W, C)
```

```asm
; @launch kernel=k_pool_kernel grid=(576,1,1) block=(256,1,1) lds=8192
; @launch kernel=k_proj_kernel grid=(144,1,1) block=(64,1,1) lds=0
; @launch kernel=k_attn_kernel grid=(256,1,1) block=(256,1,1) lds=94208
.amdgcn_target "amdgcn-amd-amdhsa--gfx950"
.text

.globl k_pool_kernel
.p2align 8
.type k_pool_kernel,@function
k_pool_kernel:

  s_cmp_ge_u32 s2, 576
  s_cbranch_scc1 Lpool_end
  s_load_dwordx2 s[4:5], s[0:1], 0
  s_load_dwordx2 s[8:9], s[0:1], 48
  v_lshrrev_b32 v1, 6, v0
  v_and_b32 v2, 63, v0
  s_nop 1
  v_readfirstlane_b32 s3, v1
  s_waitcnt lgkmcnt(0)
  s_mov_b32 s6, 28311552
  s_mov_b32 s7, 0x20000
  s_mov_b32 s10, 268435456
  s_mov_b32 s11, 0x20000
  s_lshl_b32 s12, s2, 2
  s_add_u32 s12, s12, s3
  s_mul_i32 s13, s12, 43691
  s_lshr_b32 s13, s13, 21
  s_mul_i32 s14, s13, 48
  s_sub_u32 s14, s12, s14
  s_mul_i32 s15, s13, 589824
  s_mul_i32 s16, s14, 1536
  s_add_u32 s15, s15, s16
  v_mul_u32_u24 v3, 43, v2
  v_lshrrev_b32 v3, 9, v3
  v_mul_u32_u24 v4, 12, v3
  v_sub_u32 v4, v2, v4
  v_mul_u32_u24 v5, 192, v3
  v_lshl_add_u32 v5, v4, 4, v5
  s_lshl_b32 s17, s3, 11
  v_cmp_gt_u32 vcc, 48, v2
  s_and_saveexec_b64 s[20:21], vcc
  s_cbranch_execz Lpool_end
  buffer_load_dwordx4 v[16:19], v5, s[4:7], s15 offen offset:0
  buffer_load_dwordx4 v[20:23], v5, s[4:7], s15 offen offset:768
  s_add_u32 s15, s15, 73728
  buffer_load_dwordx4 v[24:27], v5, s[4:7], s15 offen offset:0
  buffer_load_dwordx4 v[28:31], v5, s[4:7], s15 offen offset:768
  s_add_u32 s15, s15, 73728
  buffer_load_dwordx4 v[32:35], v5, s[4:7], s15 offen offset:0
  buffer_load_dwordx4 v[36:39], v5, s[4:7], s15 offen offset:768
  s_add_u32 s15, s15, 73728
  buffer_load_dwordx4 v[40:43], v5, s[4:7], s15 offen offset:0
  buffer_load_dwordx4 v[44:47], v5, s[4:7], s15 offen offset:768
  s_add_u32 s15, s15, 73728
  buffer_load_dwordx4 v[48:51], v5, s[4:7], s15 offen offset:0
  buffer_load_dwordx4 v[52:55], v5, s[4:7], s15 offen offset:768
  s_add_u32 s15, s15, 73728
  buffer_load_dwordx4 v[56:59], v5, s[4:7], s15 offen offset:0
  buffer_load_dwordx4 v[60:63], v5, s[4:7], s15 offen offset:768
  s_add_u32 s15, s15, 73728
  buffer_load_dwordx4 v[64:67], v5, s[4:7], s15 offen offset:0
  buffer_load_dwordx4 v[68:71], v5, s[4:7], s15 offen offset:768
  s_add_u32 s15, s15, 73728
  buffer_load_dwordx4 v[72:75], v5, s[4:7], s15 offen offset:0
  buffer_load_dwordx4 v[76:79], v5, s[4:7], s15 offen offset:768
  v_mov_b32 v8, 0
  v_mov_b32 v9, 0
  v_mov_b32 v10, 0
  v_mov_b32 v11, 0
  v_mov_b32 v12, 0
  v_mov_b32 v13, 0
  v_mov_b32 v14, 0
  v_mov_b32 v15, 0
  v_mov_b32 v6, 0xffff0000
  s_waitcnt vmcnt(15)
  v_lshlrev_b32 v7, 16, v16
  v_and_b32 v16, v6, v16
  v_add_f32 v8, v8, v7
  v_add_f32 v9, v9, v16
  v_lshlrev_b32 v7, 16, v17
  v_and_b32 v17, v6, v17
  v_add_f32 v10, v10, v7
  v_add_f32 v11, v11, v17
  v_lshlrev_b32 v7, 16, v18
  v_and_b32 v18, v6, v18
  v_add_f32 v12, v12, v7
  v_add_f32 v13, v13, v18
  v_lshlrev_b32 v7, 16, v19
  v_and_b32 v19, v6, v19
  v_add_f32 v14, v14, v7
  v_add_f32 v15, v15, v19
  s_waitcnt vmcnt(14)
  v_lshlrev_b32 v7, 16, v20
  v_and_b32 v20, v6, v20
  v_add_f32 v8, v8, v7
  v_add_f32 v9, v9, v20
  v_lshlrev_b32 v7, 16, v21
  v_and_b32 v21, v6, v21
  v_add_f32 v10, v10, v7
  v_add_f32 v11, v11, v21
  v_lshlrev_b32 v7, 16, v22
  v_and_b32 v22, v6, v22
  v_add_f32 v12, v12, v7
  v_add_f32 v13, v13, v22
  v_lshlrev_b32 v7, 16, v23
  v_and_b32 v23, v6, v23
  v_add_f32 v14, v14, v7
  v_add_f32 v15, v15, v23
  s_waitcnt vmcnt(13)
  v_lshlrev_b32 v7, 16, v24
  v_and_b32 v24, v6, v24
  v_add_f32 v8, v8, v7
  v_add_f32 v9, v9, v24
  v_lshlrev_b32 v7, 16, v25
  v_and_b32 v25, v6, v25
  v_add_f32 v10, v10, v7
  v_add_f32 v11, v11, v25
  v_lshlrev_b32 v7, 16, v26
  v_and_b32 v26, v6, v26
  v_add_f32 v12, v12, v7
  v_add_f32 v13, v13, v26
  v_lshlrev_b32 v7, 16, v27
  v_and_b32 v27, v6, v27
  v_add_f32 v14, v14, v7
  v_add_f32 v15, v15, v27
  s_waitcnt vmcnt(12)
  v_lshlrev_b32 v7, 16, v28
  v_and_b32 v28, v6, v28
  v_add_f32 v8, v8, v7
  v_add_f32 v9, v9, v28
  v_lshlrev_b32 v7, 16, v29
  v_and_b32 v29, v6, v29
  v_add_f32 v10, v10, v7
  v_add_f32 v11, v11, v29
  v_lshlrev_b32 v7, 16, v30
  v_and_b32 v30, v6, v30
  v_add_f32 v12, v12, v7
  v_add_f32 v13, v13, v30
  v_lshlrev_b32 v7, 16, v31
  v_and_b32 v31, v6, v31
  v_add_f32 v14, v14, v7
  v_add_f32 v15, v15, v31
  s_waitcnt vmcnt(11)
  v_lshlrev_b32 v7, 16, v32
  v_and_b32 v32, v6, v32
  v_add_f32 v8, v8, v7
  v_add_f32 v9, v9, v32
  v_lshlrev_b32 v7, 16, v33
  v_and_b32 v33, v6, v33
  v_add_f32 v10, v10, v7
  v_add_f32 v11, v11, v33
  v_lshlrev_b32 v7, 16, v34
  v_and_b32 v34, v6, v34
  v_add_f32 v12, v12, v7
  v_add_f32 v13, v13, v34
  v_lshlrev_b32 v7, 16, v35
  v_and_b32 v35, v6, v35
  v_add_f32 v14, v14, v7
  v_add_f32 v15, v15, v35
  s_waitcnt vmcnt(10)
  v_lshlrev_b32 v7, 16, v36
  v_and_b32 v36, v6, v36
  v_add_f32 v8, v8, v7
  v_add_f32 v9, v9, v36
  v_lshlrev_b32 v7, 16, v37
  v_and_b32 v37, v6, v37
  v_add_f32 v10, v10, v7
  v_add_f32 v11, v11, v37
  v_lshlrev_b32 v7, 16, v38
  v_and_b32 v38, v6, v38
  v_add_f32 v12, v12, v7
  v_add_f32 v13, v13, v38
  v_lshlrev_b32 v7, 16, v39
  v_and_b32 v39, v6, v39
  v_add_f32 v14, v14, v7
  v_add_f32 v15, v15, v39
  s_waitcnt vmcnt(9)
  v_lshlrev_b32 v7, 16, v40
  v_and_b32 v40, v6, v40
  v_add_f32 v8, v8, v7
  v_add_f32 v9, v9, v40
  v_lshlrev_b32 v7, 16, v41
  v_and_b32 v41, v6, v41
  v_add_f32 v10, v10, v7
  v_add_f32 v11, v11, v41
  v_lshlrev_b32 v7, 16, v42
  v_and_b32 v42, v6, v42
  v_add_f32 v12, v12, v7
  v_add_f32 v13, v13, v42
  v_lshlrev_b32 v7, 16, v43
  v_and_b32 v43, v6, v43
  v_add_f32 v14, v14, v7
  v_add_f32 v15, v15, v43
  s_waitcnt vmcnt(8)
  v_lshlrev_b32 v7, 16, v44
  v_and_b32 v44, v6, v44
  v_add_f32 v8, v8, v7
  v_add_f32 v9, v9, v44
  v_lshlrev_b32 v7, 16, v45
  v_and_b32 v45, v6, v45
  v_add_f32 v10, v10, v7
  v_add_f32 v11, v11, v45
  v_lshlrev_b32 v7, 16, v46
  v_and_b32 v46, v6, v46
  v_add_f32 v12, v12, v7
  v_add_f32 v13, v13, v46
  v_lshlrev_b32 v7, 16, v47
  v_and_b32 v47, v6, v47
  v_add_f32 v14, v14, v7
  v_add_f32 v15, v15, v47
  s_waitcnt vmcnt(7)
  v_lshlrev_b32 v7, 16, v48
  v_and_b32 v48, v6, v48
  v_add_f32 v8, v8, v7
  v_add_f32 v9, v9, v48
  v_lshlrev_b32 v7, 16, v49
  v_and_b32 v49, v6, v49
  v_add_f32 v10, v10, v7
  v_add_f32 v11, v11, v49
  v_lshlrev_b32 v7, 16, v50
  v_and_b32 v50, v6, v50
  v_add_f32 v12, v12, v7
  v_add_f32 v13, v13, v50
  v_lshlrev_b32 v7, 16, v51
  v_and_b32 v51, v6, v51
  v_add_f32 v14, v14, v7
  v_add_f32 v15, v15, v51
  s_waitcnt vmcnt(6)
  v_lshlrev_b32 v7, 16, v52
  v_and_b32 v52, v6, v52
  v_add_f32 v8, v8, v7
  v_add_f32 v9, v9, v52
  v_lshlrev_b32 v7, 16, v53
  v_and_b32 v53, v6, v53
  v_add_f32 v10, v10, v7
  v_add_f32 v11, v11, v53
  v_lshlrev_b32 v7, 16, v54
  v_and_b32 v54, v6, v54
  v_add_f32 v12, v12, v7
  v_add_f32 v13, v13, v54
  v_lshlrev_b32 v7, 16, v55
  v_and_b32 v55, v6, v55
  v_add_f32 v14, v14, v7
  v_add_f32 v15, v15, v55
  s_waitcnt vmcnt(5)
  v_lshlrev_b32 v7, 16, v56
  v_and_b32 v56, v6, v56
  v_add_f32 v8, v8, v7
  v_add_f32 v9, v9, v56
  v_lshlrev_b32 v7, 16, v57
  v_and_b32 v57, v6, v57
  v_add_f32 v10, v10, v7
  v_add_f32 v11, v11, v57
  v_lshlrev_b32 v7, 16, v58
  v_and_b32 v58, v6, v58
  v_add_f32 v12, v12, v7
  v_add_f32 v13, v13, v58
  v_lshlrev_b32 v7, 16, v59
  v_and_b32 v59, v6, v59
  v_add_f32 v14, v14, v7
  v_add_f32 v15, v15, v59
  s_waitcnt vmcnt(4)
  v_lshlrev_b32 v7, 16, v60
  v_and_b32 v60, v6, v60
  v_add_f32 v8, v8, v7
  v_add_f32 v9, v9, v60
  v_lshlrev_b32 v7, 16, v61
  v_and_b32 v61, v6, v61
  v_add_f32 v10, v10, v7
  v_add_f32 v11, v11, v61
  v_lshlrev_b32 v7, 16, v62
  v_and_b32 v62, v6, v62
  v_add_f32 v12, v12, v7
  v_add_f32 v13, v13, v62
  v_lshlrev_b32 v7, 16, v63
  v_and_b32 v63, v6, v63
  v_add_f32 v14, v14, v7
  v_add_f32 v15, v15, v63
  s_waitcnt vmcnt(3)
  v_lshlrev_b32 v7, 16, v64
  v_and_b32 v64, v6, v64
  v_add_f32 v8, v8, v7
  v_add_f32 v9, v9, v64
  v_lshlrev_b32 v7, 16, v65
  v_and_b32 v65, v6, v65
  v_add_f32 v10, v10, v7
  v_add_f32 v11, v11, v65
  v_lshlrev_b32 v7, 16, v66
  v_and_b32 v66, v6, v66
  v_add_f32 v12, v12, v7
  v_add_f32 v13, v13, v66
  v_lshlrev_b32 v7, 16, v67
  v_and_b32 v67, v6, v67
  v_add_f32 v14, v14, v7
  v_add_f32 v15, v15, v67
  s_waitcnt vmcnt(2)
  v_lshlrev_b32 v7, 16, v68
  v_and_b32 v68, v6, v68
  v_add_f32 v8, v8, v7
  v_add_f32 v9, v9, v68
  v_lshlrev_b32 v7, 16, v69
  v_and_b32 v69, v6, v69
  v_add_f32 v10, v10, v7
  v_add_f32 v11, v11, v69
  v_lshlrev_b32 v7, 16, v70
  v_and_b32 v70, v6, v70
  v_add_f32 v12, v12, v7
  v_add_f32 v13, v13, v70
  v_lshlrev_b32 v7, 16, v71
  v_and_b32 v71, v6, v71
  v_add_f32 v14, v14, v7
  v_add_f32 v15, v15, v71
  s_waitcnt vmcnt(1)
  v_lshlrev_b32 v7, 16, v72
  v_and_b32 v72, v6, v72
  v_add_f32 v8, v8, v7
  v_add_f32 v9, v9, v72
  v_lshlrev_b32 v7, 16, v73
  v_and_b32 v73, v6, v73
  v_add_f32 v10, v10, v7
  v_add_f32 v11, v11, v73
  v_lshlrev_b32 v7, 16, v74
  v_and_b32 v74, v6, v74
  v_add_f32 v12, v12, v7
  v_add_f32 v13, v13, v74
  v_lshlrev_b32 v7, 16, v75
  v_and_b32 v75, v6, v75
  v_add_f32 v14, v14, v7
  v_add_f32 v15, v15, v75
  s_waitcnt vmcnt(0)
  v_lshlrev_b32 v7, 16, v76
  v_and_b32 v76, v6, v76
  v_add_f32 v8, v8, v7
  v_add_f32 v9, v9, v76
  v_lshlrev_b32 v7, 16, v77
  v_and_b32 v77, v6, v77
  v_add_f32 v10, v10, v7
  v_add_f32 v11, v11, v77
  v_lshlrev_b32 v7, 16, v78
  v_and_b32 v78, v6, v78
  v_add_f32 v12, v12, v7
  v_add_f32 v13, v13, v78
  v_lshlrev_b32 v7, 16, v79
  v_and_b32 v79, v6, v79
  v_add_f32 v14, v14, v7
  v_add_f32 v15, v15, v79
  v_lshlrev_b32 v7, 5, v2
  v_add_u32 v7, s17, v7
  ds_write_b128 v7, v[8:11]
  ds_write_b128 v7, v[12:15] offset:16
  v_lshlrev_b32 v7, 3, v2
  v_add_u32 v7, s17, v7
  s_waitcnt lgkmcnt(0)
  ds_read_b64 v[16:17], v7 offset:0
  ds_read_b64 v[18:19], v7 offset:384
  ds_read_b64 v[20:21], v7 offset:768
  ds_read_b64 v[22:23], v7 offset:1152
  s_waitcnt lgkmcnt(0)
  v_add_f32 v16, v16, v18
  v_add_f32 v17, v17, v19
  v_add_f32 v20, v20, v22
  v_add_f32 v21, v21, v23
  v_add_f32 v16, v16, v20
  v_add_f32 v17, v17, v21
  v_mul_f32 v16, 0x3c800000, v16
  v_mul_f32 v17, 0x3c800000, v17
  s_nop 0
  v_cvt_pk_bf16_f32 v16, v16, v17
  v_lshlrev_b32 v7, 2, v2
  s_mul_i32 s18, s12, 192
  s_add_u32 s18, s18, 0
  buffer_store_dword v16, v7, s[8:11], s18 offen
Lpool_end:
  s_endpgm
.section .rodata,"a"
.p2align 6
.amdhsa_kernel k_pool_kernel
  .amdhsa_next_free_vgpr 80
  .amdhsa_next_free_sgpr 32
  .amdhsa_accum_offset 80
  .amdhsa_group_segment_fixed_size 0
  .amdhsa_kernarg_size 56
  .amdhsa_user_sgpr_count 2
  .amdhsa_user_sgpr_kernarg_segment_ptr 1
  .amdhsa_system_sgpr_workgroup_id_x 1
.end_amdhsa_kernel
.text

.globl k_proj_kernel
.p2align 8
.type k_proj_kernel,@function
k_proj_kernel:

  s_cmp_ge_u32 s2, 144
  s_cbranch_scc1 Lproj_end
  s_load_dwordx2 s[4:5], s[0:1], 8
  s_load_dwordx2 s[8:9], s[0:1], 16
  s_load_dwordx2 s[12:13], s[0:1], 24
  s_load_dwordx2 s[16:17], s[0:1], 48
  v_and_b32 v1, 31, v0
  v_lshrrev_b32 v2, 5, v0
  s_lshr_b32 s26, s2, 1
  s_and_b32 s27, s2, 1
  s_waitcnt lgkmcnt(0)
  s_mov_b32 s6, 18432
  s_mov_b32 s7, 0x20000
  s_mov_b32 s10, 36864
  s_mov_b32 s11, 0x20000
  s_mov_b32 s14, 18432
  s_mov_b32 s15, 0x20000
  s_mov_b32 s18, 268435456
  s_mov_b32 s19, 0x20000
  v_mul_u32_u24 v3, 192, v1
  v_lshl_add_u32 v3, v2, 4, v3
  s_mul_i32 s20, s26, 6144
  s_add_u32 s20, s20, 0
  buffer_load_dwordx4 v[16:19], v3, s[16:19], s20 offen offset:0
  buffer_load_dwordx4 v[20:23], v3, s[16:19], s20 offen offset:32
  buffer_load_dwordx4 v[24:27], v3, s[16:19], s20 offen offset:64
  buffer_load_dwordx4 v[28:31], v3, s[16:19], s20 offen offset:96
  buffer_load_dwordx4 v[32:35], v3, s[16:19], s20 offen offset:128
  buffer_load_dwordx4 v[36:39], v3, s[16:19], s20 offen offset:160
  v_mul_u32_u24 v4, 3072, v2
  v_lshl_add_u32 v4, v1, 1, v4
  s_mul_i32 s28, s27, 192
  s_add_u32 s21, s28, 0
  buffer_load_ushort v40, v4, s[8:11], s21 offen offset:0
  buffer_load_ushort a0, v4, s[8:11], s21 offen offset:384
  buffer_load_ushort v41, v4, s[8:11], s21 offen offset:768
  buffer_load_ushort a1, v4, s[8:11], s21 offen offset:1152
  buffer_load_ushort v42, v4, s[8:11], s21 offen offset:1536
  buffer_load_ushort a2, v4, s[8:11], s21 offen offset:1920
  buffer_load_ushort v43, v4, s[8:11], s21 offen offset:2304
  buffer_load_ushort a3, v4, s[8:11], s21 offen offset:2688
  buffer_load_ushort v64, v4, s[8:11], s21 offen offset:64
  buffer_load_ushort a24, v4, s[8:11], s21 offen offset:448
  buffer_load_ushort v65, v4, s[8:11], s21 offen offset:832
  buffer_load_ushort a25, v4, s[8:11], s21 offen offset:1216
  buffer_load_ushort v66, v4, s[8:11], s21 offen offset:1600
  buffer_load_ushort a26, v4, s[8:11], s21 offen offset:1984
  buffer_load_ushort v67, v4, s[8:11], s21 offen offset:2368
  buffer_load_ushort a27, v4, s[8:11], s21 offen offset:2752
  buffer_load_ushort v88, v4, s[8:11], s21 offen offset:128
  buffer_load_ushort a48, v4, s[8:11], s21 offen offset:512
  buffer_load_ushort v89, v4, s[8:11], s21 offen offset:896
  buffer_load_ushort a49, v4, s[8:11], s21 offen offset:1280
  buffer_load_ushort v90, v4, s[8:11], s21 offen offset:1664
  buffer_load_ushort a50, v4, s[8:11], s21 offen offset:2048
  buffer_load_ushort v91, v4, s[8:11], s21 offen offset:2432
  buffer_load_ushort a51, v4, s[8:11], s21 offen offset:2816
  s_add_u32 s21, s28, 6144
  buffer_load_ushort v44, v4, s[8:11], s21 offen offset:0
  buffer_load_ushort a4, v4, s[8:11], s21 offen offset:384
  buffer_load_ushort v45, v4, s[8:11], s21 offen offset:768
  buffer_load_ushort a5, v4, s[8:11], s21 offen offset:1152
  buffer_load_ushort v46, v4, s[8:11], s21 offen offset:1536
  buffer_load_ushort a6, v4, s[8:11], s21 offen offset:1920
  buffer_load_ushort v47, v4, s[8:11], s21 offen offset:2304
  buffer_load_ushort a7, v4, s[8:11], s21 offen offset:2688
  buffer_load_ushort v68, v4, s[8:11], s21 offen offset:64
  buffer_load_ushort a28, v4, s[8:11], s21 offen offset:448
  buffer_load_ushort v69, v4, s[8:11], s21 offen offset:832
  buffer_load_ushort a29, v4, s[8:11], s21 offen offset:1216
  buffer_load_ushort v70, v4, s[8:11], s21 offen offset:1600
  buffer_load_ushort a30, v4, s[8:11], s21 offen offset:1984
  buffer_load_ushort v71, v4, s[8:11], s21 offen offset:2368
  buffer_load_ushort a31, v4, s[8:11], s21 offen offset:2752
  buffer_load_ushort v92, v4, s[8:11], s21 offen offset:128
  buffer_load_ushort a52, v4, s[8:11], s21 offen offset:512
  buffer_load_ushort v93, v4, s[8:11], s21 offen offset:896
  buffer_load_ushort a53, v4, s[8:11], s21 offen offset:1280
  buffer_load_ushort v94, v4, s[8:11], s21 offen offset:1664
  buffer_load_ushort a54, v4, s[8:11], s21 offen offset:2048
  buffer_load_ushort v95, v4, s[8:11], s21 offen offset:2432
  buffer_load_ushort a55, v4, s[8:11], s21 offen offset:2816
  s_add_u32 s21, s28, 12288
  buffer_load_ushort v48, v4, s[8:11], s21 offen offset:0
  buffer_load_ushort a8, v4, s[8:11], s21 offen offset:384
  buffer_load_ushort v49, v4, s[8:11], s21 offen offset:768
  buffer_load_ushort a9, v4, s[8:11], s21 offen offset:1152
  buffer_load_ushort v50, v4, s[8:11], s21 offen offset:1536
  buffer_load_ushort a10, v4, s[8:11], s21 offen offset:1920
  buffer_load_ushort v51, v4, s[8:11], s21 offen offset:2304
  buffer_load_ushort a11, v4, s[8:11], s21 offen offset:2688
  buffer_load_ushort v72, v4, s[8:11], s21 offen offset:64
  buffer_load_ushort a32, v4, s[8:11], s21 offen offset:448
  buffer_load_ushort v73, v4, s[8:11], s21 offen offset:832
  buffer_load_ushort a33, v4, s[8:11], s21 offen offset:1216
  buffer_load_ushort v74, v4, s[8:11], s21 offen offset:1600
  buffer_load_ushort a34, v4, s[8:11], s21 offen offset:1984
  buffer_load_ushort v75, v4, s[8:11], s21 offen offset:2368
  buffer_load_ushort a35, v4, s[8:11], s21 offen offset:2752
  buffer_load_ushort v96, v4, s[8:11], s21 offen offset:128
  buffer_load_ushort a56, v4, s[8:11], s21 offen offset:512
  buffer_load_ushort v97, v4, s[8:11], s21 offen offset:896
  buffer_load_ushort a57, v4, s[8:11], s21 offen offset:1280
  buffer_load_ushort v98, v4, s[8:11], s21 offen offset:1664
  buffer_load_ushort a58, v4, s[8:11], s21 offen offset:2048
  buffer_load_ushort v99, v4, s[8:11], s21 offen offset:2432
  buffer_load_ushort a59, v4, s[8:11], s21 offen offset:2816
  s_add_u32 s21, s28, 18432
  buffer_load_ushort v52, v4, s[8:11], s21 offen offset:0
  buffer_load_ushort a12, v4, s[8:11], s21 offen offset:384
  buffer_load_ushort v53, v4, s[8:11], s21 offen offset:768
  buffer_load_ushort a13, v4, s[8:11], s21 offen offset:1152
  buffer_load_ushort v54, v4, s[8:11], s21 offen offset:1536
  buffer_load_ushort a14, v4, s[8:11], s21 offen offset:1920
  buffer_load_ushort v55, v4, s[8:11], s21 offen offset:2304
  buffer_load_ushort a15, v4, s[8:11], s21 offen offset:2688
  buffer_load_ushort v76, v4, s[8:11], s21 offen offset:64
  buffer_load_ushort a36, v4, s[8:11], s21 offen offset:448
  buffer_load_ushort v77, v4, s[8:11], s21 offen offset:832
  buffer_load_ushort a37, v4, s[8:11], s21 offen offset:1216
  buffer_load_ushort v78, v4, s[8:11], s21 offen offset:1600
  buffer_load_ushort a38, v4, s[8:11], s21 offen offset:1984
  buffer_load_ushort v79, v4, s[8:11], s21 offen offset:2368
  buffer_load_ushort a39, v4, s[8:11], s21 offen offset:2752
  buffer_load_ushort v100, v4, s[8:11], s21 offen offset:128
  buffer_load_ushort a60, v4, s[8:11], s21 offen offset:512
  buffer_load_ushort v101, v4, s[8:11], s21 offen offset:896
  buffer_load_ushort a61, v4, s[8:11], s21 offen offset:1280
  buffer_load_ushort v102, v4, s[8:11], s21 offen offset:1664
  buffer_load_ushort a62, v4, s[8:11], s21 offen offset:2048
  buffer_load_ushort v103, v4, s[8:11], s21 offen offset:2432
  buffer_load_ushort a63, v4, s[8:11], s21 offen offset:2816
  s_add_u32 s21, s28, 24576
  buffer_load_ushort v56, v4, s[8:11], s21 offen offset:0
  buffer_load_ushort a16, v4, s[8:11], s21 offen offset:384
  buffer_load_ushort v57, v4, s[8:11], s21 offen offset:768
  buffer_load_ushort a17, v4, s[8:11], s21 offen offset:1152
  buffer_load_ushort v58, v4, s[8:11], s21 offen offset:1536
  buffer_load_ushort a18, v4, s[8:11], s21 offen offset:1920
  buffer_load_ushort v59, v4, s[8:11], s21 offen offset:2304
  buffer_load_ushort a19, v4, s[8:11], s21 offen offset:2688
  buffer_load_ushort v80, v4, s[8:11], s21 offen offset:64
  buffer_load_ushort a40, v4, s[8:11], s21 offen offset:448
  buffer_load_ushort v81, v4, s[8:11], s21 offen offset:832
  buffer_load_ushort a41, v4, s[8:11], s21 offen offset:1216
  buffer_load_ushort v82, v4, s[8:11], s21 offen offset:1600
  buffer_load_ushort a42, v4, s[8:11], s21 offen offset:1984
  buffer_load_ushort v83, v4, s[8:11], s21 offen offset:2368
  buffer_load_ushort a43, v4, s[8:11], s21 offen offset:2752
  buffer_load_ushort v104, v4, s[8:11], s21 offen offset:128
  buffer_load_ushort a64, v4, s[8:11], s21 offen offset:512
  buffer_load_ushort v105, v4, s[8:11], s21 offen offset:896
  buffer_load_ushort a65, v4, s[8:11], s21 offen offset:1280
  buffer_load_ushort v106, v4, s[8:11], s21 offen offset:1664
  buffer_load_ushort a66, v4, s[8:11], s21 offen offset:2048
  buffer_load_ushort v107, v4, s[8:11], s21 offen offset:2432
  buffer_load_ushort a67, v4, s[8:11], s21 offen offset:2816
  s_add_u32 s21, s28, 30720
  buffer_load_ushort v60, v4, s[8:11], s21 offen offset:0
  buffer_load_ushort a20, v4, s[8:11], s21 offen offset:384
  buffer_load_ushort v61, v4, s[8:11], s21 offen offset:768
  buffer_load_ushort a21, v4, s[8:11], s21 offen offset:1152
  buffer_load_ushort v62, v4, s[8:11], s21 offen offset:1536
  buffer_load_ushort a22, v4, s[8:11], s21 offen offset:1920
  buffer_load_ushort v63, v4, s[8:11], s21 offen offset:2304
  buffer_load_ushort a23, v4, s[8:11], s21 offen offset:2688
  buffer_load_ushort v84, v4, s[8:11], s21 offen offset:64
  buffer_load_ushort a44, v4, s[8:11], s21 offen offset:448
  buffer_load_ushort v85, v4, s[8:11], s21 offen offset:832
  buffer_load_ushort a45, v4, s[8:11], s21 offen offset:1216
  buffer_load_ushort v86, v4, s[8:11], s21 offen offset:1600
  buffer_load_ushort a46, v4, s[8:11], s21 offen offset:1984
  buffer_load_ushort v87, v4, s[8:11], s21 offen offset:2368
  buffer_load_ushort a47, v4, s[8:11], s21 offen offset:2752
  buffer_load_ushort v108, v4, s[8:11], s21 offen offset:128
  buffer_load_ushort a68, v4, s[8:11], s21 offen offset:512
  buffer_load_ushort v109, v4, s[8:11], s21 offen offset:896
  buffer_load_ushort a69, v4, s[8:11], s21 offen offset:1280
  buffer_load_ushort v110, v4, s[8:11], s21 offen offset:1664
  buffer_load_ushort a70, v4, s[8:11], s21 offen offset:2048
  buffer_load_ushort v111, v4, s[8:11], s21 offen offset:2432
  buffer_load_ushort a71, v4, s[8:11], s21 offen offset:2816
  s_cmp_eq_u32 s27, 1
  s_cbranch_scc1 Lproj_v
  v_mul_u32_u24 v5, 192, v1
  v_lshl_add_u32 v5, v2, 3, v5
  s_mov_b32 s21, 0
  buffer_load_dwordx2 a[72:73], v5, s[4:7], s21 offen offset:0
  buffer_load_dwordx2 a[74:75], v5, s[4:7], s21 offen offset:16
  buffer_load_dwordx2 a[76:77], v5, s[4:7], s21 offen offset:32
  buffer_load_dwordx2 a[78:79], v5, s[4:7], s21 offen offset:48
  buffer_load_dwordx2 a[80:81], v5, s[4:7], s21 offen offset:64
  buffer_load_dwordx2 a[82:83], v5, s[4:7], s21 offen offset:80
  buffer_load_dwordx2 a[84:85], v5, s[4:7], s21 offen offset:96
  buffer_load_dwordx2 a[86:87], v5, s[4:7], s21 offen offset:112
  buffer_load_dwordx2 a[88:89], v5, s[4:7], s21 offen offset:128
  buffer_load_dwordx2 a[90:91], v5, s[4:7], s21 offen offset:144
  buffer_load_dwordx2 a[92:93], v5, s[4:7], s21 offen offset:160
  buffer_load_dwordx2 a[94:95], v5, s[4:7], s21 offen offset:176
  s_mov_b32 s21, 6144
  buffer_load_dwordx2 a[96:97], v5, s[4:7], s21 offen offset:0
  buffer_load_dwordx2 a[98:99], v5, s[4:7], s21 offen offset:16
  buffer_load_dwordx2 a[100:101], v5, s[4:7], s21 offen offset:32
  buffer_load_dwordx2 a[102:103], v5, s[4:7], s21 offen offset:48
  buffer_load_dwordx2 a[104:105], v5, s[4:7], s21 offen offset:64
  buffer_load_dwordx2 a[106:107], v5, s[4:7], s21 offen offset:80
  buffer_load_dwordx2 a[108:109], v5, s[4:7], s21 offen offset:96
  buffer_load_dwordx2 a[110:111], v5, s[4:7], s21 offen offset:112
  buffer_load_dwordx2 a[112:113], v5, s[4:7], s21 offen offset:128
  buffer_load_dwordx2 a[114:115], v5, s[4:7], s21 offen offset:144
  buffer_load_dwordx2 a[116:117], v5, s[4:7], s21 offen offset:160
  buffer_load_dwordx2 a[118:119], v5, s[4:7], s21 offen offset:176
  s_mov_b32 s21, 12288
  buffer_load_dwordx2 a[120:121], v5, s[4:7], s21 offen offset:0
  buffer_load_dwordx2 a[122:123], v5, s[4:7], s21 offen offset:16
  buffer_load_dwordx2 a[124:125], v5, s[4:7], s21 offen offset:32
  buffer_load_dwordx2 a[126:127], v5, s[4:7], s21 offen offset:48
  buffer_load_dwordx2 a[128:129], v5, s[4:7], s21 offen offset:64
  buffer_load_dwordx2 a[130:131], v5, s[4:7], s21 offen offset:80
  buffer_load_dwordx2 a[132:133], v5, s[4:7], s21 offen offset:96
  buffer_load_dwordx2 a[134:135], v5, s[4:7], s21 offen offset:112
  buffer_load_dwordx2 a[136:137], v5, s[4:7], s21 offen offset:128
  buffer_load_dwordx2 a[138:139], v5, s[4:7], s21 offen offset:144
  buffer_load_dwordx2 a[140:141], v5, s[4:7], s21 offen offset:160
  buffer_load_dwordx2 a[142:143], v5, s[4:7], s21 offen offset:176
  s_waitcnt vmcnt(0)
  v_accvgpr_read_b32 v8, a0
  s_nop 0
  v_lshl_or_b32 v40, v8, 16, v40
  v_accvgpr_read_b32 v8, a1
  s_nop 0
  v_lshl_or_b32 v41, v8, 16, v41
  v_accvgpr_read_b32 v8, a2
  s_nop 0
  v_lshl_or_b32 v42, v8, 16, v42
  v_accvgpr_read_b32 v8, a3
  s_nop 0
  v_lshl_or_b32 v43, v8, 16, v43
  v_accvgpr_read_b32 v8, a4
  s_nop 0
  v_lshl_or_b32 v44, v8, 16, v44
  v_accvgpr_read_b32 v8, a5
  s_nop 0
  v_lshl_or_b32 v45, v8, 16, v45
  v_accvgpr_read_b32 v8, a6
  s_nop 0
  v_lshl_or_b32 v46, v8, 16, v46
  v_accvgpr_read_b32 v8, a7
  s_nop 0
  v_lshl_or_b32 v47, v8, 16, v47
  v_accvgpr_read_b32 v8, a8
  s_nop 0
  v_lshl_or_b32 v48, v8, 16, v48
  v_accvgpr_read_b32 v8, a9
  s_nop 0
  v_lshl_or_b32 v49, v8, 16, v49
  v_accvgpr_read_b32 v8, a10
  s_nop 0
  v_lshl_or_b32 v50, v8, 16, v50
  v_accvgpr_read_b32 v8, a11
  s_nop 0
  v_lshl_or_b32 v51, v8, 16, v51
  v_accvgpr_read_b32 v8, a12
  s_nop 0
  v_lshl_or_b32 v52, v8, 16, v52
  v_accvgpr_read_b32 v8, a13
  s_nop 0
  v_lshl_or_b32 v53, v8, 16, v53
  v_accvgpr_read_b32 v8, a14
  s_nop 0
  v_lshl_or_b32 v54, v8, 16, v54
  v_accvgpr_read_b32 v8, a15
  s_nop 0
  v_lshl_or_b32 v55, v8, 16, v55
  v_accvgpr_read_b32 v8, a16
  s_nop 0
  v_lshl_or_b32 v56, v8, 16, v56
  v_accvgpr_read_b32 v8, a17
  s_nop 0
  v_lshl_or_b32 v57, v8, 16, v57
  v_accvgpr_read_b32 v8, a18
  s_nop 0
  v_lshl_or_b32 v58, v8, 16, v58
  v_accvgpr_read_b32 v8, a19
  s_nop 0
  v_lshl_or_b32 v59, v8, 16, v59
  v_accvgpr_read_b32 v8, a20
  s_nop 0
  v_lshl_or_b32 v60, v8, 16, v60
  v_accvgpr_read_b32 v8, a21
  s_nop 0
  v_lshl_or_b32 v61, v8, 16, v61
  v_accvgpr_read_b32 v8, a22
  s_nop 0
  v_lshl_or_b32 v62, v8, 16, v62
  v_accvgpr_read_b32 v8, a23
  s_nop 0
  v_lshl_or_b32 v63, v8, 16, v63
  v_accvgpr_read_b32 v8, a24
  s_nop 0
  v_lshl_or_b32 v64, v8, 16, v64
  v_accvgpr_read_b32 v8, a25
  s_nop 0
  v_lshl_or_b32 v65, v8, 16, v65
  v_accvgpr_read_b32 v8, a26
  s_nop 0
  v_lshl_or_b32 v66, v8, 16, v66
  v_accvgpr_read_b32 v8, a27
  s_nop 0
  v_lshl_or_b32 v67, v8, 16, v67
  v_accvgpr_read_b32 v8, a28
  s_nop 0
  v_lshl_or_b32 v68, v8, 16, v68
  v_accvgpr_read_b32 v8, a29
  s_nop 0
  v_lshl_or_b32 v69, v8, 16, v69
  v_accvgpr_read_b32 v8, a30
  s_nop 0
  v_lshl_or_b32 v70, v8, 16, v70
  v_accvgpr_read_b32 v8, a31
  s_nop 0
  v_lshl_or_b32 v71, v8, 16, v71
  v_accvgpr_read_b32 v8, a32
  s_nop 0
  v_lshl_or_b32 v72, v8, 16, v72
  v_accvgpr_read_b32 v8, a33
  s_nop 0
  v_lshl_or_b32 v73, v8, 16, v73
  v_accvgpr_read_b32 v8, a34
  s_nop 0
  v_lshl_or_b32 v74, v8, 16, v74
  v_accvgpr_read_b32 v8, a35
  s_nop 0
  v_lshl_or_b32 v75, v8, 16, v75
  v_accvgpr_read_b32 v8, a36
  s_nop 0
  v_lshl_or_b32 v76, v8, 16, v76
  v_accvgpr_read_b32 v8, a37
  s_nop 0
  v_lshl_or_b32 v77, v8, 16, v77
  v_accvgpr_read_b32 v8, a38
  s_nop 0
  v_lshl_or_b32 v78, v8, 16, v78
  v_accvgpr_read_b32 v8, a39
  s_nop 0
  v_lshl_or_b32 v79, v8, 16, v79
  v_accvgpr_read_b32 v8, a40
  s_nop 0
  v_lshl_or_b32 v80, v8, 16, v80
  v_accvgpr_read_b32 v8, a41
  s_nop 0
  v_lshl_or_b32 v81, v8, 16, v81
  v_accvgpr_read_b32 v8, a42
  s_nop 0
  v_lshl_or_b32 v82, v8, 16, v82
  v_accvgpr_read_b32 v8, a43
  s_nop 0
  v_lshl_or_b32 v83, v8, 16, v83
  v_accvgpr_read_b32 v8, a44
  s_nop 0
  v_lshl_or_b32 v84, v8, 16, v84
  v_accvgpr_read_b32 v8, a45
  s_nop 0
  v_lshl_or_b32 v85, v8, 16, v85
  v_accvgpr_read_b32 v8, a46
  s_nop 0
  v_lshl_or_b32 v86, v8, 16, v86
  v_accvgpr_read_b32 v8, a47
  s_nop 0
  v_lshl_or_b32 v87, v8, 16, v87
  v_accvgpr_read_b32 v8, a48
  s_nop 0
  v_lshl_or_b32 v88, v8, 16, v88
  v_accvgpr_read_b32 v8, a49
  s_nop 0
  v_lshl_or_b32 v89, v8, 16, v89
  v_accvgpr_read_b32 v8, a50
  s_nop 0
  v_lshl_or_b32 v90, v8, 16, v90
  v_accvgpr_read_b32 v8, a51
  s_nop 0
  v_lshl_or_b32 v91, v8, 16, v91
  v_accvgpr_read_b32 v8, a52
  s_nop 0
  v_lshl_or_b32 v92, v8, 16, v92
  v_accvgpr_read_b32 v8, a53
  s_nop 0
  v_lshl_or_b32 v93, v8, 16, v93
  v_accvgpr_read_b32 v8, a54
  s_nop 0
  v_lshl_or_b32 v94, v8, 16, v94
  v_accvgpr_read_b32 v8, a55
  s_nop 0
  v_lshl_or_b32 v95, v8, 16, v95
  v_accvgpr_read_b32 v8, a56
  s_nop 0
  v_lshl_or_b32 v96, v8, 16, v96
  v_accvgpr_read_b32 v8, a57
  s_nop 0
  v_lshl_or_b32 v97, v8, 16, v97
  v_accvgpr_read_b32 v8, a58
  s_nop 0
  v_lshl_or_b32 v98, v8, 16, v98
  v_accvgpr_read_b32 v8, a59
  s_nop 0
  v_lshl_or_b32 v99, v8, 16, v99
  v_accvgpr_read_b32 v8, a60
  s_nop 0
  v_lshl_or_b32 v100, v8, 16, v100
  v_accvgpr_read_b32 v8, a61
  s_nop 0
  v_lshl_or_b32 v101, v8, 16, v101
  v_accvgpr_read_b32 v8, a62
  s_nop 0
  v_lshl_or_b32 v102, v8, 16, v102
  v_accvgpr_read_b32 v8, a63
  s_nop 0
  v_lshl_or_b32 v103, v8, 16, v103
  v_accvgpr_read_b32 v8, a64
  s_nop 0
  v_lshl_or_b32 v104, v8, 16, v104
  v_accvgpr_read_b32 v8, a65
  s_nop 0
  v_lshl_or_b32 v105, v8, 16, v105
  v_accvgpr_read_b32 v8, a66
  s_nop 0
  v_lshl_or_b32 v106, v8, 16, v106
  v_accvgpr_read_b32 v8, a67
  s_nop 0
  v_lshl_or_b32 v107, v8, 16, v107
  v_accvgpr_read_b32 v8, a68
  s_nop 0
  v_lshl_or_b32 v108, v8, 16, v108
  v_accvgpr_read_b32 v8, a69
  s_nop 0
  v_lshl_or_b32 v109, v8, 16, v109
  v_accvgpr_read_b32 v8, a70
  s_nop 0
  v_lshl_or_b32 v110, v8, 16, v110
  v_accvgpr_read_b32 v8, a71
  s_nop 0
  v_lshl_or_b32 v111, v8, 16, v111
  s_nop 3
  v_mfma_f32_32x32x16_bf16 v[112:127], v[40:43], v[16:19], 0
  v_mfma_f32_32x32x16_bf16 v[112:127], v[44:47], v[20:23], v[112:127]
  v_mfma_f32_32x32x16_bf16 v[112:127], v[48:51], v[24:27], v[112:127]
  v_mfma_f32_32x32x16_bf16 v[112:127], v[52:55], v[28:31], v[112:127]
  v_mfma_f32_32x32x16_bf16 v[112:127], v[56:59], v[32:35], v[112:127]
  v_mfma_f32_32x32x16_bf16 v[112:127], v[60:63], v[36:39], v[112:127]
  v_mfma_f32_32x32x16_bf16 v[128:143], v[64:67], v[16:19], 0
  v_mfma_f32_32x32x16_bf16 v[128:143], v[68:71], v[20:23], v[128:143]
  v_mfma_f32_32x32x16_bf16 v[128:143], v[72:75], v[24:27], v[128:143]
  v_mfma_f32_32x32x16_bf16 v[128:143], v[76:79], v[28:31], v[128:143]
  v_mfma_f32_32x32x16_bf16 v[128:143], v[80:83], v[32:35], v[128:143]
  v_mfma_f32_32x32x16_bf16 v[128:143], v[84:87], v[36:39], v[128:143]
  v_mfma_f32_32x32x16_bf16 v[144:159], v[88:91], v[16:19], 0
  v_mfma_f32_32x32x16_bf16 v[144:159], v[92:95], v[20:23], v[144:159]
  v_mfma_f32_32x32x16_bf16 v[144:159], v[96:99], v[24:27], v[144:159]
  v_mfma_f32_32x32x16_bf16 v[144:159], v[100:103], v[28:31], v[144:159]
  v_mfma_f32_32x32x16_bf16 v[144:159], v[104:107], v[32:35], v[144:159]
  v_mfma_f32_32x32x16_bf16 v[144:159], v[108:111], v[36:39], v[144:159]
  s_nop 15
  s_nop 15
  v_cvt_pk_bf16_f32 v160, v112, v113
  v_cvt_pk_bf16_f32 v161, v114, v115
  v_cvt_pk_bf16_f32 v162, v116, v117
  v_cvt_pk_bf16_f32 v163, v118, v119
  v_cvt_pk_bf16_f32 v164, v120, v121
  v_cvt_pk_bf16_f32 v165, v122, v123
  v_cvt_pk_bf16_f32 v166, v124, v125
  v_cvt_pk_bf16_f32 v167, v126, v127
  v_cvt_pk_bf16_f32 v168, v128, v129
  v_cvt_pk_bf16_f32 v169, v130, v131
  v_cvt_pk_bf16_f32 v170, v132, v133
  v_cvt_pk_bf16_f32 v171, v134, v135
  v_cvt_pk_bf16_f32 v172, v136, v137
  v_cvt_pk_bf16_f32 v173, v138, v139
  v_cvt_pk_bf16_f32 v174, v140, v141
  v_cvt_pk_bf16_f32 v175, v142, v143
  v_cvt_pk_bf16_f32 v176, v144, v145
  v_cvt_pk_bf16_f32 v177, v146, v147
  v_cvt_pk_bf16_f32 v178, v148, v149
  v_cvt_pk_bf16_f32 v179, v150, v151
  v_cvt_pk_bf16_f32 v180, v152, v153
  v_cvt_pk_bf16_f32 v181, v154, v155
  v_cvt_pk_bf16_f32 v182, v156, v157
  v_cvt_pk_bf16_f32 v183, v158, v159
  s_nop 3
  s_mov_b32 s24, 0x3e16c740
  v_lshlrev_b32 v7, 4, v1
  v_lshl_add_u32 v7, v2, 3, v7
  s_mul_i32 s22, s26, 12288
  s_add_u32 s22, s22, 1048576
  s_add_u32 s23, s22, 4096
  v_mfma_f32_32x32x16_bf16 v[192:207], a[72:75], v[160:163], 0
  v_mfma_f32_32x32x16_bf16 v[192:207], a[76:79], v[164:167], v[192:207]
  v_mfma_f32_32x32x16_bf16 v[192:207], a[80:83], v[168:171], v[192:207]
  v_mfma_f32_32x32x16_bf16 v[192:207], a[84:87], v[172:175], v[192:207]
  v_mfma_f32_32x32x16_bf16 v[192:207], a[88:91], v[176:179], v[192:207]
  v_mfma_f32_32x32x16_bf16 v[192:207], a[92:95], v[180:183], v[192:207]
  s_nop 15
  s_nop 15
  v_mul_f32 v192, s24, v192
  v_mul_f32 v193, s24, v193
  v_mul_f32 v194, s24, v194
  v_mul_f32 v195, s24, v195
  s_nop 0
  v_cvt_pk_bf16_f32 v8, v192, v193
  v_cvt_pk_bf16_f32 v9, v194, v195
  buffer_store_dwordx2 v[8:9], v7, s[16:19], s22 offen offset:0
  v_mul_f32 v196, s24, v196
  v_mul_f32 v197, s24, v197
  v_mul_f32 v198, s24, v198
  v_mul_f32 v199, s24, v199
  s_nop 0
  v_cvt_pk_bf16_f32 v10, v196, v197
  v_cvt_pk_bf16_f32 v11, v198, v199
  buffer_store_dwordx2 v[10:11], v7, s[16:19], s22 offen offset:512
  v_mul_f32 v200, s24, v200
  v_mul_f32 v201, s24, v201
  v_mul_f32 v202, s24, v202
  v_mul_f32 v203, s24, v203
  s_nop 0
  v_cvt_pk_bf16_f32 v12, v200, v201
  v_cvt_pk_bf16_f32 v13, v202, v203
  buffer_store_dwordx2 v[12:13], v7, s[16:19], s22 offen offset:1024
  v_mul_f32 v204, s24, v204
  v_mul_f32 v205, s24, v205
  v_mul_f32 v206, s24, v206
  v_mul_f32 v207, s24, v207
  s_nop 0
  v_cvt_pk_bf16_f32 v14, v204, v205
  v_cvt_pk_bf16_f32 v15, v206, v207
  buffer_store_dwordx2 v[14:15], v7, s[16:19], s22 offen offset:1536
  s_waitcnt vmcnt(0)
  v_mfma_f32_32x32x16_bf16 v[192:207], a[96:99], v[160:163], 0
  v_mfma_f32_32x32x16_bf16 v[192:207], a[100:103], v[164:167], v[192:207]
  v_mfma_f32_32x32x16_bf16 v[192:207], a[104:107], v[168:171], v[192:207]
  v_mfma_f32_32x32x16_bf16 v[192:207], a[108:111], v[172:175], v[192:207]
  v_mfma_f32_32x32x16_bf16 v[192:207], a[112:115], v[176:179], v[192:207]
  v_mfma_f32_32x32x16_bf16 v[192:207], a[116:119], v[180:183], v[192:207]
  s_nop 15
  s_nop 15
  v_mul_f32 v192, s24, v192
  v_mul_f32 v193, s24, v193
  v_mul_f32 v194, s24, v194
  v_mul_f32 v195, s24, v195
  s_nop 0
  v_cvt_pk_bf16_f32 v8, v192, v193
  v_cvt_pk_bf16_f32 v9, v194, v195
  buffer_store_dwordx2 v[8:9], v7, s[16:19], s22 offen offset:2048
  v_mul_f32 v196, s24, v196
  v_mul_f32 v197, s24, v197
  v_mul_f32 v198, s24, v198
  v_mul_f32 v199, s24, v199
  s_nop 0
  v_cvt_pk_bf16_f32 v10, v196, v197
  v_cvt_pk_bf16_f32 v11, v198, v199
  buffer_store_dwordx2 v[10:11], v7, s[16:19], s22 offen offset:2560
  v_mul_f32 v200, s24, v200
  v_mul_f32 v201, s24, v201
  v_mul_f32 v202, s24, v202
  v_mul_f32 v203, s24, v203
  s_nop 0
  v_cvt_pk_bf16_f32 v12, v200, v201
  v_cvt_pk_bf16_f32 v13, v202, v203
  buffer_store_dwordx2 v[12:13], v7, s[16:19], s22 offen offset:3072
  v_mul_f32 v204, s24, v204
  v_mul_f32 v205, s24, v205
  v_mul_f32 v206, s24, v206
  v_mul_f32 v207, s24, v207
  s_nop 0
  v_cvt_pk_bf16_f32 v14, v204, v205
  v_cvt_pk_bf16_f32 v15, v206, v207
  buffer_store_dwordx2 v[14:15], v7, s[16:19], s22 offen offset:3584
  s_waitcnt vmcnt(0)
  v_mfma_f32_32x32x16_bf16 v[192:207], a[120:123], v[160:163], 0
  v_mfma_f32_32x32x16_bf16 v[192:207], a[124:127], v[164:167], v[192:207]
  v_mfma_f32_32x32x16_bf16 v[192:207], a[128:131], v[168:171], v[192:207]
  v_mfma_f32_32x32x16_bf16 v[192:207], a[132:135], v[172:175], v[192:207]
  v_mfma_f32_32x32x16_bf16 v[192:207], a[136:139], v[176:179], v[192:207]
  v_mfma_f32_32x32x16_bf16 v[192:207], a[140:143], v[180:183], v[192:207]
  s_nop 15
  s_nop 15
  v_mul_f32 v192, s24, v192
  v_mul_f32 v193, s24, v193
  v_mul_f32 v194, s24, v194
  v_mul_f32 v195, s24, v195
  s_nop 0
  v_cvt_pk_bf16_f32 v8, v192, v193
  v_cvt_pk_bf16_f32 v9, v194, v195
  buffer_store_dwordx2 v[8:9], v7, s[16:19], s23 offen offset:0
  v_mul_f32 v196, s24, v196
  v_mul_f32 v197, s24, v197
  v_mul_f32 v198, s24, v198
  v_mul_f32 v199, s24, v199
  s_nop 0
  v_cvt_pk_bf16_f32 v10, v196, v197
  v_cvt_pk_bf16_f32 v11, v198, v199
  buffer_store_dwordx2 v[10:11], v7, s[16:19], s23 offen offset:512
  v_mul_f32 v200, s24, v200
  v_mul_f32 v201, s24, v201
  v_mul_f32 v202, s24, v202
  v_mul_f32 v203, s24, v203
  s_nop 0
  v_cvt_pk_bf16_f32 v12, v200, v201
  v_cvt_pk_bf16_f32 v13, v202, v203
  buffer_store_dwordx2 v[12:13], v7, s[16:19], s23 offen offset:1024
  v_mul_f32 v204, s24, v204
  v_mul_f32 v205, s24, v205
  v_mul_f32 v206, s24, v206
  v_mul_f32 v207, s24, v207
  s_nop 0
  v_cvt_pk_bf16_f32 v14, v204, v205
  v_cvt_pk_bf16_f32 v15, v206, v207
  buffer_store_dwordx2 v[14:15], v7, s[16:19], s23 offen offset:1536
  s_waitcnt vmcnt(0)
  s_endpgm
Lproj_v:
  v_mul_u32_u24 v6, 768, v2
  v_lshl_add_u32 v6, v1, 1, v6
  s_mov_b32 s21, 0
  buffer_load_ushort v184, v6, s[12:15], s21 offen offset:0
  buffer_load_ushort a72, v6, s[12:15], s21 offen offset:192
  buffer_load_ushort v185, v6, s[12:15], s21 offen offset:384
  buffer_load_ushort a73, v6, s[12:15], s21 offen offset:576
  buffer_load_ushort v186, v6, s[12:15], s21 offen offset:1536
  buffer_load_ushort a74, v6, s[12:15], s21 offen offset:1728
  buffer_load_ushort v187, v6, s[12:15], s21 offen offset:1920
  buffer_load_ushort a75, v6, s[12:15], s21 offen offset:2112
  buffer_load_ushort v208, v6, s[12:15], s21 offen offset:64
  buffer_load_ushort a96, v6, s[12:15], s21 offen offset:256
  buffer_load_ushort v209, v6, s[12:15], s21 offen offset:448
  buffer_load_ushort a97, v6, s[12:15], s21 offen offset:640
  buffer_load_ushort v210, v6, s[12:15], s21 offen offset:1600
  buffer_load_ushort a98, v6, s[12:15], s21 offen offset:1792
  buffer_load_ushort v211, v6, s[12:15], s21 offen offset:1984
  buffer_load_ushort a99, v6, s[12:15], s21 offen offset:2176
  buffer_load_ushort v232, v6, s[12:15], s21 offen offset:128
  buffer_load_ushort a120, v6, s[12:15], s21 offen offset:320
  buffer_load_ushort v233, v6, s[12:15], s21 offen offset:512
  buffer_load_ushort a121, v6, s[12:15], s21 offen offset:704
  buffer_load_ushort v234, v6, s[12:15], s21 offen offset:1664
  buffer_load_ushort a122, v6, s[12:15], s21 offen offset:1856
  buffer_load_ushort v235, v6, s[12:15], s21 offen offset:2048
  buffer_load_ushort a123, v6, s[12:15], s21 offen offset:2240
  s_mov_b32 s21, 3072
  buffer_load_ushort v188, v6, s[12:15], s21 offen offset:0
  buffer_load_ushort a76, v6, s[12:15], s21 offen offset:192
  buffer_load_ushort v189, v6, s[12:15], s21 offen offset:384
  buffer_load_ushort a77, v6, s[12:15], s21 offen offset:576
  buffer_load_ushort v190, v6, s[12:15], s21 offen offset:1536
  buffer_load_ushort a78, v6, s[12:15], s21 offen offset:1728
  buffer_load_ushort v191, v6, s[12:15], s21 offen offset:1920
  buffer_load_ushort a79, v6, s[12:15], s21 offen offset:2112
  buffer_load_ushort v212, v6, s[12:15], s21 offen offset:64
  buffer_load_ushort a100, v6, s[12:15], s21 offen offset:256
  buffer_load_ushort v213, v6, s[12:15], s21 offen offset:448
  buffer_load_ushort a101, v6, s[12:15], s21 offen offset:640
  buffer_load_ushort v214, v6, s[12:15], s21 offen offset:1600
  buffer_load_ushort a102, v6, s[12:15], s21 offen offset:1792
  buffer_load_ushort v215, v6, s[12:15], s21 offen offset:1984
  buffer_load_ushort a103, v6, s[12:15], s21 offen offset:2176
  buffer_load_ushort v236, v6, s[12:15], s21 offen offset:128
  buffer_load_ushort a124, v6, s[12:15], s21 offen offset:320
  buffer_load_ushort v237, v6, s[12:15], s21 offen offset:512
  buffer_load_ushort a125, v6, s[12:15], s21 offen offset:704
  buffer_load_ushort v238, v6, s[12:15], s21 offen offset:1664
  buffer_load_ushort a126, v6, s[12:15], s21 offen offset:1856
  buffer_load_ushort v239, v6, s[12:15], s21 offen offset:2048
  buffer_load_ushort a127, v6, s[12:15], s21 offen offset:2240
  s_mov_b32 s21, 6144
  buffer_load_ushort v192, v6, s[12:15], s21 offen offset:0
  buffer_load_ushort a80, v6, s[12:15], s21 offen offset:192
  buffer_load_ushort v193, v6, s[12:15], s21 offen offset:384
  buffer_load_ushort a81, v6, s[12:15], s21 offen offset:576
  buffer_load_ushort v194, v6, s[12:15], s21 offen offset:1536
  buffer_load_ushort a82, v6, s[12:15], s21 offen offset:1728
  buffer_load_ushort v195, v6, s[12:15], s21 offen offset:1920
  buffer_load_ushort a83, v6, s[12:15], s21 offen offset:2112
  buffer_load_ushort v216, v6, s[12:15], s21 offen offset:64
  buffer_load_ushort a104, v6, s[12:15], s21 offen offset:256
  buffer_load_ushort v217, v6, s[12:15], s21 offen offset:448
  buffer_load_ushort a105, v6, s[12:15], s21 offen offset:640
  buffer_load_ushort v218, v6, s[12:15], s21 offen offset:1600
  buffer_load_ushort a106, v6, s[12:15], s21 offen offset:1792
  buffer_load_ushort v219, v6, s[12:15], s21 offen offset:1984
  buffer_load_ushort a107, v6, s[12:15], s21 offen offset:2176
  buffer_load_ushort v240, v6, s[12:15], s21 offen offset:128
  buffer_load_ushort a128, v6, s[12:15], s21 offen offset:320
  buffer_load_ushort v241, v6, s[12:15], s21 offen offset:512
  buffer_load_ushort a129, v6, s[12:15], s21 offen offset:704
  buffer_load_ushort v242, v6, s[12:15], s21 offen offset:1664
  buffer_load_ushort a130, v6, s[12:15], s21 offen offset:1856
  buffer_load_ushort v243, v6, s[12:15], s21 offen offset:2048
  buffer_load_ushort a131, v6, s[12:15], s21 offen offset:2240
  s_mov_b32 s21, 9216
  buffer_load_ushort v196, v6, s[12:15], s21 offen offset:0
  buffer_load_ushort a84, v6, s[12:15], s21 offen offset:192
  buffer_load_ushort v197, v6, s[12:15], s21 offen offset:384
  buffer_load_ushort a85, v6, s[12:15], s21 offen offset:576
  buffer_load_ushort v198, v6, s[12:15], s21 offen offset:1536
  buffer_load_ushort a86, v6, s[12:15], s21 offen offset:1728
  buffer_load_ushort v199, v6, s[12:15], s21 offen offset:1920
  buffer_load_ushort a87, v6, s[12:15], s21 offen offset:2112
  buffer_load_ushort v220, v6, s[12:15], s21 offen offset:64
  buffer_load_ushort a108, v6, s[12:15], s21 offen offset:256
  buffer_load_ushort v221, v6, s[12:15], s21 offen offset:448
  buffer_load_ushort a109, v6, s[12:15], s21 offen offset:640
  buffer_load_ushort v222, v6, s[12:15], s21 offen offset:1600
  buffer_load_ushort a110, v6, s[12:15], s21 offen offset:1792
  buffer_load_ushort v223, v6, s[12:15], s21 offen offset:1984
  buffer_load_ushort a111, v6, s[12:15], s21 offen offset:2176
  buffer_load_ushort v244, v6, s[12:15], s21 offen offset:128
  buffer_load_ushort a132, v6, s[12:15], s21 offen offset:320
  buffer_load_ushort v245, v6, s[12:15], s21 offen offset:512
  buffer_load_ushort a133, v6, s[12:15], s21 offen offset:704
  buffer_load_ushort v246, v6, s[12:15], s21 offen offset:1664
  buffer_load_ushort a134, v6, s[12:15], s21 offen offset:1856
  buffer_load_ushort v247, v6, s[12:15], s21 offen offset:2048
  buffer_load_ushort a135, v6, s[12:15], s21 offen offset:2240
  s_mov_b32 s21, 12288
  buffer_load_ushort v200, v6, s[12:15], s21 offen offset:0
  buffer_load_ushort a88, v6, s[12:15], s21 offen offset:192
  buffer_load_ushort v201, v6, s[12:15], s21 offen offset:384
  buffer_load_ushort a89, v6, s[12:15], s21 offen offset:576
  buffer_load_ushort v202, v6, s[12:15], s21 offen offset:1536
  buffer_load_ushort a90, v6, s[12:15], s21 offen offset:1728
  buffer_load_ushort v203, v6, s[12:15], s21 offen offset:1920
  buffer_load_ushort a91, v6, s[12:15], s21 offen offset:2112
  buffer_load_ushort v224, v6, s[12:15], s21 offen offset:64
  buffer_load_ushort a112, v6, s[12:15], s21 offen offset:256
  buffer_load_ushort v225, v6, s[12:15], s21 offen offset:448
  buffer_load_ushort a113, v6, s[12:15], s21 offen offset:640
  buffer_load_ushort v226, v6, s[12:15], s21 offen offset:1600
  buffer_load_ushort a114, v6, s[12:15], s21 offen offset:1792
  buffer_load_ushort v227, v6, s[12:15], s21 offen offset:1984
  buffer_load_ushort a115, v6, s[12:15], s21 offen offset:2176
  buffer_load_ushort v248, v6, s[12:15], s21 offen offset:128
  buffer_load_ushort a136, v6, s[12:15], s21 offen offset:320
  buffer_load_ushort v249, v6, s[12:15], s21 offen offset:512
  buffer_load_ushort a137, v6, s[12:15], s21 offen offset:704
  buffer_load_ushort v250, v6, s[12:15], s21 offen offset:1664
  buffer_load_ushort a138, v6, s[12:15], s21 offen offset:1856
  buffer_load_ushort v251, v6, s[12:15], s21 offen offset:2048
  buffer_load_ushort a139, v6, s[12:15], s21 offen offset:2240
  s_mov_b32 s21, 15360
  buffer_load_ushort v204, v6, s[12:15], s21 offen offset:0
  buffer_load_ushort a92, v6, s[12:15], s21 offen offset:192
  buffer_load_ushort v205, v6, s[12:15], s21 offen offset:384
  buffer_load_ushort a93, v6, s[12:15], s21 offen offset:576
  buffer_load_ushort v206, v6, s[12:15], s21 offen offset:1536
  buffer_load_ushort a94, v6, s[12:15], s21 offen offset:1728
  buffer_load_ushort v207, v6, s[12:15], s21 offen offset:1920
  buffer_load_ushort a95, v6, s[12:15], s21 offen offset:2112
  buffer_load_ushort v228, v6, s[12:15], s21 offen offset:64
  buffer_load_ushort a116, v6, s[12:15], s21 offen offset:256
  buffer_load_ushort v229, v6, s[12:15], s21 offen offset:448
  buffer_load_ushort a117, v6, s[12:15], s21 offen offset:640
  buffer_load_ushort v230, v6, s[12:15], s21 offen offset:1600
  buffer_load_ushort a118, v6, s[12:15], s21 offen offset:1792
  buffer_load_ushort v231, v6, s[12:15], s21 offen offset:1984
  buffer_load_ushort a119, v6, s[12:15], s21 offen offset:2176
  buffer_load_ushort v252, v6, s[12:15], s21 offen offset:128
  buffer_load_ushort a140, v6, s[12:15], s21 offen offset:320
  buffer_load_ushort v253, v6, s[12:15], s21 offen offset:512
  buffer_load_ushort a141, v6, s[12:15], s21 offen offset:704
  buffer_load_ushort v254, v6, s[12:15], s21 offen offset:1664
  buffer_load_ushort a142, v6, s[12:15], s21 offen offset:1856
  buffer_load_ushort v255, v6, s[12:15], s21 offen offset:2048
  buffer_load_ushort a143, v6, s[12:15], s21 offen offset:2240
  s_waitcnt vmcnt(0)
  v_accvgpr_read_b32 v8, a0
  s_nop 0
  v_lshl_or_b32 v40, v8, 16, v40
  v_accvgpr_read_b32 v8, a1
  s_nop 0
  v_lshl_or_b32 v41, v8, 16, v41
  v_accvgpr_read_b32 v8, a2
  s_nop 0
  v_lshl_or_b32 v42, v8, 16, v42
  v_accvgpr_read_b32 v8, a3
  s_nop 0
  v_lshl_or_b32 v43, v8, 16, v43
  v_accvgpr_read_b32 v8, a4
  s_nop 0
  v_lshl_or_b32 v44, v8, 16, v44
  v_accvgpr_read_b32 v8, a5
  s_nop 0
  v_lshl_or_b32 v45, v8, 16, v45
  v_accvgpr_read_b32 v8, a6
  s_nop 0
  v_lshl_or_b32 v46, v8, 16, v46
  v_accvgpr_read_b32 v8, a7
  s_nop 0
  v_lshl_or_b32 v47, v8, 16, v47
  v_accvgpr_read_b32 v8, a8
  s_nop 0
  v_lshl_or_b32 v48, v8, 16, v48
  v_accvgpr_read_b32 v8, a9
  s_nop 0
  v_lshl_or_b32 v49, v8, 16, v49
  v_accvgpr_read_b32 v8, a10
  s_nop 0
  v_lshl_or_b32 v50, v8, 16, v50
  v_accvgpr_read_b32 v8, a11
  s_nop 0
  v_lshl_or_b32 v51, v8, 16, v51
  v_accvgpr_read_b32 v8, a12
  s_nop 0
  v_lshl_or_b32 v52, v8, 16, v52
  v_accvgpr_read_b32 v8, a13
  s_nop 0
  v_lshl_or_b32 v53, v8, 16, v53
  v_accvgpr_read_b32 v8, a14
  s_nop 0
  v_lshl_or_b32 v54, v8, 16, v54
  v_accvgpr_read_b32 v8, a15
  s_nop 0
  v_lshl_or_b32 v55, v8, 16, v55
  v_accvgpr_read_b32 v8, a16
  s_nop 0
  v_lshl_or_b32 v56, v8, 16, v56
  v_accvgpr_read_b32 v8, a17
  s_nop 0
  v_lshl_or_b32 v57, v8, 16, v57
  v_accvgpr_read_b32 v8, a18
  s_nop 0
  v_lshl_or_b32 v58, v8, 16, v58
  v_accvgpr_read_b32 v8, a19
  s_nop 0
  v_lshl_or_b32 v59, v8, 16, v59
  v_accvgpr_read_b32 v8, a20
  s_nop 0
  v_lshl_or_b32 v60, v8, 16, v60
  v_accvgpr_read_b32 v8, a21
  s_nop 0
  v_lshl_or_b32 v61, v8, 16, v61
  v_accvgpr_read_b32 v8, a22
  s_nop 0
  v_lshl_or_b32 v62, v8, 16, v62
  v_accvgpr_read_b32 v8, a23
  s_nop 0
  v_lshl_or_b32 v63, v8, 16, v63
  v_accvgpr_read_b32 v8, a24
  s_nop 0
  v_lshl_or_b32 v64, v8, 16, v64
  v_accvgpr_read_b32 v8, a25
  s_nop 0
  v_lshl_or_b32 v65, v8, 16, v65
  v_accvgpr_read_b32 v8, a26
  s_nop 0
  v_lshl_or_b32 v66, v8, 16, v66
  v_accvgpr_read_b32 v8, a27
  s_nop 0
  v_lshl_or_b32 v67, v8, 16, v67
  v_accvgpr_read_b32 v8, a28
  s_nop 0
  v_lshl_or_b32 v68, v8, 16, v68
  v_accvgpr_read_b32 v8, a29
  s_nop 0
  v_lshl_or_b32 v69, v8, 16, v69
  v_accvgpr_read_b32 v8, a30
  s_nop 0
  v_lshl_or_b32 v70, v8, 16, v70
  v_accvgpr_read_b32 v8, a31
  s_nop 0
  v_lshl_or_b32 v71, v8, 16, v71
  v_accvgpr_read_b32 v8, a32
  s_nop 0
  v_lshl_or_b32 v72, v8, 16, v72
  v_accvgpr_read_b32 v8, a33
  s_nop 0
  v_lshl_or_b32 v73, v8, 16, v73
  v_accvgpr_read_b32 v8, a34
  s_nop 0
  v_lshl_or_b32 v74, v8, 16, v74
  v_accvgpr_read_b32 v8, a35
  s_nop 0
  v_lshl_or_b32 v75, v8, 16, v75
  v_accvgpr_read_b32 v8, a36
  s_nop 0
  v_lshl_or_b32 v76, v8, 16, v76
  v_accvgpr_read_b32 v8, a37
  s_nop 0
  v_lshl_or_b32 v77, v8, 16, v77
  v_accvgpr_read_b32 v8, a38
  s_nop 0
  v_lshl_or_b32 v78, v8, 16, v78
  v_accvgpr_read_b32 v8, a39
  s_nop 0
  v_lshl_or_b32 v79, v8, 16, v79
  v_accvgpr_read_b32 v8, a40
  s_nop 0
  v_lshl_or_b32 v80, v8, 16, v80
  v_accvgpr_read_b32 v8, a41
  s_nop 0
  v_lshl_or_b32 v81, v8, 16, v81
  v_accvgpr_read_b32 v8, a42
  s_nop 0
  v_lshl_or_b32 v82, v8, 16, v82
  v_accvgpr_read_b32 v8, a43
  s_nop 0
  v_lshl_or_b32 v83, v8, 16, v83
  v_accvgpr_read_b32 v8, a44
  s_nop 0
  v_lshl_or_b32 v84, v8, 16, v84
  v_accvgpr_read_b32 v8, a45
  s_nop 0
  v_lshl_or_b32 v85, v8, 16, v85
  v_accvgpr_read_b32 v8, a46
  s_nop 0
  v_lshl_or_b32 v86, v8, 16, v86
  v_accvgpr_read_b32 v8, a47
  s_nop 0
  v_lshl_or_b32 v87, v8, 16, v87
  v_accvgpr_read_b32 v8, a48
  s_nop 0
  v_lshl_or_b32 v88, v8, 16, v88
  v_accvgpr_read_b32 v8, a49
  s_nop 0
  v_lshl_or_b32 v89, v8, 16, v89
  v_accvgpr_read_b32 v8, a50
  s_nop 0
  v_lshl_or_b32 v90, v8, 16, v90
  v_accvgpr_read_b32 v8, a51
  s_nop 0
  v_lshl_or_b32 v91, v8, 16, v91
  v_accvgpr_read_b32 v8, a52
  s_nop 0
  v_lshl_or_b32 v92, v8, 16, v92
  v_accvgpr_read_b32 v8, a53
  s_nop 0
  v_lshl_or_b32 v93, v8, 16, v93
  v_accvgpr_read_b32 v8, a54
  s_nop 0
  v_lshl_or_b32 v94, v8, 16, v94
  v_accvgpr_read_b32 v8, a55
  s_nop 0
  v_lshl_or_b32 v95, v8, 16, v95
  v_accvgpr_read_b32 v8, a56
  s_nop 0
  v_lshl_or_b32 v96, v8, 16, v96
  v_accvgpr_read_b32 v8, a57
  s_nop 0
  v_lshl_or_b32 v97, v8, 16, v97
  v_accvgpr_read_b32 v8, a58
  s_nop 0
  v_lshl_or_b32 v98, v8, 16, v98
  v_accvgpr_read_b32 v8, a59
  s_nop 0
  v_lshl_or_b32 v99, v8, 16, v99
  v_accvgpr_read_b32 v8, a60
  s_nop 0
  v_lshl_or_b32 v100, v8, 16, v100
  v_accvgpr_read_b32 v8, a61
  s_nop 0
  v_lshl_or_b32 v101, v8, 16, v101
  v_accvgpr_read_b32 v8, a62
  s_nop 0
  v_lshl_or_b32 v102, v8, 16, v102
  v_accvgpr_read_b32 v8, a63
  s_nop 0
  v_lshl_or_b32 v103, v8, 16, v103
  v_accvgpr_read_b32 v8, a64
  s_nop 0
  v_lshl_or_b32 v104, v8, 16, v104
  v_accvgpr_read_b32 v8, a65
  s_nop 0
  v_lshl_or_b32 v105, v8, 16, v105
  v_accvgpr_read_b32 v8, a66
  s_nop 0
  v_lshl_or_b32 v106, v8, 16, v106
  v_accvgpr_read_b32 v8, a67
  s_nop 0
  v_lshl_or_b32 v107, v8, 16, v107
  v_accvgpr_read_b32 v8, a68
  s_nop 0
  v_lshl_or_b32 v108, v8, 16, v108
  v_accvgpr_read_b32 v8, a69
  s_nop 0
  v_lshl_or_b32 v109, v8, 16, v109
  v_accvgpr_read_b32 v8, a70
  s_nop 0
  v_lshl_or_b32 v110, v8, 16, v110
  v_accvgpr_read_b32 v8, a71
  s_nop 0
  v_lshl_or_b32 v111, v8, 16, v111
  s_nop 3
  v_mfma_f32_32x32x16_bf16 v[112:127], v[40:43], v[16:19], 0
  v_mfma_f32_32x32x16_bf16 v[112:127], v[44:47], v[20:23], v[112:127]
  v_mfma_f32_32x32x16_bf16 v[112:127], v[48:51], v[24:27], v[112:127]
  v_mfma_f32_32x32x16_bf16 v[112:127], v[52:55], v[28:31], v[112:127]
  v_mfma_f32_32x32x16_bf16 v[112:127], v[56:59], v[32:35], v[112:127]
  v_mfma_f32_32x32x16_bf16 v[112:127], v[60:63], v[36:39], v[112:127]
  v_mfma_f32_32x32x16_bf16 v[128:143], v[64:67], v[16:19], 0
  v_mfma_f32_32x32x16_bf16 v[128:143], v[68:71], v[20:23], v[128:143]
  v_mfma_f32_32x32x16_bf16 v[128:143], v[72:75], v[24:27], v[128:143]
  v_mfma_f32_32x32x16_bf16 v[128:143], v[76:79], v[28:31], v[128:143]
  v_mfma_f32_32x32x16_bf16 v[128:143], v[80:83], v[32:35], v[128:143]
  v_mfma_f32_32x32x16_bf16 v[128:143], v[84:87], v[36:39], v[128:143]
  v_mfma_f32_32x32x16_bf16 v[144:159], v[88:91], v[16:19], 0
  v_mfma_f32_32x32x16_bf16 v[144:159], v[92:95], v[20:23], v[144:159]
  v_mfma_f32_32x32x16_bf16 v[144:159], v[96:99], v[24:27], v[144:159]
  v_mfma_f32_32x32x16_bf16 v[144:159], v[100:103], v[28:31], v[144:159]
  v_mfma_f32_32x32x16_bf16 v[144:159], v[104:107], v[32:35], v[144:159]
  v_mfma_f32_32x32x16_bf16 v[144:159], v[108:111], v[36:39], v[144:159]
  s_nop 15
  s_nop 15
  v_cvt_pk_bf16_f32 v160, v112, v113
  v_cvt_pk_bf16_f32 v161, v114, v115
  v_cvt_pk_bf16_f32 v162, v116, v117
  v_cvt_pk_bf16_f32 v163, v118, v119
  v_cvt_pk_bf16_f32 v164, v120, v121
  v_cvt_pk_bf16_f32 v165, v122, v123
  v_cvt_pk_bf16_f32 v166, v124, v125
  v_cvt_pk_bf16_f32 v167, v126, v127
  v_cvt_pk_bf16_f32 v168, v128, v129
  v_cvt_pk_bf16_f32 v169, v130, v131
  v_cvt_pk_bf16_f32 v170, v132, v133
  v_cvt_pk_bf16_f32 v171, v134, v135
  v_cvt_pk_bf16_f32 v172, v136, v137
  v_cvt_pk_bf16_f32 v173, v138, v139
  v_cvt_pk_bf16_f32 v174, v140, v141
  v_cvt_pk_bf16_f32 v175, v142, v143
  v_cvt_pk_bf16_f32 v176, v144, v145
  v_cvt_pk_bf16_f32 v177, v146, v147
  v_cvt_pk_bf16_f32 v178, v148, v149
  v_cvt_pk_bf16_f32 v179, v150, v151
  v_cvt_pk_bf16_f32 v180, v152, v153
  v_cvt_pk_bf16_f32 v181, v154, v155
  v_cvt_pk_bf16_f32 v182, v156, v157
  v_cvt_pk_bf16_f32 v183, v158, v159
  s_nop 3
  v_accvgpr_read_b32 v8, a72
  s_nop 0
  v_lshl_or_b32 v184, v8, 16, v184
  v_accvgpr_read_b32 v8, a73
  s_nop 0
  v_lshl_or_b32 v185, v8, 16, v185
  v_accvgpr_read_b32 v8, a74
  s_nop 0
  v_lshl_or_b32 v186, v8, 16, v186
  v_accvgpr_read_b32 v8, a75
  s_nop 0
  v_lshl_or_b32 v187, v8, 16, v187
  v_accvgpr_read_b32 v8, a76
  s_nop 0
  v_lshl_or_b32 v188, v8, 16, v188
  v_accvgpr_read_b32 v8, a77
  s_nop 0
  v_lshl_or_b32 v189, v8, 16, v189
  v_accvgpr_read_b32 v8, a78
  s_nop 0
  v_lshl_or_b32 v190, v8, 16, v190
  v_accvgpr_read_b32 v8, a79
  s_nop 0
  v_lshl_or_b32 v191, v8, 16, v191
  v_accvgpr_read_b32 v8, a80
  s_nop 0
  v_lshl_or_b32 v192, v8, 16, v192
  v_accvgpr_read_b32 v8, a81
  s_nop 0
  v_lshl_or_b32 v193, v8, 16, v193
  v_accvgpr_read_b32 v8, a82
  s_nop 0
  v_lshl_or_b32 v194, v8, 16, v194
  v_accvgpr_read_b32 v8, a83
  s_nop 0
  v_lshl_or_b32 v195, v8, 16, v195
  v_accvgpr_read_b32 v8, a84
  s_nop 0
  v_lshl_or_b32 v196, v8, 16, v196
  v_accvgpr_read_b32 v8, a85
  s_nop 0
  v_lshl_or_b32 v197, v8, 16, v197
  v_accvgpr_read_b32 v8, a86
  s_nop 0
  v_lshl_or_b32 v198, v8, 16, v198
  v_accvgpr_read_b32 v8, a87
  s_nop 0
  v_lshl_or_b32 v199, v8, 16, v199
  v_accvgpr_read_b32 v8, a88
  s_nop 0
  v_lshl_or_b32 v200, v8, 16, v200
  v_accvgpr_read_b32 v8, a89
  s_nop 0
  v_lshl_or_b32 v201, v8, 16, v201
  v_accvgpr_read_b32 v8, a90
  s_nop 0
  v_lshl_or_b32 v202, v8, 16, v202
  v_accvgpr_read_b32 v8, a91
  s_nop 0
  v_lshl_or_b32 v203, v8, 16, v203
  v_accvgpr_read_b32 v8, a92
  s_nop 0
  v_lshl_or_b32 v204, v8, 16, v204
  v_accvgpr_read_b32 v8, a93
  s_nop 0
  v_lshl_or_b32 v205, v8, 16, v205
  v_accvgpr_read_b32 v8, a94
  s_nop 0
  v_lshl_or_b32 v206, v8, 16, v206
  v_accvgpr_read_b32 v8, a95
  s_nop 0
  v_lshl_or_b32 v207, v8, 16, v207
  v_accvgpr_read_b32 v8, a96
  s_nop 0
  v_lshl_or_b32 v208, v8, 16, v208
  v_accvgpr_read_b32 v8, a97
  s_nop 0
  v_lshl_or_b32 v209, v8, 16, v209
  v_accvgpr_read_b32 v8, a98
  s_nop 0
  v_lshl_or_b32 v210, v8, 16, v210
  v_accvgpr_read_b32 v8, a99
  s_nop 0
  v_lshl_or_b32 v211, v8, 16, v211
  v_accvgpr_read_b32 v8, a100
  s_nop 0
  v_lshl_or_b32 v212, v8, 16, v212
  v_accvgpr_read_b32 v8, a101
  s_nop 0
  v_lshl_or_b32 v213, v8, 16, v213
  v_accvgpr_read_b32 v8, a102
  s_nop 0
  v_lshl_or_b32 v214, v8, 16, v214
  v_accvgpr_read_b32 v8, a103
  s_nop 0
  v_lshl_or_b32 v215, v8, 16, v215
  v_accvgpr_read_b32 v8, a104
  s_nop 0
  v_lshl_or_b32 v216, v8, 16, v216
  v_accvgpr_read_b32 v8, a105
  s_nop 0
  v_lshl_or_b32 v217, v8, 16, v217
  v_accvgpr_read_b32 v8, a106
  s_nop 0
  v_lshl_or_b32 v218, v8, 16, v218
  v_accvgpr_read_b32 v8, a107
  s_nop 0
  v_lshl_or_b32 v219, v8, 16, v219
  v_accvgpr_read_b32 v8, a108
  s_nop 0
  v_lshl_or_b32 v220, v8, 16, v220
  v_accvgpr_read_b32 v8, a109
  s_nop 0
  v_lshl_or_b32 v221, v8, 16, v221
  v_accvgpr_read_b32 v8, a110
  s_nop 0
  v_lshl_or_b32 v222, v8, 16, v222
  v_accvgpr_read_b32 v8, a111
  s_nop 0
  v_lshl_or_b32 v223, v8, 16, v223
  v_accvgpr_read_b32 v8, a112
  s_nop 0
  v_lshl_or_b32 v224, v8, 16, v224
  v_accvgpr_read_b32 v8, a113
  s_nop 0
  v_lshl_or_b32 v225, v8, 16, v225
  v_accvgpr_read_b32 v8, a114
  s_nop 0
  v_lshl_or_b32 v226, v8, 16, v226
  v_accvgpr_read_b32 v8, a115
  s_nop 0
  v_lshl_or_b32 v227, v8, 16, v227
  v_accvgpr_read_b32 v8, a116
  s_nop 0
  v_lshl_or_b32 v228, v8, 16, v228
  v_accvgpr_read_b32 v8, a117
  s_nop 0
  v_lshl_or_b32 v229, v8, 16, v229
  v_accvgpr_read_b32 v8, a118
  s_nop 0
  v_lshl_or_b32 v230, v8, 16, v230
  v_accvgpr_read_b32 v8, a119
  s_nop 0
  v_lshl_or_b32 v231, v8, 16, v231
  v_accvgpr_read_b32 v8, a120
  s_nop 0
  v_lshl_or_b32 v232, v8, 16, v232
  v_accvgpr_read_b32 v8, a121
  s_nop 0
  v_lshl_or_b32 v233, v8, 16, v233
  v_accvgpr_read_b32 v8, a122
  s_nop 0
  v_lshl_or_b32 v234, v8, 16, v234
  v_accvgpr_read_b32 v8, a123
  s_nop 0
  v_lshl_or_b32 v235, v8, 16, v235
  v_accvgpr_read_b32 v8, a124
  s_nop 0
  v_lshl_or_b32 v236, v8, 16, v236
  v_accvgpr_read_b32 v8, a125
  s_nop 0
  v_lshl_or_b32 v237, v8, 16, v237
  v_accvgpr_read_b32 v8, a126
  s_nop 0
  v_lshl_or_b32 v238, v8, 16, v238
  v_accvgpr_read_b32 v8, a127
  s_nop 0
  v_lshl_or_b32 v239, v8, 16, v239
  v_accvgpr_read_b32 v8, a128
  s_nop 0
  v_lshl_or_b32 v240, v8, 16, v240
  v_accvgpr_read_b32 v8, a129
  s_nop 0
  v_lshl_or_b32 v241, v8, 16, v241
  v_accvgpr_read_b32 v8, a130
  s_nop 0
  v_lshl_or_b32 v242, v8, 16, v242
  v_accvgpr_read_b32 v8, a131
  s_nop 0
  v_lshl_or_b32 v243, v8, 16, v243
  v_accvgpr_read_b32 v8, a132
  s_nop 0
  v_lshl_or_b32 v244, v8, 16, v244
  v_accvgpr_read_b32 v8, a133
  s_nop 0
  v_lshl_or_b32 v245, v8, 16, v245
  v_accvgpr_read_b32 v8, a134
  s_nop 0
  v_lshl_or_b32 v246, v8, 16, v246
  v_accvgpr_read_b32 v8, a135
  s_nop 0
  v_lshl_or_b32 v247, v8, 16, v247
  v_accvgpr_read_b32 v8, a136
  s_nop 0
  v_lshl_or_b32 v248, v8, 16, v248
  v_accvgpr_read_b32 v8, a137
  s_nop 0
  v_lshl_or_b32 v249, v8, 16, v249
  v_accvgpr_read_b32 v8, a138
  s_nop 0
  v_lshl_or_b32 v250, v8, 16, v250
  v_accvgpr_read_b32 v8, a139
  s_nop 0
  v_lshl_or_b32 v251, v8, 16, v251
  v_accvgpr_read_b32 v8, a140
  s_nop 0
  v_lshl_or_b32 v252, v8, 16, v252
  v_accvgpr_read_b32 v8, a141
  s_nop 0
  v_lshl_or_b32 v253, v8, 16, v253
  v_accvgpr_read_b32 v8, a142
  s_nop 0
  v_lshl_or_b32 v254, v8, 16, v254
  v_accvgpr_read_b32 v8, a143
  s_nop 0
  v_lshl_or_b32 v255, v8, 16, v255
  v_lshlrev_b32 v7, 4, v0
  s_mul_i32 s22, s26, 12288
  s_add_u32 s22, s22, 1048576
  s_add_u32 s23, s22, 6144
  s_add_u32 s25, s22, 10240
  v_mfma_f32_32x32x16_bf16 v[40:55], v[160:163], v[184:187], 0
  v_mfma_f32_32x32x16_bf16 v[40:55], v[164:167], v[188:191], v[40:55]
  v_mfma_f32_32x32x16_bf16 v[40:55], v[168:171], v[192:195], v[40:55]
  v_mfma_f32_32x32x16_bf16 v[40:55], v[172:175], v[196:199], v[40:55]
  v_mfma_f32_32x32x16_bf16 v[40:55], v[176:179], v[200:203], v[40:55]
  v_mfma_f32_32x32x16_bf16 v[40:55], v[180:183], v[204:207], v[40:55]
  s_nop 15
  s_nop 15
  v_cvt_pk_bf16_f32 v8, v40, v41
  v_cvt_pk_bf16_f32 v9, v42, v43
  v_cvt_pk_bf16_f32 v10, v44, v45
  v_cvt_pk_bf16_f32 v11, v46, v47
  buffer_store_dwordx4 v[8:11], v7, s[16:19], s23 offen offset:0
  v_cvt_pk_bf16_f32 v12, v48, v49
  v_cvt_pk_bf16_f32 v13, v50, v51
  v_cvt_pk_bf16_f32 v14, v52, v53
  v_cvt_pk_bf16_f32 v15, v54, v55
  buffer_store_dwordx4 v[12:15], v7, s[16:19], s23 offen offset:1024
  s_waitcnt vmcnt(0)
  v_mfma_f32_32x32x16_bf16 v[40:55], v[160:163], v[208:211], 0
  v_mfma_f32_32x32x16_bf16 v[40:55], v[164:167], v[212:215], v[40:55]
  v_mfma_f32_32x32x16_bf16 v[40:55], v[168:171], v[216:219], v[40:55]
  v_mfma_f32_32x32x16_bf16 v[40:55], v[172:175], v[220:223], v[40:55]
  v_mfma_f32_32x32x16_bf16 v[40:55], v[176:179], v[224:227], v[40:55]
  v_mfma_f32_32x32x16_bf16 v[40:55], v[180:183], v[228:231], v[40:55]
  s_nop 15
  s_nop 15
  v_cvt_pk_bf16_f32 v8, v40, v41
  v_cvt_pk_bf16_f32 v9, v42, v43
  v_cvt_pk_bf16_f32 v10, v44, v45
  v_cvt_pk_bf16_f32 v11, v46, v47
  buffer_store_dwordx4 v[8:11], v7, s[16:19], s23 offen offset:2048
  v_cvt_pk_bf16_f32 v12, v48, v49
  v_cvt_pk_bf16_f32 v13, v50, v51
  v_cvt_pk_bf16_f32 v14, v52, v53
  v_cvt_pk_bf16_f32 v15, v54, v55
  buffer_store_dwordx4 v[12:15], v7, s[16:19], s23 offen offset:3072
  s_waitcnt vmcnt(0)
  v_mfma_f32_32x32x16_bf16 v[40:55], v[160:163], v[232:235], 0
  v_mfma_f32_32x32x16_bf16 v[40:55], v[164:167], v[236:239], v[40:55]
  v_mfma_f32_32x32x16_bf16 v[40:55], v[168:171], v[240:243], v[40:55]
  v_mfma_f32_32x32x16_bf16 v[40:55], v[172:175], v[244:247], v[40:55]
  v_mfma_f32_32x32x16_bf16 v[40:55], v[176:179], v[248:251], v[40:55]
  v_mfma_f32_32x32x16_bf16 v[40:55], v[180:183], v[252:255], v[40:55]
  s_nop 15
  s_nop 15
  v_cvt_pk_bf16_f32 v8, v40, v41
  v_cvt_pk_bf16_f32 v9, v42, v43
  v_cvt_pk_bf16_f32 v10, v44, v45
  v_cvt_pk_bf16_f32 v11, v46, v47
  buffer_store_dwordx4 v[8:11], v7, s[16:19], s25 offen offset:0
  v_cvt_pk_bf16_f32 v12, v48, v49
  v_cvt_pk_bf16_f32 v13, v50, v51
  v_cvt_pk_bf16_f32 v14, v52, v53
  v_cvt_pk_bf16_f32 v15, v54, v55
  buffer_store_dwordx4 v[12:15], v7, s[16:19], s25 offen offset:1024
  s_waitcnt vmcnt(0)
Lproj_end:
  s_endpgm
.section .rodata,"a"
.p2align 6
.amdhsa_kernel k_proj_kernel
  .amdhsa_next_free_vgpr 400
  .amdhsa_next_free_sgpr 32
  .amdhsa_accum_offset 256
  .amdhsa_group_segment_fixed_size 0
  .amdhsa_kernarg_size 56
  .amdhsa_user_sgpr_count 2
  .amdhsa_user_sgpr_kernarg_segment_ptr 1
  .amdhsa_system_sgpr_workgroup_id_x 1
.end_amdhsa_kernel
.text

.globl k_attn_kernel
.p2align 8
.type k_attn_kernel,@function
k_attn_kernel:

  s_cmp_ge_u32 s2, 256
  s_cbranch_scc1 Lattn_exit
  s_load_dwordx2 s[4:5], s[0:1], 0
  s_load_dwordx2 s[8:9], s[0:1], 48
  s_load_dwordx2 s[12:13], s[0:1], 32
  v_lshrrev_b32 v1, 6, v0
  v_and_b32 v0, 63, v0
  s_nop 1
  v_readfirstlane_b32 s16, v1
  s_waitcnt lgkmcnt(0)
  s_mov_b32 s6, 28311552
  s_mov_b32 s7, 0x20000
  s_add_u32 s8, s8, 1048576
  s_addc_u32 s9, s9, 0
  s_mov_b32 s10, 884736
  s_mov_b32 s11, 0x20000
  s_mov_b32 s14, 28311552
  s_mov_b32 s15, 0x20000
  s_and_b32 s17, s16, 1
  s_mul_i32 s18, s2, 110592
  v_lshlrev_b32 v14, 4, v0
  s_mul_i32 s28, s16, 6144
  s_add_u32 s29, s28, 0
  s_mov_b32 m0, s29
  s_nop 0
  buffer_load_dwordx4 v14, s[8:11], s29 offen offset:0 lds
  buffer_load_dwordx4 v14, s[8:11], s29 offen offset:1024 lds
  buffer_load_dwordx4 v14, s[8:11], s29 offen offset:2048 lds
  buffer_load_dwordx4 v14, s[8:11], s29 offen offset:3072 lds
  s_add_u32 s29, s29, 4096
  s_mov_b32 m0, s29
  s_nop 0
  buffer_load_dwordx4 v14, s[8:11], s29 offen offset:0 lds
  buffer_load_dwordx4 v14, s[8:11], s29 offen offset:1024 lds
  s_add_u32 s29, s28, 24576
  s_mov_b32 m0, s29
  s_nop 0
  buffer_load_dwordx4 v14, s[8:11], s29 offen offset:0 lds
  buffer_load_dwordx4 v14, s[8:11], s29 offen offset:1024 lds
  buffer_load_dwordx4 v14, s[8:11], s29 offen offset:2048 lds
  buffer_load_dwordx4 v14, s[8:11], s29 offen offset:3072 lds
  s_add_u32 s29, s29, 4096
  s_mov_b32 m0, s29
  s_nop 0
  buffer_load_dwordx4 v14, s[8:11], s29 offen offset:0 lds
  buffer_load_dwordx4 v14, s[8:11], s29 offen offset:1024 lds
  s_add_u32 s20, s28, 49152
  s_add_u32 s21, s28, 49152
  v_and_b32 v15, 31, v0
  v_mul_u32_u24 v15, 192, v15
  v_lshrrev_b32 v1, 5, v0
  v_lshl_add_u32 v15, v1, 4, v15
  s_lshl_b32 s29, s16, 2
  s_add_u32 s29, s29, 0
  s_mul_i32 s29, s29, 6144
  s_add_u32 s29, s29, s18
  buffer_load_dwordx4 v[24:27], v15, s[4:7], s29 offen offset:0
  buffer_load_dwordx4 v[28:31], v15, s[4:7], s29 offen offset:32
  buffer_load_dwordx4 v[32:35], v15, s[4:7], s29 offen offset:64
  buffer_load_dwordx4 v[36:39], v15, s[4:7], s29 offen offset:96
  buffer_load_dwordx4 v[40:43], v15, s[4:7], s29 offen offset:128
  buffer_load_dwordx4 v[44:47], v15, s[4:7], s29 offen offset:160
  s_lshl_b32 s29, s16, 2
  s_add_u32 s29, s29, 1
  s_mul_i32 s29, s29, 6144
  s_add_u32 s29, s29, s18
  buffer_load_dwordx4 v[48:51], v15, s[4:7], s29 offen offset:0
  buffer_load_dwordx4 v[52:55], v15, s[4:7], s29 offen offset:32
  buffer_load_dwordx4 v[56:59], v15, s[4:7], s29 offen offset:64
  buffer_load_dwordx4 v[60:63], v15, s[4:7], s29 offen offset:96
  buffer_load_dwordx4 v[64:67], v15, s[4:7], s29 offen offset:128
  buffer_load_dwordx4 v[68:71], v15, s[4:7], s29 offen offset:160
  s_lshl_b32 s29, s16, 2
  s_add_u32 s29, s29, 2
  s_mul_i32 s29, s29, 6144
  s_add_u32 s29, s29, s18
  buffer_load_dwordx4 v[72:75], v15, s[4:7], s29 offen offset:0
  buffer_load_dwordx4 v[76:79], v15, s[4:7], s29 offen offset:32
  buffer_load_dwordx4 v[80:83], v15, s[4:7], s29 offen offset:64
  buffer_load_dwordx4 v[84:87], v15, s[4:7], s29 offen offset:96
  buffer_load_dwordx4 v[88:91], v15, s[4:7], s29 offen offset:128
  buffer_load_dwordx4 v[92:95], v15, s[4:7], s29 offen offset:160
  s_lshl_b32 s29, s16, 2
  s_add_u32 s29, s29, 3
  s_mul_i32 s29, s29, 6144
  s_add_u32 s29, s29, s18
  buffer_load_dwordx4 v[96:99], v15, s[4:7], s29 offen offset:0
  buffer_load_dwordx4 v[100:103], v15, s[4:7], s29 offen offset:32
  buffer_load_dwordx4 v[104:107], v15, s[4:7], s29 offen offset:64
  buffer_load_dwordx4 v[108:111], v15, s[4:7], s29 offen offset:96
  buffer_load_dwordx4 v[112:115], v15, s[4:7], s29 offen offset:128
  buffer_load_dwordx4 v[116:119], v15, s[4:7], s29 offen offset:160
  s_lshr_b32 s29, s16, 1
  s_add_u32 s29, s29, 16
  s_mul_i32 s29, s29, 6144
  s_add_u32 s29, s29, s18
  buffer_load_dwordx4 v[120:123], v15, s[4:7], s29 offen offset:0
  buffer_load_dwordx4 v[124:127], v15, s[4:7], s29 offen offset:32
  buffer_load_dwordx4 v[128:131], v15, s[4:7], s29 offen offset:64
  buffer_load_dwordx4 v[132:135], v15, s[4:7], s29 offen offset:96
  buffer_load_dwordx4 v[136:139], v15, s[4:7], s29 offen offset:128
  buffer_load_dwordx4 v[140:143], v15, s[4:7], s29 offen offset:160
  v_accvgpr_write_b32 a0, 0
  v_accvgpr_write_b32 a1, 0
  v_accvgpr_write_b32 a2, 0
  v_accvgpr_write_b32 a3, 0
  v_accvgpr_write_b32 a4, 0
  v_accvgpr_write_b32 a5, 0
  v_accvgpr_write_b32 a6, 0
  v_accvgpr_write_b32 a7, 0
  v_accvgpr_write_b32 a8, 0
  v_accvgpr_write_b32 a9, 0
  v_accvgpr_write_b32 a10, 0
  v_accvgpr_write_b32 a11, 0
  v_accvgpr_write_b32 a12, 0
  v_accvgpr_write_b32 a13, 0
  v_accvgpr_write_b32 a14, 0
  v_accvgpr_write_b32 a15, 0
  v_accvgpr_write_b32 a16, 0
  v_accvgpr_write_b32 a17, 0
  v_accvgpr_write_b32 a18, 0
  v_accvgpr_write_b32 a19, 0
  v_accvgpr_write_b32 a20, 0
  v_accvgpr_write_b32 a21, 0
  v_accvgpr_write_b32 a22, 0
  v_accvgpr_write_b32 a23, 0
  v_accvgpr_write_b32 a24, 0
  v_accvgpr_write_b32 a25, 0
  v_accvgpr_write_b32 a26, 0
  v_accvgpr_write_b32 a27, 0
  v_accvgpr_write_b32 a28, 0
  v_accvgpr_write_b32 a29, 0
  v_accvgpr_write_b32 a30, 0
  v_accvgpr_write_b32 a31, 0
  v_accvgpr_write_b32 a32, 0
  v_accvgpr_write_b32 a33, 0
  v_accvgpr_write_b32 a34, 0
  v_accvgpr_write_b32 a35, 0
  v_accvgpr_write_b32 a36, 0
  v_accvgpr_write_b32 a37, 0
  v_accvgpr_write_b32 a38, 0
  v_accvgpr_write_b32 a39, 0
  v_accvgpr_write_b32 a40, 0
  v_accvgpr_write_b32 a41, 0
  v_accvgpr_write_b32 a42, 0
  v_accvgpr_write_b32 a43, 0
  v_accvgpr_write_b32 a44, 0
  v_accvgpr_write_b32 a45, 0
  v_accvgpr_write_b32 a46, 0
  v_accvgpr_write_b32 a47, 0
  v_accvgpr_write_b32 a48, 0
  v_accvgpr_write_b32 a49, 0
  v_accvgpr_write_b32 a50, 0
  v_accvgpr_write_b32 a51, 0
  v_accvgpr_write_b32 a52, 0
  v_accvgpr_write_b32 a53, 0
  v_accvgpr_write_b32 a54, 0
  v_accvgpr_write_b32 a55, 0
  v_accvgpr_write_b32 a56, 0
  v_accvgpr_write_b32 a57, 0
  v_accvgpr_write_b32 a58, 0
  v_accvgpr_write_b32 a59, 0
  v_accvgpr_write_b32 a60, 0
  v_accvgpr_write_b32 a61, 0
  v_accvgpr_write_b32 a62, 0
  v_accvgpr_write_b32 a63, 0
  v_accvgpr_write_b32 a64, 0
  v_accvgpr_write_b32 a65, 0
  v_accvgpr_write_b32 a66, 0
  v_accvgpr_write_b32 a67, 0
  v_accvgpr_write_b32 a68, 0
  v_accvgpr_write_b32 a69, 0
  v_accvgpr_write_b32 a70, 0
  v_accvgpr_write_b32 a71, 0
  v_accvgpr_write_b32 a72, 0
  v_accvgpr_write_b32 a73, 0
  v_accvgpr_write_b32 a74, 0
  v_accvgpr_write_b32 a75, 0
  v_accvgpr_write_b32 a76, 0
  v_accvgpr_write_b32 a77, 0
  v_accvgpr_write_b32 a78, 0
  v_accvgpr_write_b32 a79, 0
  v_accvgpr_write_b32 a80, 0
  v_accvgpr_write_b32 a81, 0
  v_accvgpr_write_b32 a82, 0
  v_accvgpr_write_b32 a83, 0
  v_accvgpr_write_b32 a84, 0
  v_accvgpr_write_b32 a85, 0
  v_accvgpr_write_b32 a86, 0
  v_accvgpr_write_b32 a87, 0
  v_accvgpr_write_b32 a88, 0
  v_accvgpr_write_b32 a89, 0
  v_accvgpr_write_b32 a90, 0
  v_accvgpr_write_b32 a91, 0
  v_accvgpr_write_b32 a92, 0
  v_accvgpr_write_b32 a93, 0
  v_accvgpr_write_b32 a94, 0
  v_accvgpr_write_b32 a95, 0
  v_accvgpr_write_b32 a96, 0
  v_accvgpr_write_b32 a97, 0
  v_accvgpr_write_b32 a98, 0
  v_accvgpr_write_b32 a99, 0
  v_accvgpr_write_b32 a100, 0
  v_accvgpr_write_b32 a101, 0
  v_accvgpr_write_b32 a102, 0
  v_accvgpr_write_b32 a103, 0
  v_accvgpr_write_b32 a104, 0
  v_accvgpr_write_b32 a105, 0
  v_accvgpr_write_b32 a106, 0
  v_accvgpr_write_b32 a107, 0
  v_accvgpr_write_b32 a108, 0
  v_accvgpr_write_b32 a109, 0
  v_accvgpr_write_b32 a110, 0
  v_accvgpr_write_b32 a111, 0
  v_accvgpr_write_b32 a112, 0
  v_accvgpr_write_b32 a113, 0
  v_accvgpr_write_b32 a114, 0
  v_accvgpr_write_b32 a115, 0
  v_accvgpr_write_b32 a116, 0
  v_accvgpr_write_b32 a117, 0
  v_accvgpr_write_b32 a118, 0
  v_accvgpr_write_b32 a119, 0
  v_accvgpr_write_b32 a120, 0
  v_accvgpr_write_b32 a121, 0
  v_accvgpr_write_b32 a122, 0
  v_accvgpr_write_b32 a123, 0
  v_accvgpr_write_b32 a124, 0
  v_accvgpr_write_b32 a125, 0
  v_accvgpr_write_b32 a126, 0
  v_accvgpr_write_b32 a127, 0
  v_accvgpr_write_b32 a128, 0
  v_accvgpr_write_b32 a129, 0
  v_accvgpr_write_b32 a130, 0
  v_accvgpr_write_b32 a131, 0
  v_accvgpr_write_b32 a132, 0
  v_accvgpr_write_b32 a133, 0
  v_accvgpr_write_b32 a134, 0
  v_accvgpr_write_b32 a135, 0
  v_accvgpr_write_b32 a136, 0
  v_accvgpr_write_b32 a137, 0
  v_accvgpr_write_b32 a138, 0
  v_accvgpr_write_b32 a139, 0
  v_accvgpr_write_b32 a140, 0
  v_accvgpr_write_b32 a141, 0
  v_accvgpr_write_b32 a142, 0
  v_accvgpr_write_b32 a143, 0
  v_accvgpr_write_b32 a144, 0
  v_accvgpr_write_b32 a145, 0
  v_accvgpr_write_b32 a146, 0
  v_accvgpr_write_b32 a147, 0
  v_accvgpr_write_b32 a148, 0
  v_accvgpr_write_b32 a149, 0
  v_accvgpr_write_b32 a150, 0
  v_accvgpr_write_b32 a151, 0
  v_accvgpr_write_b32 a152, 0
  v_accvgpr_write_b32 a153, 0
  v_accvgpr_write_b32 a154, 0
  v_accvgpr_write_b32 a155, 0
  v_accvgpr_write_b32 a156, 0
  v_accvgpr_write_b32 a157, 0
  v_accvgpr_write_b32 a158, 0
  v_accvgpr_write_b32 a159, 0
  v_accvgpr_write_b32 a160, 0
  v_accvgpr_write_b32 a161, 0
  v_accvgpr_write_b32 a162, 0
  v_accvgpr_write_b32 a163, 0
  v_accvgpr_write_b32 a164, 0
  v_accvgpr_write_b32 a165, 0
  v_accvgpr_write_b32 a166, 0
  v_accvgpr_write_b32 a167, 0
  v_accvgpr_write_b32 a168, 0
  v_accvgpr_write_b32 a169, 0
  v_accvgpr_write_b32 a170, 0
  v_accvgpr_write_b32 a171, 0
  v_accvgpr_write_b32 a172, 0
  v_accvgpr_write_b32 a173, 0
  v_accvgpr_write_b32 a174, 0
  v_accvgpr_write_b32 a175, 0
  v_accvgpr_write_b32 a176, 0
  v_accvgpr_write_b32 a177, 0
  v_accvgpr_write_b32 a178, 0
  v_accvgpr_write_b32 a179, 0
  v_accvgpr_write_b32 a180, 0
  v_accvgpr_write_b32 a181, 0
  v_accvgpr_write_b32 a182, 0
  v_accvgpr_write_b32 a183, 0
  v_accvgpr_write_b32 a184, 0
  v_accvgpr_write_b32 a185, 0
  v_accvgpr_write_b32 a186, 0
  v_accvgpr_write_b32 a187, 0
  v_accvgpr_write_b32 a188, 0
  v_accvgpr_write_b32 a189, 0
  v_accvgpr_write_b32 a190, 0
  v_accvgpr_write_b32 a191, 0
  v_accvgpr_write_b32 a192, 0
  v_accvgpr_write_b32 a193, 0
  v_accvgpr_write_b32 a194, 0
  v_accvgpr_write_b32 a195, 0
  v_accvgpr_write_b32 a196, 0
  v_accvgpr_write_b32 a197, 0
  v_accvgpr_write_b32 a198, 0
  v_accvgpr_write_b32 a199, 0
  v_accvgpr_write_b32 a200, 0
  v_accvgpr_write_b32 a201, 0
  v_accvgpr_write_b32 a202, 0
  v_accvgpr_write_b32 a203, 0
  v_accvgpr_write_b32 a204, 0
  v_accvgpr_write_b32 a205, 0
  v_accvgpr_write_b32 a206, 0
  v_accvgpr_write_b32 a207, 0
  v_accvgpr_write_b32 a208, 0
  v_accvgpr_write_b32 a209, 0
  v_accvgpr_write_b32 a210, 0
  v_accvgpr_write_b32 a211, 0
  v_accvgpr_write_b32 a212, 0
  v_accvgpr_write_b32 a213, 0
  v_accvgpr_write_b32 a214, 0
  v_accvgpr_write_b32 a215, 0
  v_accvgpr_write_b32 a216, 0
  v_accvgpr_write_b32 a217, 0
  v_accvgpr_write_b32 a218, 0
  v_accvgpr_write_b32 a219, 0
  v_accvgpr_write_b32 a220, 0
  v_accvgpr_write_b32 a221, 0
  v_accvgpr_write_b32 a222, 0
  v_accvgpr_write_b32 a223, 0
  v_accvgpr_write_b32 a224, 0
  v_accvgpr_write_b32 a225, 0
  v_accvgpr_write_b32 a226, 0
  v_accvgpr_write_b32 a227, 0
  v_accvgpr_write_b32 a228, 0
  v_accvgpr_write_b32 a229, 0
  v_accvgpr_write_b32 a230, 0
  v_accvgpr_write_b32 a231, 0
  v_accvgpr_write_b32 a232, 0
  v_accvgpr_write_b32 a233, 0
  v_accvgpr_write_b32 a234, 0
  v_accvgpr_write_b32 a235, 0
  v_accvgpr_write_b32 a236, 0
  v_accvgpr_write_b32 a237, 0
  v_accvgpr_write_b32 a238, 0
  v_accvgpr_write_b32 a239, 0
  v_mov_b32 v176, 0
  v_mov_b32 v177, 0
  v_mov_b32 v178, 0
  v_mov_b32 v179, 0
  v_mov_b32 v180, 0
  v_mov_b32 v181, 0
  v_mov_b32 v182, 0
  v_mov_b32 v183, 0
  v_mov_b32 v184, 0
  v_mov_b32 v185, 0
  v_mov_b32 v186, 0
  v_mov_b32 v187, 0
  v_mov_b32 v188, 0
  v_mov_b32 v189, 0
  v_mov_b32 v190, 0
  v_mov_b32 v191, 0
  v_mov_b32 v216, 0
  v_mov_b32 v217, 0
  v_mov_b32 v218, 0
  v_mov_b32 v219, 0
  v_mov_b32 v220, 0
  v_mov_b32 v221, 0
  v_mov_b32 v222, 0
  v_mov_b32 v223, 0
  v_mov_b32 v224, 0
  v_mov_b32 v225, 0
  v_mov_b32 v226, 0
  v_mov_b32 v227, 0
  v_mov_b32 v228, 0
  v_mov_b32 v229, 0
  v_mov_b32 v230, 0
  v_mov_b32 v231, 0
  v_mov_b32 v232, 0
  v_mov_b32 v233, 0
  v_mov_b32 v234, 0
  v_mov_b32 v235, 0
  v_mov_b32 v236, 0
  v_mov_b32 v237, 0
  v_mov_b32 v238, 0
  v_mov_b32 v239, 0
  v_mov_b32 v240, 0
  v_mov_b32 v241, 0
  v_mov_b32 v242, 0
  v_mov_b32 v243, 0
  v_mov_b32 v244, 0
  v_mov_b32 v245, 0
  v_mov_b32 v246, 0
  v_mov_b32 v247, 0
  v_mov_b32 v248, 0
  v_mov_b32 v249, 0
  v_mov_b32 v250, 0
  v_mov_b32 v251, 0
  v_mov_b32 v252, 0
  v_mov_b32 v253, 0
  v_mov_b32 v254, 0
  v_mov_b32 v255, 0
  v_mov_b32 v4, 0
  v_mov_b32 v5, 0
  v_mov_b32 v6, 0
  v_mov_b32 v7, 0
  v_mov_b32 v8, 0
  v_mov_b32 v9, 0
  v_mov_b32 v10, 0
  v_mov_b32 v11, 0
  v_mov_b32 v12, 0
  v_mov_b32 v13, 0
  s_mul_i32 s29, s17, 12288
  v_add_u32 v1, s29, v14
  s_sub_u32 s29, 12288, s29
  v_add_u32 v2, s29, v14
  s_mul_i32 s29, s16, 5120
  s_add_u32 s29, s29, 73728
  v_add_u32 v3, s29, v14
  ds_write_b128 v3, v[240:243] offset:0
  ds_write_b128 v3, v[240:243] offset:1024
  ds_write_b128 v3, v[240:243] offset:2048
  ds_write_b128 v3, v[240:243] offset:3072
  ds_write_b128 v3, v[240:243] offset:4096
  s_mov_b32 s24, 0x5f800000
  s_mov_b32 s25, 0xbf800000
  s_mov_b32 s26, 0xff800000
  s_mov_b32 s27, 0
  s_waitcnt vmcnt(0) lgkmcnt(0)
  s_barrier
  ds_read_b128 v[192:195], v1 offset:0
  ds_read_b128 v[196:199], v1 offset:1024
  ds_read_b128 v[200:203], v1 offset:2048
  ds_read_b128 v[204:207], v1 offset:3072
  ds_read_b128 v[208:211], v1 offset:4096
  ds_read_b128 v[212:215], v1 offset:5120
  s_waitcnt lgkmcnt(0)
  v_mfma_f32_32x32x16_bf16 v[144:159], v[192:195], v[24:27], v[240:255]
  v_mfma_f32_32x32x16_bf16 v[144:159], v[196:199], v[28:31], v[144:159]
  v_mfma_f32_32x32x16_bf16 v[144:159], v[200:203], v[32:35], v[144:159]
  v_mfma_f32_32x32x16_bf16 v[144:159], v[204:207], v[36:39], v[144:159]
  v_mfma_f32_32x32x16_bf16 v[144:159], v[208:211], v[40:43], v[144:159]
  v_mfma_f32_32x32x16_bf16 v[144:159], v[212:215], v[44:47], v[144:159]
  s_nop 15
  s_nop 15
  s_mov_b32 s28, 0
  s_waitcnt lgkmcnt(0)
Lloop:
  s_waitcnt lgkmcnt(0)
  v_mfma_f32_32x32x16_bf16 v[160:175], v[192:195], v[48:51], v[240:255]
  v_exp_f32 v16, v144
  v_exp_f32 v17, v145
  v_exp_f32 v18, v146
  v_mfma_f32_32x32x16_bf16 a[144:159], v[216:219], v[184:187], a[144:159]
  ds_read_b128 v[216:219], v1 offset:6144
  v_exp_f32 v19, v147
  v_add_f32 v0, v16, v17
  v_cvt_pk_bf16_f32 v176, v16, v17
  v_mfma_f32_32x32x16_bf16 v[160:175], v[196:199], v[52:55], v[160:175]
  v_exp_f32 v16, v148
  v_exp_f32 v17, v149
  v_add_f32 v0, v0, v18
  v_add_f32 v0, v0, v19
  v_mfma_f32_32x32x16_bf16 a[144:159], v[220:223], v[188:191], a[144:159]
  ds_read_b128 v[220:223], v1 offset:7168
  v_cvt_pk_bf16_f32 v177, v18, v19
  v_exp_f32 v18, v150
  v_exp_f32 v19, v151
  v_mfma_f32_32x32x16_bf16 v[160:175], v[200:203], v[56:59], v[160:175]
  ds_read_b128 v[240:243], v3 offset:2048
  v_add_f32 v0, v0, v16
  v_add_f32 v0, v0, v17
  v_cvt_pk_bf16_f32 v178, v16, v17
  v_mfma_f32_32x32x16_bf16 a[160:175], v[224:227], v[184:187], a[160:175]
  ds_read_b128 v[224:227], v1 offset:8192
  ds_read_b128 v[244:247], v3 offset:2048
  v_exp_f32 v16, v152
  v_exp_f32 v17, v153
  v_mfma_f32_32x32x16_bf16 v[160:175], v[204:207], v[60:63], v[160:175]
  ds_read_b128 v[248:251], v3 offset:2048
  v_add_f32 v0, v0, v18
  v_add_f32 v0, v0, v19
  v_cvt_pk_bf16_f32 v179, v18, v19
  v_exp_f32 v18, v154
  v_mfma_f32_32x32x16_bf16 a[160:175], v[228:231], v[188:191], a[160:175]
  ds_read_b128 v[228:231], v1 offset:9216
  ds_read_b128 v[252:255], v3 offset:2048
  v_exp_f32 v19, v155
  v_add_f32 v0, v0, v16
  v_add_f32 v0, v0, v17
  v_mfma_f32_32x32x16_bf16 v[160:175], v[208:211], v[64:67], v[160:175]
  v_cvt_pk_bf16_f32 v180, v16, v17
  v_exp_f32 v16, v156
  v_exp_f32 v17, v157
  v_mfma_f32_32x32x16_bf16 a[176:191], v[232:235], v[184:187], a[176:191]
  ds_read_b128 v[232:235], v1 offset:10240
  v_add_f32 v0, v0, v18
  v_add_f32 v0, v0, v19
  v_cvt_pk_bf16_f32 v181, v18, v19
  v_exp_f32 v18, v158
  v_mfma_f32_32x32x16_bf16 v[160:175], v[212:215], v[68:71], v[160:175]
  v_exp_f32 v19, v159
  v_add_f32 v0, v0, v16
  v_add_f32 v0, v0, v17
  v_cvt_pk_bf16_f32 v182, v16, v17
  v_mfma_f32_32x32x16_bf16 a[176:191], v[236:239], v[188:191], a[176:191]
  ds_read_b128 v[236:239], v1 offset:11264
  v_add_f32 v0, v0, v18
  v_add_f32 v0, v0, v19
  v_cvt_pk_bf16_f32 v183, v18, v19
  v_cmp_lt_f32 vcc, s25, v0
  s_cbranch_vccnz Lslow_0
Lret_0:
  v_add_f32 v4, v4, v0
  s_waitcnt lgkmcnt(2)
  v_mfma_f32_32x32x16_bf16 v[144:159], v[192:195], v[72:75], v[240:255]
  v_exp_f32 v16, v160
  v_exp_f32 v17, v161
  v_exp_f32 v18, v162
  v_mfma_f32_32x32x16_bf16 a[0:15], v[216:219], v[176:179], a[0:15]
  v_exp_f32 v19, v163
  v_add_f32 v0, v16, v17
  v_cvt_pk_bf16_f32 v184, v16, v17
  v_mfma_f32_32x32x16_bf16 v[144:159], v[196:199], v[76:79], v[144:159]
  v_exp_f32 v16, v164
  v_exp_f32 v17, v165
  v_add_f32 v0, v0, v18
  v_mfma_f32_32x32x16_bf16 a[0:15], v[220:223], v[180:183], a[0:15]
  v_add_f32 v0, v0, v19
  v_cvt_pk_bf16_f32 v185, v18, v19
  v_exp_f32 v18, v166
  v_exp_f32 v19, v167
  v_mfma_f32_32x32x16_bf16 v[144:159], v[200:203], v[80:83], v[144:159]
  ds_read_b128 v[240:243], v3 offset:3072
  v_add_f32 v0, v0, v16
  v_add_f32 v0, v0, v17
  v_cvt_pk_bf16_f32 v186, v16, v17
  v_mfma_f32_32x32x16_bf16 a[16:31], v[224:227], v[176:179], a[16:31]
  ds_read_b128 v[244:247], v3 offset:3072
  v_exp_f32 v16, v168
  v_exp_f32 v17, v169
  v_mfma_f32_32x32x16_bf16 v[144:159], v[204:207], v[84:87], v[144:159]
  ds_read_b128 v[248:251], v3 offset:3072
  v_add_f32 v0, v0, v18
  v_add_f32 v0, v0, v19
  v_cvt_pk_bf16_f32 v187, v18, v19
  v_exp_f32 v18, v170
  v_mfma_f32_32x32x16_bf16 a[16:31], v[228:231], v[180:183], a[16:31]
  ds_read_b128 v[252:255], v3 offset:3072
  v_exp_f32 v19, v171
  v_add_f32 v0, v0, v16
  v_add_f32 v0, v0, v17
  v_mfma_f32_32x32x16_bf16 v[144:159], v[208:211], v[88:91], v[144:159]
  v_cvt_pk_bf16_f32 v188, v16, v17
  v_exp_f32 v16, v172
  v_exp_f32 v17, v173
  s_waitcnt lgkmcnt(5)
  v_mfma_f32_32x32x16_bf16 a[32:47], v[232:235], v[176:179], a[32:47]
  v_add_f32 v0, v0, v18
  v_add_f32 v0, v0, v19
  v_cvt_pk_bf16_f32 v189, v18, v19
  v_exp_f32 v18, v174
  v_mfma_f32_32x32x16_bf16 v[144:159], v[212:215], v[92:95], v[144:159]
  v_exp_f32 v19, v175
  v_add_f32 v0, v0, v16
  v_add_f32 v0, v0, v17
  v_cvt_pk_bf16_f32 v190, v16, v17
  s_waitcnt lgkmcnt(4)
  v_mfma_f32_32x32x16_bf16 a[32:47], v[236:239], v[180:183], a[32:47]
  v_add_f32 v0, v0, v18
  v_add_f32 v0, v0, v19
  v_cvt_pk_bf16_f32 v191, v18, v19
  v_cmp_lt_f32 vcc, s25, v0
  s_cbranch_vccnz Lslow_1
Lret_1:
  v_add_f32 v5, v5, v0
  s_waitcnt lgkmcnt(0)
  v_mfma_f32_32x32x16_bf16 v[160:175], v[192:195], v[96:99], v[240:255]
  v_exp_f32 v16, v144
  v_exp_f32 v17, v145
  v_exp_f32 v18, v146
  v_mfma_f32_32x32x16_bf16 a[48:63], v[216:219], v[184:187], a[48:63]
  v_exp_f32 v19, v147
  v_add_f32 v0, v16, v17
  v_cvt_pk_bf16_f32 v176, v16, v17
  v_mfma_f32_32x32x16_bf16 v[160:175], v[196:199], v[100:103], v[160:175]
  v_exp_f32 v16, v148
  v_exp_f32 v17, v149
  v_add_f32 v0, v0, v18
  v_mfma_f32_32x32x16_bf16 a[48:63], v[220:223], v[188:191], a[48:63]
  v_add_f32 v0, v0, v19
  v_cvt_pk_bf16_f32 v177, v18, v19
  v_exp_f32 v18, v150
  v_exp_f32 v19, v151
  v_mfma_f32_32x32x16_bf16 v[160:175], v[200:203], v[104:107], v[160:175]
  ds_read_b128 v[240:243], v3 offset:4096
  v_add_f32 v0, v0, v16
  v_add_f32 v0, v0, v17
  v_cvt_pk_bf16_f32 v178, v16, v17
  v_mfma_f32_32x32x16_bf16 a[64:79], v[224:227], v[184:187], a[64:79]
  ds_read_b128 v[244:247], v3 offset:4096
  v_exp_f32 v16, v152
  v_exp_f32 v17, v153
  v_mfma_f32_32x32x16_bf16 v[160:175], v[204:207], v[108:111], v[160:175]
  ds_read_b128 v[248:251], v3 offset:4096
  v_add_f32 v0, v0, v18
  v_add_f32 v0, v0, v19
  v_cvt_pk_bf16_f32 v179, v18, v19
  v_exp_f32 v18, v154
  v_mfma_f32_32x32x16_bf16 a[64:79], v[228:231], v[188:191], a[64:79]
  ds_read_b128 v[252:255], v3 offset:4096
  v_exp_f32 v19, v155
  v_add_f32 v0, v0, v16
  v_add_f32 v0, v0, v17
  v_mfma_f32_32x32x16_bf16 v[160:175], v[208:211], v[112:115], v[160:175]
  v_cvt_pk_bf16_f32 v180, v16, v17
  v_exp_f32 v16, v156
  v_exp_f32 v17, v157
  v_mfma_f32_32x32x16_bf16 a[80:95], v[232:235], v[184:187], a[80:95]
  v_add_f32 v0, v0, v18
  v_add_f32 v0, v0, v19
  v_cvt_pk_bf16_f32 v181, v18, v19
  v_exp_f32 v18, v158
  v_mfma_f32_32x32x16_bf16 v[160:175], v[212:215], v[116:119], v[160:175]
  v_exp_f32 v19, v159
  v_add_f32 v0, v0, v16
  v_add_f32 v0, v0, v17
  v_cvt_pk_bf16_f32 v182, v16, v17
  v_mfma_f32_32x32x16_bf16 a[80:95], v[236:239], v[188:191], a[80:95]
  v_add_f32 v0, v0, v18
  v_add_f32 v0, v0, v19
  v_cvt_pk_bf16_f32 v183, v18, v19
  v_cmp_lt_f32 vcc, s25, v0
  s_cbranch_vccnz Lslow_2
Lret_2:
  v_add_f32 v6, v6, v0
  s_waitcnt lgkmcnt(0)
  v_mfma_f32_32x32x16_bf16 v[144:159], v[192:195], v[120:123], v[240:255]
  ds_read_b128 v[192:195], v2 offset:0
  v_exp_f32 v16, v160
  v_exp_f32 v17, v161
  v_mfma_f32_32x32x16_bf16 a[96:111], v[216:219], v[176:179], a[96:111]
  v_exp_f32 v18, v162
  v_exp_f32 v19, v163
  v_add_f32 v0, v16, v17
  v_cvt_pk_bf16_f32 v184, v16, v17
  v_mfma_f32_32x32x16_bf16 v[144:159], v[196:199], v[124:127], v[144:159]
  ds_read_b128 v[196:199], v2 offset:1024
  v_exp_f32 v16, v164
  v_exp_f32 v17, v165
  v_add_f32 v0, v0, v18
  v_mfma_f32_32x32x16_bf16 a[96:111], v[220:223], v[180:183], a[96:111]
  v_add_f32 v0, v0, v19
  v_cvt_pk_bf16_f32 v185, v18, v19
  v_exp_f32 v18, v166
  v_exp_f32 v19, v167
  v_mfma_f32_32x32x16_bf16 v[144:159], v[200:203], v[128:131], v[144:159]
  ds_read_b128 v[200:203], v2 offset:2048
  ds_read_b128 v[240:243], v3 offset:0
  v_add_f32 v0, v0, v16
  v_add_f32 v0, v0, v17
  v_cvt_pk_bf16_f32 v186, v16, v17
  v_mfma_f32_32x32x16_bf16 a[112:127], v[224:227], v[176:179], a[112:127]
  ds_read_b128 v[244:247], v3 offset:0
  v_exp_f32 v16, v168
  v_exp_f32 v17, v169
  v_mfma_f32_32x32x16_bf16 v[144:159], v[204:207], v[132:135], v[144:159]
  ds_read_b128 v[204:207], v2 offset:3072
  ds_read_b128 v[248:251], v3 offset:0
  v_add_f32 v0, v0, v18
  v_add_f32 v0, v0, v19
  v_cvt_pk_bf16_f32 v187, v18, v19
  v_exp_f32 v18, v170
  v_mfma_f32_32x32x16_bf16 a[112:127], v[228:231], v[180:183], a[112:127]
  ds_read_b128 v[252:255], v3 offset:0
  v_exp_f32 v19, v171
  v_add_f32 v0, v0, v16
  v_add_f32 v0, v0, v17
  v_mfma_f32_32x32x16_bf16 v[144:159], v[208:211], v[136:139], v[144:159]
  ds_read_b128 v[208:211], v2 offset:4096
  v_cvt_pk_bf16_f32 v188, v16, v17
  v_exp_f32 v16, v172
  v_exp_f32 v17, v173
  v_mfma_f32_32x32x16_bf16 a[128:143], v[232:235], v[176:179], a[128:143]
  v_add_f32 v0, v0, v18
  v_add_f32 v0, v0, v19
  v_cvt_pk_bf16_f32 v189, v18, v19
  v_exp_f32 v18, v174
  v_mfma_f32_32x32x16_bf16 v[144:159], v[212:215], v[140:143], v[144:159]
  ds_read_b128 v[212:215], v2 offset:5120
  v_exp_f32 v19, v175
  v_add_f32 v0, v0, v16
  v_add_f32 v0, v0, v17
  v_mfma_f32_32x32x16_bf16 a[128:143], v[236:239], v[180:183], a[128:143]
  v_cvt_pk_bf16_f32 v190, v16, v17
  v_add_f32 v0, v0, v18
  v_add_f32 v0, v0, v19
  v_cvt_pk_bf16_f32 v191, v18, v19
  v_cmp_lt_f32 vcc, s25, v0
  s_cbranch_vccnz Lslow_3
Lret_3:
  v_add_f32 v7, v7, v0
  s_waitcnt lgkmcnt(2)
  v_mfma_f32_32x32x16_bf16 v[160:175], v[192:195], v[24:27], v[240:255]
  v_exp_f32 v16, v144
  v_exp_f32 v17, v145
  v_exp_f32 v18, v146
  v_mfma_f32_32x32x16_bf16 a[144:159], v[216:219], v[184:187], a[144:159]
  v_exp_f32 v19, v147
  v_add_f32 v0, v16, v17
  v_cvt_pk_bf16_f32 v176, v16, v17
  v_mfma_f32_32x32x16_bf16 v[160:175], v[196:199], v[28:31], v[160:175]
  v_exp_f32 v16, v148
  v_exp_f32 v17, v149
  v_add_f32 v0, v0, v18
  v_mfma_f32_32x32x16_bf16 a[144:159], v[220:223], v[188:191], a[144:159]
  v_add_f32 v0, v0, v19
  v_cvt_pk_bf16_f32 v177, v18, v19
  v_exp_f32 v18, v150
  v_exp_f32 v19, v151
  v_mfma_f32_32x32x16_bf16 v[160:175], v[200:203], v[32:35], v[160:175]
  ds_read_b128 v[240:243], v3 offset:1024
  v_add_f32 v0, v0, v16
  v_add_f32 v0, v0, v17
  v_cvt_pk_bf16_f32 v178, v16, v17
  v_mfma_f32_32x32x16_bf16 a[160:175], v[224:227], v[184:187], a[160:175]
  ds_read_b128 v[244:247], v3 offset:1024
  v_exp_f32 v16, v152
  v_exp_f32 v17, v153
  v_mfma_f32_32x32x16_bf16 v[160:175], v[204:207], v[36:39], v[160:175]
  ds_read_b128 v[248:251], v3 offset:1024
  v_add_f32 v0, v0, v18
  v_add_f32 v0, v0, v19
  v_cvt_pk_bf16_f32 v179, v18, v19
  v_exp_f32 v18, v154
  v_mfma_f32_32x32x16_bf16 a[160:175], v[228:231], v[188:191], a[160:175]
  ds_read_b128 v[252:255], v3 offset:1024
  v_exp_f32 v19, v155
  v_add_f32 v0, v0, v16
  v_add_f32 v0, v0, v17
  s_waitcnt lgkmcnt(5)
  v_mfma_f32_32x32x16_bf16 v[160:175], v[208:211], v[40:43], v[160:175]
  v_cvt_pk_bf16_f32 v180, v16, v17
  v_exp_f32 v16, v156
  v_exp_f32 v17, v157
  v_mfma_f32_32x32x16_bf16 a[176:191], v[232:235], v[184:187], a[176:191]
  v_add_f32 v0, v0, v18
  v_add_f32 v0, v0, v19
  v_cvt_pk_bf16_f32 v181, v18, v19
  v_exp_f32 v18, v158
  s_waitcnt lgkmcnt(4)
  v_mfma_f32_32x32x16_bf16 v[160:175], v[212:215], v[44:47], v[160:175]
  v_exp_f32 v19, v159
  v_add_f32 v0, v0, v16
  v_add_f32 v0, v0, v17
  v_cvt_pk_bf16_f32 v182, v16, v17
  v_mfma_f32_32x32x16_bf16 a[176:191], v[236:239], v[188:191], a[176:191]
  v_add_f32 v0, v0, v18
  v_add_f32 v0, v0, v19
  v_cvt_pk_bf16_f32 v183, v18, v19
  v_cmp_lt_f32 vcc, s25, v0
  s_cbranch_vccnz Lslow_4
Lret_4:
  v_add_f32 v8, v8, v0
  s_mov_b32 s26, 0
  s_mov_b32 s25, s24
  s_waitcnt lgkmcnt(0)
  v_mfma_f32_32x32x16_bf16 v[144:159], v[192:195], v[48:51], v[240:255]
  v_exp_f32 v16, v160
  v_exp_f32 v17, v161
  v_exp_f32 v18, v162
  v_mfma_f32_32x32x16_bf16 a[192:207], v[216:219], v[176:179], a[192:207]
  ds_read_b128 v[216:219], v2 offset:6144
  v_exp_f32 v19, v163
  v_add_f32 v0, v16, v17
  v_cvt_pk_bf16_f32 v184, v16, v17
  v_mfma_f32_32x32x16_bf16 v[144:159], v[196:199], v[52:55], v[144:159]
  v_exp_f32 v16, v164
  v_exp_f32 v17, v165
  v_add_f32 v0, v0, v18
  v_add_f32 v0, v0, v19
  v_mfma_f32_32x32x16_bf16 a[192:207], v[220:223], v[180:183], a[192:207]
  ds_read_b128 v[220:223], v2 offset:7168
  v_cvt_pk_bf16_f32 v185, v18, v19
  v_exp_f32 v18, v166
  v_exp_f32 v19, v167
  v_mfma_f32_32x32x16_bf16 v[144:159], v[200:203], v[56:59], v[144:159]
  ds_read_b128 v[240:243], v3 offset:2048
  v_add_f32 v0, v0, v16
  v_add_f32 v0, v0, v17
  v_cvt_pk_bf16_f32 v186, v16, v17
  v_mfma_f32_32x32x16_bf16 a[208:223], v[224:227], v[176:179], a[208:223]
  ds_read_b128 v[224:227], v2 offset:8192
  ds_read_b128 v[244:247], v3 offset:2048
  v_exp_f32 v16, v168
  v_exp_f32 v17, v169
  v_mfma_f32_32x32x16_bf16 v[144:159], v[204:207], v[60:63], v[144:159]
  ds_read_b128 v[248:251], v3 offset:2048
  v_add_f32 v0, v0, v18
  v_add_f32 v0, v0, v19
  v_cvt_pk_bf16_f32 v187, v18, v19
  v_exp_f32 v18, v170
  v_mfma_f32_32x32x16_bf16 a[208:223], v[228:231], v[180:183], a[208:223]
  ds_read_b128 v[228:231], v2 offset:9216
  ds_read_b128 v[252:255], v3 offset:2048
  v_exp_f32 v19, v171
  v_add_f32 v0, v0, v16
  v_add_f32 v0, v0, v17
  v_mfma_f32_32x32x16_bf16 v[144:159], v[208:211], v[64:67], v[144:159]
  v_cvt_pk_bf16_f32 v188, v16, v17
  v_exp_f32 v16, v172
  v_exp_f32 v17, v173
  v_mfma_f32_32x32x16_bf16 a[224:239], v[232:235], v[176:179], a[224:239]
  ds_read_b128 v[232:235], v2 offset:10240
  v_add_f32 v0, v0, v18
  v_add_f32 v0, v0, v19
  v_cvt_pk_bf16_f32 v189, v18, v19
  v_exp_f32 v18, v174
  v_mfma_f32_32x32x16_bf16 v[144:159], v[212:215], v[68:71], v[144:159]
  v_exp_f32 v19, v175
  v_add_f32 v0, v0, v16
  v_add_f32 v0, v0, v17
  v_cvt_pk_bf16_f32 v190, v16, v17
  v_mfma_f32_32x32x16_bf16 a[224:239], v[236:239], v[180:183], a[224:239]
  ds_read_b128 v[236:239], v2 offset:11264
  v_add_f32 v0, v0, v18
  v_add_f32 v0, v0, v19
  v_cvt_pk_bf16_f32 v191, v18, v19
  v_cmp_lt_f32 vcc, s24, v0
  s_cbranch_vccnz Lslow_5
Lret_5:
  v_add_f32 v4, v4, v0
  s_waitcnt lgkmcnt(2)
  v_mfma_f32_32x32x16_bf16 v[160:175], v[192:195], v[72:75], v[240:255]
  v_exp_f32 v16, v144
  v_exp_f32 v17, v145
  v_exp_f32 v18, v146
  v_mfma_f32_32x32x16_bf16 a[0:15], v[216:219], v[184:187], a[0:15]
  v_exp_f32 v19, v147
  v_add_f32 v0, v16, v17
  v_cvt_pk_bf16_f32 v176, v16, v17
  v_mfma_f32_32x32x16_bf16 v[160:175], v[196:199], v[76:79], v[160:175]
  v_exp_f32 v16, v148
  v_exp_f32 v17, v149
  v_add_f32 v0, v0, v18
  v_mfma_f32_32x32x16_bf16 a[0:15], v[220:223], v[188:191], a[0:15]
  v_add_f32 v0, v0, v19
  v_cvt_pk_bf16_f32 v177, v18, v19
  v_exp_f32 v18, v150
  v_exp_f32 v19, v151
  v_mfma_f32_32x32x16_bf16 v[160:175], v[200:203], v[80:83], v[160:175]
  ds_read_b128 v[240:243], v3 offset:3072
  v_add_f32 v0, v0, v16
  v_add_f32 v0, v0, v17
  v_cvt_pk_bf16_f32 v178, v16, v17
  v_mfma_f32_32x32x16_bf16 a[16:31], v[224:227], v[184:187], a[16:31]
  ds_read_b128 v[244:247], v3 offset:3072
  v_exp_f32 v16, v152
  v_exp_f32 v17, v153
  v_mfma_f32_32x32x16_bf16 v[160:175], v[204:207], v[84:87], v[160:175]
  ds_read_b128 v[248:251], v3 offset:3072
  v_add_f32 v0, v0, v18
  v_add_f32 v0, v0, v19
  v_cvt_pk_bf16_f32 v179, v18, v19
  v_exp_f32 v18, v154
  v_mfma_f32_32x32x16_bf16 a[16:31], v[228:231], v[188:191], a[16:31]
  ds_read_b128 v[252:255], v3 offset:3072
  v_exp_f32 v19, v155
  v_add_f32 v0, v0, v16
  v_add_f32 v0, v0, v17
  v_mfma_f32_32x32x16_bf16 v[160:175], v[208:211], v[88:91], v[160:175]
  v_cvt_pk_bf16_f32 v180, v16, v17
  v_exp_f32 v16, v156
  v_exp_f32 v17, v157
  s_waitcnt lgkmcnt(5)
  v_mfma_f32_32x32x16_bf16 a[32:47], v[232:235], v[184:187], a[32:47]
  v_add_f32 v0, v0, v18
  v_add_f32 v0, v0, v19
  v_cvt_pk_bf16_f32 v181, v18, v19
  v_exp_f32 v18, v158
  v_mfma_f32_32x32x16_bf16 v[160:175], v[212:215], v[92:95], v[160:175]
  v_exp_f32 v19, v159
  v_add_f32 v0, v0, v16
  v_add_f32 v0, v0, v17
  v_cvt_pk_bf16_f32 v182, v16, v17
  s_waitcnt lgkmcnt(4)
  v_mfma_f32_32x32x16_bf16 a[32:47], v[236:239], v[188:191], a[32:47]
  v_add_f32 v0, v0, v18
  v_add_f32 v0, v0, v19
  v_cvt_pk_bf16_f32 v183, v18, v19
  v_cmp_lt_f32 vcc, s24, v0
  s_cbranch_vccnz Lslow_6
Lret_6:
  v_add_f32 v5, v5, v0
  s_waitcnt vmcnt(0)
  s_barrier
  s_add_u32 s28, s28, 24576
  s_cmp_ge_u32 s28, 73728
  s_cselect_b32 s30, 73728, 0
  s_sub_u32 s28, s28, s30
  s_sub_u32 s30, 24576, s30
  v_add_u32 v1, s30, v1
  v_add_u32 v2, s30, v2
  s_waitcnt lgkmcnt(0)
  v_mfma_f32_32x32x16_bf16 v[144:159], v[192:195], v[96:99], v[240:255]
  ds_read_b128 v[192:195], v1 offset:0
  v_exp_f32 v16, v160
  v_exp_f32 v17, v161
  v_mfma_f32_32x32x16_bf16 a[48:63], v[216:219], v[176:179], a[48:63]
  s_add_u32 m0, s21, 0
  s_add_u32 s29, s20, 0
  buffer_load_dwordx4 v14, s[8:11], s29 offen offset:0 lds
  v_exp_f32 v18, v162
  v_exp_f32 v19, v163
  v_add_f32 v0, v16, v17
  v_cvt_pk_bf16_f32 v184, v16, v17
  v_mfma_f32_32x32x16_bf16 v[144:159], v[196:199], v[100:103], v[144:159]
  ds_read_b128 v[196:199], v1 offset:1024
  v_exp_f32 v16, v164
  v_exp_f32 v17, v165
  v_add_f32 v0, v0, v18
  v_mfma_f32_32x32x16_bf16 a[48:63], v[220:223], v[180:183], a[48:63]
  s_add_u32 m0, s21, 0
  s_add_u32 s29, s20, 0
  buffer_load_dwordx4 v14, s[8:11], s29 offen offset:1024 lds
  v_add_f32 v0, v0, v19
  v_cvt_pk_bf16_f32 v185, v18, v19
  v_exp_f32 v18, v166
  v_exp_f32 v19, v167
  v_mfma_f32_32x32x16_bf16 v[144:159], v[200:203], v[104:107], v[144:159]
  ds_read_b128 v[200:203], v1 offset:2048
  ds_read_b128 v[240:243], v3 offset:0
  v_add_f32 v0, v0, v16
  v_add_f32 v0, v0, v17
  v_cvt_pk_bf16_f32 v186, v16, v17
  v_mfma_f32_32x32x16_bf16 a[64:79], v[224:227], v[176:179], a[64:79]
  ds_read_b128 v[244:247], v3 offset:0
  s_add_u32 m0, s21, 0
  s_add_u32 s29, s20, 0
  buffer_load_dwordx4 v14, s[8:11], s29 offen offset:2048 lds
  v_exp_f32 v16, v168
  v_exp_f32 v17, v169
  v_mfma_f32_32x32x16_bf16 v[144:159], v[204:207], v[108:111], v[144:159]
  ds_read_b128 v[204:207], v1 offset:3072
  ds_read_b128 v[248:251], v3 offset:0
  v_add_f32 v0, v0, v18
  v_add_f32 v0, v0, v19
  v_cvt_pk_bf16_f32 v187, v18, v19
  v_exp_f32 v18, v170
  v_mfma_f32_32x32x16_bf16 a[64:79], v[228:231], v[180:183], a[64:79]
  ds_read_b128 v[252:255], v3 offset:0
  v_exp_f32 v19, v171
  v_add_f32 v0, v0, v16
  v_add_f32 v0, v0, v17
  v_mfma_f32_32x32x16_bf16 v[144:159], v[208:211], v[112:115], v[144:159]
  ds_read_b128 v[208:211], v1 offset:4096
  v_cvt_pk_bf16_f32 v188, v16, v17
  v_exp_f32 v16, v172
  v_exp_f32 v17, v173
  v_mfma_f32_32x32x16_bf16 a[80:95], v[232:235], v[176:179], a[80:95]
  v_add_f32 v0, v0, v18
  v_add_f32 v0, v0, v19
  v_cvt_pk_bf16_f32 v189, v18, v19
  v_exp_f32 v18, v174
  v_mfma_f32_32x32x16_bf16 v[144:159], v[212:215], v[116:119], v[144:159]
  ds_read_b128 v[212:215], v1 offset:5120
  v_exp_f32 v19, v175
  v_add_f32 v0, v0, v16
  v_add_f32 v0, v0, v17
  v_mfma_f32_32x32x16_bf16 a[80:95], v[236:239], v[180:183], a[80:95]
  v_cvt_pk_bf16_f32 v190, v16, v17
  v_add_f32 v0, v0, v18
  v_add_f32 v0, v0, v19
  v_cvt_pk_bf16_f32 v191, v18, v19
  v_cmp_lt_f32 vcc, s24, v0
  s_cbranch_vccnz Lslow_7
Lret_7:
  v_add_f32 v6, v6, v0
  s_waitcnt lgkmcnt(2)
  v_mfma_f32_32x32x16_bf16 v[160:175], v[192:195], v[24:27], v[240:255]
  v_exp_f32 v16, v144
  v_exp_f32 v17, v145
  v_exp_f32 v18, v146
  v_mfma_f32_32x32x16_bf16 a[96:111], v[216:219], v[184:187], a[96:111]
  s_add_u32 m0, s21, 0
  s_add_u32 s29, s20, 0
  buffer_load_dwordx4 v14, s[8:11], s29 offen offset:3072 lds
  v_exp_f32 v19, v147
  v_add_f32 v0, v16, v17
  v_cvt_pk_bf16_f32 v176, v16, v17
  v_mfma_f32_32x32x16_bf16 v[160:175], v[196:199], v[28:31], v[160:175]
  v_exp_f32 v16, v148
  v_exp_f32 v17, v149
  v_add_f32 v0, v0, v18
  v_mfma_f32_32x32x16_bf16 a[96:111], v[220:223], v[188:191], a[96:111]
  s_add_u32 m0, s21, 4096
  s_add_u32 s29, s20, 4096
  buffer_load_dwordx4 v14, s[8:11], s29 offen offset:0 lds
  v_add_f32 v0, v0, v19
  v_cvt_pk_bf16_f32 v177, v18, v19
  v_exp_f32 v18, v150
  v_exp_f32 v19, v151
  v_mfma_f32_32x32x16_bf16 v[160:175], v[200:203], v[32:35], v[160:175]
  ds_read_b128 v[240:243], v3 offset:1024
  v_add_f32 v0, v0, v16
  v_add_f32 v0, v0, v17
  v_cvt_pk_bf16_f32 v178, v16, v17
  v_mfma_f32_32x32x16_bf16 a[112:127], v[224:227], v[184:187], a[112:127]
  ds_read_b128 v[244:247], v3 offset:1024
  s_add_u32 m0, s21, 4096
  s_add_u32 s29, s20, 4096
  buffer_load_dwordx4 v14, s[8:11], s29 offen offset:1024 lds
  s_add_u32 s20, s20, 24576
  s_add_u32 s21, s21, 24576
  s_cmp_ge_u32 s21, 73728
  s_cselect_b32 s29, 73728, 0
  s_sub_u32 s21, s21, s29
  v_exp_f32 v16, v152
  v_exp_f32 v17, v153
  v_mfma_f32_32x32x16_bf16 v[160:175], v[204:207], v[36:39], v[160:175]
  ds_read_b128 v[248:251], v3 offset:1024
  v_add_f32 v0, v0, v18
  v_add_f32 v0, v0, v19
  v_cvt_pk_bf16_f32 v179, v18, v19
  v_exp_f32 v18, v154
  v_mfma_f32_32x32x16_bf16 a[112:127], v[228:231], v[188:191], a[112:127]
  ds_read_b128 v[252:255], v3 offset:1024
  v_exp_f32 v19, v155
  v_add_f32 v0, v0, v16
  v_add_f32 v0, v0, v17
  s_waitcnt lgkmcnt(5)
  v_mfma_f32_32x32x16_bf16 v[160:175], v[208:211], v[40:43], v[160:175]
  v_cvt_pk_bf16_f32 v180, v16, v17
  v_exp_f32 v16, v156
  v_exp_f32 v17, v157
  v_mfma_f32_32x32x16_bf16 a[128:143], v[232:235], v[184:187], a[128:143]
  v_add_f32 v0, v0, v18
  v_add_f32 v0, v0, v19
  v_cvt_pk_bf16_f32 v181, v18, v19
  v_exp_f32 v18, v158
  s_waitcnt lgkmcnt(4)
  v_mfma_f32_32x32x16_bf16 v[160:175], v[212:215], v[44:47], v[160:175]
  v_exp_f32 v19, v159
  v_add_f32 v0, v0, v16
  v_add_f32 v0, v0, v17
  v_cvt_pk_bf16_f32 v182, v16, v17
  v_mfma_f32_32x32x16_bf16 a[128:143], v[236:239], v[188:191], a[128:143]
  v_add_f32 v0, v0, v18
  v_add_f32 v0, v0, v19
  v_cvt_pk_bf16_f32 v183, v18, v19
  v_cmp_lt_f32 vcc, s24, v0
  s_cbranch_vccnz Lslow_8
Lret_8:
  v_add_f32 v7, v7, v0
  s_waitcnt lgkmcnt(0)
  v_mfma_f32_32x32x16_bf16 v[144:159], v[192:195], v[48:51], v[240:255]
  v_exp_f32 v16, v160
  v_exp_f32 v17, v161
  v_exp_f32 v18, v162
  v_mfma_f32_32x32x16_bf16 a[144:159], v[216:219], v[176:179], a[144:159]
  ds_read_b128 v[216:219], v1 offset:6144
  v_exp_f32 v19, v163
  v_add_f32 v0, v16, v17
  v_cvt_pk_bf16_f32 v184, v16, v17
  v_mfma_f32_32x32x16_bf16 v[144:159], v[196:199], v[52:55], v[144:159]
  v_exp_f32 v16, v164
  v_exp_f32 v17, v165
  v_add_f32 v0, v0, v18
  v_add_f32 v0, v0, v19
  v_mfma_f32_32x32x16_bf16 a[144:159], v[220:223], v[180:183], a[144:159]
  ds_read_b128 v[220:223], v1 offset:7168
  v_cvt_pk_bf16_f32 v185, v18, v19
  v_exp_f32 v18, v166
  v_exp_f32 v19, v167
  v_mfma_f32_32x32x16_bf16 v[144:159], v[200:203], v[56:59], v[144:159]
  ds_read_b128 v[240:243], v3 offset:2048
  v_add_f32 v0, v0, v16
  v_add_f32 v0, v0, v17
  v_cvt_pk_bf16_f32 v186, v16, v17
  v_mfma_f32_32x32x16_bf16 a[160:175], v[224:227], v[176:179], a[160:175]
  ds_read_b128 v[224:227], v1 offset:8192
  ds_read_b128 v[244:247], v3 offset:2048
  v_exp_f32 v16, v168
  v_exp_f32 v17, v169
  v_mfma_f32_32x32x16_bf16 v[144:159], v[204:207], v[60:63], v[144:159]
  ds_read_b128 v[248:251], v3 offset:2048
  v_add_f32 v0, v0, v18
  v_add_f32 v0, v0, v19
  v_cvt_pk_bf16_f32 v187, v18, v19
  v_exp_f32 v18, v170
  v_mfma_f32_32x32x16_bf16 a[160:175], v[228:231], v[180:183], a[160:175]
  ds_read_b128 v[228:231], v1 offset:9216
  ds_read_b128 v[252:255], v3 offset:2048
  v_exp_f32 v19, v171
  v_add_f32 v0, v0, v16
  v_add_f32 v0, v0, v17
  v_mfma_f32_32x32x16_bf16 v[144:159], v[208:211], v[64:67], v[144:159]
  v_cvt_pk_bf16_f32 v188, v16, v17
  v_exp_f32 v16, v172
  v_exp_f32 v17, v173
  v_mfma_f32_32x32x16_bf16 a[176:191], v[232:235], v[176:179], a[176:191]
  ds_read_b128 v[232:235], v1 offset:10240
  v_add_f32 v0, v0, v18
  v_add_f32 v0, v0, v19
  v_cvt_pk_bf16_f32 v189, v18, v19
  v_exp_f32 v18, v174
  v_mfma_f32_32x32x16_bf16 v[144:159], v[212:215], v[68:71], v[144:159]
  v_exp_f32 v19, v175
  v_add_f32 v0, v0, v16
  v_add_f32 v0, v0, v17
  v_cvt_pk_bf16_f32 v190, v16, v17
  v_mfma_f32_32x32x16_bf16 a[176:191], v[236:239], v[180:183], a[176:191]
  ds_read_b128 v[236:239], v1 offset:11264
  v_add_f32 v0, v0, v18
  v_add_f32 v0, v0, v19
  v_cvt_pk_bf16_f32 v191, v18, v19
  v_cmp_lt_f32 vcc, s25, v0
  s_cbranch_vccnz Lslow_9
Lret_9:
  v_add_f32 v4, v4, v0
  s_waitcnt lgkmcnt(2)
  v_mfma_f32_32x32x16_bf16 v[160:175], v[192:195], v[72:75], v[240:255]
  v_exp_f32 v16, v144
  v_exp_f32 v17, v145
  v_exp_f32 v18, v146
  v_mfma_f32_32x32x16_bf16 a[0:15], v[216:219], v[184:187], a[0:15]
  v_exp_f32 v19, v147
  v_add_f32 v0, v16, v17
  v_cvt_pk_bf16_f32 v176, v16, v17
  v_mfma_f32_32x32x16_bf16 v[160:175], v[196:199], v[76:79], v[160:175]
  v_exp_f32 v16, v148
  v_exp_f32 v17, v149
  v_add_f32 v0, v0, v18
  v_mfma_f32_32x32x16_bf16 a[0:15], v[220:223], v[188:191], a[0:15]
  v_add_f32 v0, v0, v19
  v_cvt_pk_bf16_f32 v177, v18, v19
  v_exp_f32 v18, v150
  v_exp_f32 v19, v151
  v_mfma_f32_32x32x16_bf16 v[160:175], v[200:203], v[80:83], v[160:175]
  ds_read_b128 v[240:243], v3 offset:3072
  v_add_f32 v0, v0, v16
  v_add_f32 v0, v0, v17
  v_cvt_pk_bf16_f32 v178, v16, v17
  v_mfma_f32_32x32x16_bf16 a[16:31], v[224:227], v[184:187], a[16:31]
  ds_read_b128 v[244:247], v3 offset:3072
  v_exp_f32 v16, v152
  v_exp_f32 v17, v153
  v_mfma_f32_32x32x16_bf16 v[160:175], v[204:207], v[84:87], v[160:175]
  ds_read_b128 v[248:251], v3 offset:3072
  v_add_f32 v0, v0, v18
  v_add_f32 v0, v0, v19
  v_cvt_pk_bf16_f32 v179, v18, v19
  v_exp_f32 v18, v154
  v_mfma_f32_32x32x16_bf16 a[16:31], v[228:231], v[188:191], a[16:31]
  ds_read_b128 v[252:255], v3 offset:3072
  v_exp_f32 v19, v155
  v_add_f32 v0, v0, v16
  v_add_f32 v0, v0, v17
  v_mfma_f32_32x32x16_bf16 v[160:175], v[208:211], v[88:91], v[160:175]
  v_cvt_pk_bf16_f32 v180, v16, v17
  v_exp_f32 v16, v156
  v_exp_f32 v17, v157
  s_waitcnt lgkmcnt(5)
  v_mfma_f32_32x32x16_bf16 a[32:47], v[232:235], v[184:187], a[32:47]
  v_add_f32 v0, v0, v18
  v_add_f32 v0, v0, v19
  v_cvt_pk_bf16_f32 v181, v18, v19
  v_exp_f32 v18, v158
  v_mfma_f32_32x32x16_bf16 v[160:175], v[212:215], v[92:95], v[160:175]
  v_exp_f32 v19, v159
  v_add_f32 v0, v0, v16
  v_add_f32 v0, v0, v17
  v_cvt_pk_bf16_f32 v182, v16, v17
  s_waitcnt lgkmcnt(4)
  v_mfma_f32_32x32x16_bf16 a[32:47], v[236:239], v[188:191], a[32:47]
  v_add_f32 v0, v0, v18
  v_add_f32 v0, v0, v19
  v_cvt_pk_bf16_f32 v183, v18, v19
  v_cmp_lt_f32 vcc, s25, v0
  s_cbranch_vccnz Lslow_10
Lret_10:
  v_add_f32 v5, v5, v0
  s_waitcnt lgkmcnt(0)
  v_mfma_f32_32x32x16_bf16 v[144:159], v[192:195], v[96:99], v[240:255]
  v_exp_f32 v16, v160
  v_exp_f32 v17, v161
  v_exp_f32 v18, v162
  v_mfma_f32_32x32x16_bf16 a[48:63], v[216:219], v[176:179], a[48:63]
  v_exp_f32 v19, v163
  v_add_f32 v0, v16, v17
  v_cvt_pk_bf16_f32 v184, v16, v17
  v_mfma_f32_32x32x16_bf16 v[144:159], v[196:199], v[100:103], v[144:159]
  v_exp_f32 v16, v164
  v_exp_f32 v17, v165
  v_add_f32 v0, v0, v18
  v_mfma_f32_32x32x16_bf16 a[48:63], v[220:223], v[180:183], a[48:63]
  v_add_f32 v0, v0, v19
  v_cvt_pk_bf16_f32 v185, v18, v19
  v_exp_f32 v18, v166
  v_exp_f32 v19, v167
  v_mfma_f32_32x32x16_bf16 v[144:159], v[200:203], v[104:107], v[144:159]
  ds_read_b128 v[240:243], v3 offset:4096
  v_add_f32 v0, v0, v16
  v_add_f32 v0, v0, v17
  v_cvt_pk_bf16_f32 v186, v16, v17
  v_mfma_f32_32x32x16_bf16 a[64:79], v[224:227], v[176:179], a[64:79]
  ds_read_b128 v[244:247], v3 offset:4096
  v_exp_f32 v16, v168
  v_exp_f32 v17, v169
  v_mfma_f32_32x32x16_bf16 v[144:159], v[204:207], v[108:111], v[144:159]
  ds_read_b128 v[248:251], v3 offset:4096
  v_add_f32 v0, v0, v18
  v_add_f32 v0, v0, v19
  v_cvt_pk_bf16_f32 v187, v18, v19
  v_exp_f32 v18, v170
  v_mfma_f32_32x32x16_bf16 a[64:79], v[228:231], v[180:183], a[64:79]
  ds_read_b128 v[252:255], v3 offset:4096
  v_exp_f32 v19, v171
  v_add_f32 v0, v0, v16
  v_add_f32 v0, v0, v17
  v_mfma_f32_32x32x16_bf16 v[144:159], v[208:211], v[112:115], v[144:159]
  v_cvt_pk_bf16_f32 v188, v16, v17
  v_exp_f32 v16, v172
  v_exp_f32 v17, v173
  v_mfma_f32_32x32x16_bf16 a[80:95], v[232:235], v[176:179], a[80:95]
  v_add_f32 v0, v0, v18
  v_add_f32 v0, v0, v19
  v_cvt_pk_bf16_f32 v189, v18, v19
  v_exp_f32 v18, v174
  v_mfma_f32_32x32x16_bf16 v[144:159], v[212:215], v[116:119], v[144:159]
  v_exp_f32 v19, v175
  v_add_f32 v0, v0, v16
  v_add_f32 v0, v0, v17
  v_cvt_pk_bf16_f32 v190, v16, v17
  v_mfma_f32_32x32x16_bf16 a[80:95], v[236:239], v[180:183], a[80:95]
  v_add_f32 v0, v0, v18
  v_add_f32 v0, v0, v19
  v_cvt_pk_bf16_f32 v191, v18, v19
  v_cmp_lt_f32 vcc, s25, v0
  s_cbranch_vccnz Lslow_11
Lret_11:
  v_add_f32 v6, v6, v0
  s_waitcnt lgkmcnt(0)
  v_mfma_f32_32x32x16_bf16 v[160:175], v[192:195], v[120:123], v[240:255]
  ds_read_b128 v[192:195], v2 offset:0
  v_exp_f32 v16, v144
  v_exp_f32 v17, v145
  v_mfma_f32_32x32x16_bf16 a[96:111], v[216:219], v[184:187], a[96:111]
  v_exp_f32 v18, v146
  v_exp_f32 v19, v147
  v_add_f32 v0, v16, v17
  v_cvt_pk_bf16_f32 v176, v16, v17
  v_mfma_f32_32x32x16_bf16 v[160:175], v[196:199], v[124:127], v[160:175]
  ds_read_b128 v[196:199], v2 offset:1024
  v_exp_f32 v16, v148
  v_exp_f32 v17, v149
  v_add_f32 v0, v0, v18
  v_mfma_f32_32x32x16_bf16 a[96:111], v[220:223], v[188:191], a[96:111]
  v_add_f32 v0, v0, v19
  v_cvt_pk_bf16_f32 v177, v18, v19
  v_exp_f32 v18, v150
  v_exp_f32 v19, v151
  v_mfma_f32_32x32x16_bf16 v[160:175], v[200:203], v[128:131], v[160:175]
  ds_read_b128 v[200:203], v2 offset:2048
  ds_read_b128 v[240:243], v3 offset:0
  v_add_f32 v0, v0, v16
  v_add_f32 v0, v0, v17
  v_cvt_pk_bf16_f32 v178, v16, v17
  v_mfma_f32_32x32x16_bf16 a[112:127], v[224:227], v[184:187], a[112:127]
  ds_read_b128 v[244:247], v3 offset:0
  v_exp_f32 v16, v152
  v_exp_f32 v17, v153
  v_mfma_f32_32x32x16_bf16 v[160:175], v[204:207], v[132:135], v[160:175]
  ds_read_b128 v[204:207], v2 offset:3072
  ds_read_b128 v[248:251], v3 offset:0
  v_add_f32 v0, v0, v18
  v_add_f32 v0, v0, v19
  v_cvt_pk_bf16_f32 v179, v18, v19
  v_exp_f32 v18, v154
  v_mfma_f32_32x32x16_bf16 a[112:127], v[228:231], v[188:191], a[112:127]
  ds_read_b128 v[252:255], v3 offset:0
  v_exp_f32 v19, v155
  v_add_f32 v0, v0, v16
  v_add_f32 v0, v0, v17
  v_mfma_f32_32x32x16_bf16 v[160:175], v[208:211], v[136:139], v[160:175]
  ds_read_b128 v[208:211], v2 offset:4096
  v_cvt_pk_bf16_f32 v180, v16, v17
  v_exp_f32 v16, v156
  v_exp_f32 v17, v157
  v_mfma_f32_32x32x16_bf16 a[128:143], v[232:235], v[184:187], a[128:143]
  v_add_f32 v0, v0, v18
  v_add_f32 v0, v0, v19
  v_cvt_pk_bf16_f32 v181, v18, v19
  v_exp_f32 v18, v158
  v_mfma_f32_32x32x16_bf16 v[160:175], v[212:215], v[140:143], v[160:175]
  ds_read_b128 v[212:215], v2 offset:5120
  v_exp_f32 v19, v159
  v_add_f32 v0, v0, v16
  v_add_f32 v0, v0, v17
  v_mfma_f32_32x32x16_bf16 a[128:143], v[236:239], v[188:191], a[128:143]
  v_cvt_pk_bf16_f32 v182, v16, v17
  v_add_f32 v0, v0, v18
  v_add_f32 v0, v0, v19
  v_cvt_pk_bf16_f32 v183, v18, v19
  v_cmp_lt_f32 vcc, s25, v0
  s_cbranch_vccnz Lslow_12
Lret_12:
  v_add_f32 v7, v7, v0
  s_waitcnt lgkmcnt(2)
  v_mfma_f32_32x32x16_bf16 v[144:159], v[192:195], v[24:27], v[240:255]
  v_exp_f32 v16, v160
  v_exp_f32 v17, v161
  v_exp_f32 v18, v162
  v_mfma_f32_32x32x16_bf16 a[144:159], v[216:219], v[176:179], a[144:159]
  v_exp_f32 v19, v163
  v_add_f32 v0, v16, v17
  v_cvt_pk_bf16_f32 v184, v16, v17
  v_mfma_f32_32x32x16_bf16 v[144:159], v[196:199], v[28:31], v[144:159]
  v_exp_f32 v16, v164
  v_exp_f32 v17, v165
  v_add_f32 v0, v0, v18
  v_mfma_f32_32x32x16_bf16 a[144:159], v[220:223], v[180:183], a[144:159]
  v_add_f32 v0, v0, v19
  v_cvt_pk_bf16_f32 v185, v18, v19
  v_exp_f32 v18, v166
  v_exp_f32 v19, v167
  v_mfma_f32_32x32x16_bf16 v[144:159], v[200:203], v[32:35], v[144:159]
  ds_read_b128 v[240:243], v3 offset:1024
  v_add_f32 v0, v0, v16
  v_add_f32 v0, v0, v17
  v_cvt_pk_bf16_f32 v186, v16, v17
  v_mfma_f32_32x32x16_bf16 a[160:175], v[224:227], v[176:179], a[160:175]
  ds_read_b128 v[244:247], v3 offset:1024
  v_exp_f32 v16, v168
  v_exp_f32 v17, v169
  v_mfma_f32_32x32x16_bf16 v[144:159], v[204:207], v[36:39], v[144:159]
  ds_read_b128 v[248:251], v3 offset:1024
  v_add_f32 v0, v0, v18
  v_add_f32 v0, v0, v19
  v_cvt_pk_bf16_f32 v187, v18, v19
  v_exp_f32 v18, v170
  v_mfma_f32_32x32x16_bf16 a[160:175], v[228:231], v[180:183], a[160:175]
  ds_read_b128 v[252:255], v3 offset:1024
  v_exp_f32 v19, v171
  v_add_f32 v0, v0, v16
  v_add_f32 v0, v0, v17
  s_waitcnt lgkmcnt(5)
  v_mfma_f32_32x32x16_bf16 v[144:159], v[208:211], v[40:43], v[144:159]
  v_cvt_pk_bf16_f32 v188, v16, v17
  v_exp_f32 v16, v172
  v_exp_f32 v17, v173
  v_mfma_f32_32x32x16_bf16 a[176:191], v[232:235], v[176:179], a[176:191]
  v_add_f32 v0, v0, v18
  v_add_f32 v0, v0, v19
  v_cvt_pk_bf16_f32 v189, v18, v19
  v_exp_f32 v18, v174
  s_waitcnt lgkmcnt(4)
  v_mfma_f32_32x32x16_bf16 v[144:159], v[212:215], v[44:47], v[144:159]
  v_exp_f32 v19, v175
  v_add_f32 v0, v0, v16
  v_add_f32 v0, v0, v17
  v_cvt_pk_bf16_f32 v190, v16, v17
  v_mfma_f32_32x32x16_bf16 a[176:191], v[236:239], v[180:183], a[176:191]
  v_add_f32 v0, v0, v18
  v_add_f32 v0, v0, v19
  v_cvt_pk_bf16_f32 v191, v18, v19
  v_cmp_lt_f32 vcc, s25, v0
  s_cbranch_vccnz Lslow_13
Lret_13:
  v_add_f32 v8, v8, v0
  s_mov_b32 s26, 0
  s_mov_b32 s25, s24
  s_waitcnt lgkmcnt(0)
  v_mfma_f32_32x32x16_bf16 v[160:175], v[192:195], v[48:51], v[240:255]
  v_exp_f32 v16, v144
  v_exp_f32 v17, v145
  v_exp_f32 v18, v146
  v_mfma_f32_32x32x16_bf16 a[192:207], v[216:219], v[184:187], a[192:207]
  ds_read_b128 v[216:219], v2 offset:6144
  v_exp_f32 v19, v147
  v_add_f32 v0, v16, v17
  v_cvt_pk_bf16_f32 v176, v16, v17
  v_mfma_f32_32x32x16_bf16 v[160:175], v[196:199], v[52:55], v[160:175]
  v_exp_f32 v16, v148
  v_exp_f32 v17, v149
  v_add_f32 v0, v0, v18
  v_add_f32 v0, v0, v19
  v_mfma_f32_32x32x16_bf16 a[192:207], v[220:223], v[188:191], a[192:207]
  ds_read_b128 v[220:223], v2 offset:7168
  v_cvt_pk_bf16_f32 v177, v18, v19
  v_exp_f32 v18, v150
  v_exp_f32 v19, v151
  v_mfma_f32_32x32x16_bf16 v[160:175], v[200:203], v[56:59], v[160:175]
  ds_read_b128 v[240:243], v3 offset:2048
  v_add_f32 v0, v0, v16
  v_add_f32 v0, v0, v17
  v_cvt_pk_bf16_f32 v178, v16, v17
  v_mfma_f32_32x32x16_bf16 a[208:223], v[224:227], v[184:187], a[208:223]
  ds_read_b128 v[224:227], v2 offset:8192
  ds_read_b128 v[244:247], v3 offset:2048
  v_exp_f32 v16, v152
  v_exp_f32 v17, v153
  v_mfma_f32_32x32x16_bf16 v[160:175], v[204:207], v[60:63], v[160:175]
  ds_read_b128 v[248:251], v3 offset:2048
  v_add_f32 v0, v0, v18
  v_add_f32 v0, v0, v19
  v_cvt_pk_bf16_f32 v179, v18, v19
  v_exp_f32 v18, v154
  v_mfma_f32_32x32x16_bf16 a[208:223], v[228:231], v[188:191], a[208:223]
  ds_read_b128 v[228:231], v2 offset:9216
  ds_read_b128 v[252:255], v3 offset:2048
  v_exp_f32 v19, v155
  v_add_f32 v0, v0, v16
  v_add_f32 v0, v0, v17
  v_mfma_f32_32x32x16_bf16 v[160:175], v[208:211], v[64:67], v[160:175]
  v_cvt_pk_bf16_f32 v180, v16, v17
  v_exp_f32 v16, v156
  v_exp_f32 v17, v157
  v_mfma_f32_32x32x16_bf16 a[224:239], v[232:235], v[184:187], a[224:239]
  ds_read_b128 v[232:235], v2 offset:10240
  v_add_f32 v0, v0, v18
  v_add_f32 v0, v0, v19
  v_cvt_pk_bf16_f32 v181, v18, v19
  v_exp_f32 v18, v158
  v_mfma_f32_32x32x16_bf16 v[160:175], v[212:215], v[68:71], v[160:175]
  v_exp_f32 v19, v159
  v_add_f32 v0, v0, v16
  v_add_f32 v0, v0, v17
  v_cvt_pk_bf16_f32 v182, v16, v17
  v_mfma_f32_32x32x16_bf16 a[224:239], v[236:239], v[188:191], a[224:239]
  ds_read_b128 v[236:239], v2 offset:11264
  v_add_f32 v0, v0, v18
  v_add_f32 v0, v0, v19
  v_cvt_pk_bf16_f32 v183, v18, v19
  v_cmp_lt_f32 vcc, s24, v0
  s_cbranch_vccnz Lslow_14
Lret_14:
  v_add_f32 v4, v4, v0
  s_waitcnt lgkmcnt(2)
  v_mfma_f32_32x32x16_bf16 v[144:159], v[192:195], v[72:75], v[240:255]
  v_exp_f32 v16, v160
  v_exp_f32 v17, v161
  v_exp_f32 v18, v162
  v_mfma_f32_32x32x16_bf16 a[0:15], v[216:219], v[176:179], a[0:15]
  v_exp_f32 v19, v163
  v_add_f32 v0, v16, v17
  v_cvt_pk_bf16_f32 v184, v16, v17
  v_mfma_f32_32x32x16_bf16 v[144:159], v[196:199], v[76:79], v[144:159]
  v_exp_f32 v16, v164
  v_exp_f32 v17, v165
  v_add_f32 v0, v0, v18
  v_mfma_f32_32x32x16_bf16 a[0:15], v[220:223], v[180:183], a[0:15]
  v_add_f32 v0, v0, v19
  v_cvt_pk_bf16_f32 v185, v18, v19
  v_exp_f32 v18, v166
  v_exp_f32 v19, v167
  v_mfma_f32_32x32x16_bf16 v[144:159], v[200:203], v[80:83], v[144:159]
  ds_read_b128 v[240:243], v3 offset:3072
  v_add_f32 v0, v0, v16
  v_add_f32 v0, v0, v17
  v_cvt_pk_bf16_f32 v186, v16, v17
  v_mfma_f32_32x32x16_bf16 a[16:31], v[224:227], v[176:179], a[16:31]
  ds_read_b128 v[244:247], v3 offset:3072
  v_exp_f32 v16, v168
  v_exp_f32 v17, v169
  v_mfma_f32_32x32x16_bf16 v[144:159], v[204:207], v[84:87], v[144:159]
  ds_read_b128 v[248:251], v3 offset:3072
  v_add_f32 v0, v0, v18
  v_add_f32 v0, v0, v19
  v_cvt_pk_bf16_f32 v187, v18, v19
  v_exp_f32 v18, v170
  v_mfma_f32_32x32x16_bf16 a[16:31], v[228:231], v[180:183], a[16:31]
  ds_read_b128 v[252:255], v3 offset:3072
  v_exp_f32 v19, v171
  v_add_f32 v0, v0, v16
  v_add_f32 v0, v0, v17
  v_mfma_f32_32x32x16_bf16 v[144:159], v[208:211], v[88:91], v[144:159]
  v_cvt_pk_bf16_f32 v188, v16, v17
  v_exp_f32 v16, v172
  v_exp_f32 v17, v173
  s_waitcnt lgkmcnt(5)
  v_mfma_f32_32x32x16_bf16 a[32:47], v[232:235], v[176:179], a[32:47]
  v_add_f32 v0, v0, v18
  v_add_f32 v0, v0, v19
  v_cvt_pk_bf16_f32 v189, v18, v19
  v_exp_f32 v18, v174
  v_mfma_f32_32x32x16_bf16 v[144:159], v[212:215], v[92:95], v[144:159]
  v_exp_f32 v19, v175
  v_add_f32 v0, v0, v16
  v_add_f32 v0, v0, v17
  v_cvt_pk_bf16_f32 v190, v16, v17
  s_waitcnt lgkmcnt(4)
  v_mfma_f32_32x32x16_bf16 a[32:47], v[236:239], v[180:183], a[32:47]
  v_add_f32 v0, v0, v18
  v_add_f32 v0, v0, v19
  v_cvt_pk_bf16_f32 v191, v18, v19
  v_cmp_lt_f32 vcc, s24, v0
  s_cbranch_vccnz Lslow_15
Lret_15:
  v_add_f32 v5, v5, v0
  s_waitcnt vmcnt(0)
  s_barrier
  s_add_u32 s28, s28, 24576
  s_cmp_ge_u32 s28, 73728
  s_cselect_b32 s30, 73728, 0
  s_sub_u32 s28, s28, s30
  s_sub_u32 s30, 24576, s30
  v_add_u32 v1, s30, v1
  v_add_u32 v2, s30, v2
  s_waitcnt lgkmcnt(0)
  v_mfma_f32_32x32x16_bf16 v[160:175], v[192:195], v[96:99], v[240:255]
  ds_read_b128 v[192:195], v1 offset:0
  v_exp_f32 v16, v144
  v_exp_f32 v17, v145
  v_mfma_f32_32x32x16_bf16 a[48:63], v[216:219], v[184:187], a[48:63]
  s_add_u32 m0, s21, 0
  s_add_u32 s29, s20, 0
  buffer_load_dwordx4 v14, s[8:11], s29 offen offset:0 lds
  v_exp_f32 v18, v146
  v_exp_f32 v19, v147
  v_add_f32 v0, v16, v17
  v_cvt_pk_bf16_f32 v176, v16, v17
  v_mfma_f32_32x32x16_bf16 v[160:175], v[196:199], v[100:103], v[160:175]
  ds_read_b128 v[196:199], v1 offset:1024
  v_exp_f32 v16, v148
  v_exp_f32 v17, v149
  v_add_f32 v0, v0, v18
  v_mfma_f32_32x32x16_bf16 a[48:63], v[220:223], v[188:191], a[48:63]
  s_add_u32 m0, s21, 0
  s_add_u32 s29, s20, 0
  buffer_load_dwordx4 v14, s[8:11], s29 offen offset:1024 lds
  v_add_f32 v0, v0, v19
  v_cvt_pk_bf16_f32 v177, v18, v19
  v_exp_f32 v18, v150
  v_exp_f32 v19, v151
  v_mfma_f32_32x32x16_bf16 v[160:175], v[200:203], v[104:107], v[160:175]
  ds_read_b128 v[200:203], v1 offset:2048
  ds_read_b128 v[240:243], v3 offset:0
  v_add_f32 v0, v0, v16
  v_add_f32 v0, v0, v17
  v_cvt_pk_bf16_f32 v178, v16, v17
  v_mfma_f32_32x32x16_bf16 a[64:79], v[224:227], v[184:187], a[64:79]
  ds_read_b128 v[244:247], v3 offset:0
  s_add_u32 m0, s21, 0
  s_add_u32 s29, s20, 0
  buffer_load_dwordx4 v14, s[8:11], s29 offen offset:2048 lds
  v_exp_f32 v16, v152
  v_exp_f32 v17, v153
  v_mfma_f32_32x32x16_bf16 v[160:175], v[204:207], v[108:111], v[160:175]
  ds_read_b128 v[204:207], v1 offset:3072
  ds_read_b128 v[248:251], v3 offset:0
  v_add_f32 v0, v0, v18
  v_add_f32 v0, v0, v19
  v_cvt_pk_bf16_f32 v179, v18, v19
  v_exp_f32 v18, v154
  v_mfma_f32_32x32x16_bf16 a[64:79], v[228:231], v[188:191], a[64:79]
  ds_read_b128 v[252:255], v3 offset:0
  v_exp_f32 v19, v155
  v_add_f32 v0, v0, v16
  v_add_f32 v0, v0, v17
  v_mfma_f32_32x32x16_bf16 v[160:175], v[208:211], v[112:115], v[160:175]
  ds_read_b128 v[208:211], v1 offset:4096
  v_cvt_pk_bf16_f32 v180, v16, v17
  v_exp_f32 v16, v156
  v_exp_f32 v17, v157
  v_mfma_f32_32x32x16_bf16 a[80:95], v[232:235], v[184:187], a[80:95]
  v_add_f32 v0, v0, v18
  v_add_f32 v0, v0, v19
  v_cvt_pk_bf16_f32 v181, v18, v19
  v_exp_f32 v18, v158
  v_mfma_f32_32x32x16_bf16 v[160:175], v[212:215], v[116:119], v[160:175]
  ds_read_b128 v[212:215], v1 offset:5120
  v_exp_f32 v19, v159
  v_add_f32 v0, v0, v16
  v_add_f32 v0, v0, v17
  v_mfma_f32_32x32x16_bf16 a[80:95], v[236:239], v[188:191], a[80:95]
  v_cvt_pk_bf16_f32 v182, v16, v17
  v_add_f32 v0, v0, v18
  v_add_f32 v0, v0, v19
  v_cvt_pk_bf16_f32 v183, v18, v19
  v_cmp_lt_f32 vcc, s24, v0
  s_cbranch_vccnz Lslow_16
Lret_16:
  v_add_f32 v6, v6, v0
  s_waitcnt lgkmcnt(2)
  v_mfma_f32_32x32x16_bf16 v[144:159], v[192:195], v[24:27], v[240:255]
  v_exp_f32 v16, v160
  v_exp_f32 v17, v161
  v_exp_f32 v18, v162
  v_mfma_f32_32x32x16_bf16 a[96:111], v[216:219], v[176:179], a[96:111]
  s_add_u32 m0, s21, 0
  s_add_u32 s29, s20, 0
  buffer_load_dwordx4 v14, s[8:11], s29 offen offset:3072 lds
  v_exp_f32 v19, v163
  v_add_f32 v0, v16, v17
  v_cvt_pk_bf16_f32 v184, v16, v17
  v_mfma_f32_32x32x16_bf16 v[144:159], v[196:199], v[28:31], v[144:159]
  v_exp_f32 v16, v164
  v_exp_f32 v17, v165
  v_add_f32 v0, v0, v18
  v_mfma_f32_32x32x16_bf16 a[96:111], v[220:223], v[180:183], a[96:111]
  s_add_u32 m0, s21, 4096
  s_add_u32 s29, s20, 4096
  buffer_load_dwordx4 v14, s[8:11], s29 offen offset:0 lds
  v_add_f32 v0, v0, v19
  v_cvt_pk_bf16_f32 v185, v18, v19
  v_exp_f32 v18, v166
  v_exp_f32 v19, v167
  v_mfma_f32_32x32x16_bf16 v[144:159], v[200:203], v[32:35], v[144:159]
  ds_read_b128 v[240:243], v3 offset:1024
  v_add_f32 v0, v0, v16
  v_add_f32 v0, v0, v17
  v_cvt_pk_bf16_f32 v186, v16, v17
  v_mfma_f32_32x32x16_bf16 a[112:127], v[224:227], v[176:179], a[112:127]
  ds_read_b128 v[244:247], v3 offset:1024
  s_add_u32 m0, s21, 4096
  s_add_u32 s29, s20, 4096
  buffer_load_dwordx4 v14, s[8:11], s29 offen offset:1024 lds
  s_add_u32 s20, s20, 24576
  s_add_u32 s21, s21, 24576
  s_cmp_ge_u32 s21, 73728
  s_cselect_b32 s29, 73728, 0
  s_sub_u32 s21, s21, s29
  v_exp_f32 v16, v168
  v_exp_f32 v17, v169
  v_mfma_f32_32x32x16_bf16 v[144:159], v[204:207], v[36:39], v[144:159]
  ds_read_b128 v[248:251], v3 offset:1024
  v_add_f32 v0, v0, v18
  v_add_f32 v0, v0, v19
  v_cvt_pk_bf16_f32 v187, v18, v19
  v_exp_f32 v18, v170
  v_mfma_f32_32x32x16_bf16 a[112:127], v[228:231], v[180:183], a[112:127]
  ds_read_b128 v[252:255], v3 offset:1024
  v_exp_f32 v19, v171
  v_add_f32 v0, v0, v16
  v_add_f32 v0, v0, v17
  s_waitcnt lgkmcnt(5)
  v_mfma_f32_32x32x16_bf16 v[144:159], v[208:211], v[40:43], v[144:159]
  v_cvt_pk_bf16_f32 v188, v16, v17
  v_exp_f32 v16, v172
  v_exp_f32 v17, v173
  v_mfma_f32_32x32x16_bf16 a[128:143], v[232:235], v[176:179], a[128:143]
  v_add_f32 v0, v0, v18
  v_add_f32 v0, v0, v19
  v_cvt_pk_bf16_f32 v189, v18, v19
  v_exp_f32 v18, v174
  s_waitcnt lgkmcnt(4)
  v_mfma_f32_32x32x16_bf16 v[144:159], v[212:215], v[44:47], v[144:159]
  v_exp_f32 v19, v175
  v_add_f32 v0, v0, v16
  v_add_f32 v0, v0, v17
  v_cvt_pk_bf16_f32 v190, v16, v17
  v_mfma_f32_32x32x16_bf16 a[128:143], v[236:239], v[180:183], a[128:143]
  v_add_f32 v0, v0, v18
  v_add_f32 v0, v0, v19
  v_cvt_pk_bf16_f32 v191, v18, v19
  v_cmp_lt_f32 vcc, s24, v0
  s_cbranch_vccnz Lslow_17
Lret_17:
  v_add_f32 v7, v7, v0
  s_add_u32 s27, s27, 1
  s_cmp_lt_u32 s27, 18
  s_cbranch_scc1 Lloop
  s_waitcnt lgkmcnt(0)
  s_nop 7
  v_mfma_f32_32x32x16_bf16 a[144:159], v[216:219], v[184:187], a[144:159]
  v_mfma_f32_32x32x16_bf16 a[144:159], v[220:223], v[188:191], a[144:159]
  v_mfma_f32_32x32x16_bf16 a[160:175], v[224:227], v[184:187], a[160:175]
  v_mfma_f32_32x32x16_bf16 a[160:175], v[228:231], v[188:191], a[160:175]
  v_mfma_f32_32x32x16_bf16 a[176:191], v[232:235], v[184:187], a[176:191]
  v_mfma_f32_32x32x16_bf16 a[176:191], v[236:239], v[188:191], a[176:191]
  s_nop 15
  s_nop 15
  v_lshrrev_b32 v0, 4, v14
  v_and_b32 v15, 31, v0
  v_mul_u32_u24 v15, 192, v15
  v_lshrrev_b32 v1, 5, v0
  v_lshl_add_u32 v15, v1, 4, v15
  s_lshl_b32 s29, s16, 2
  s_add_u32 s29, s29, 0
  s_mul_i32 s29, s29, 6144
  s_add_u32 s29, s29, s18
  v_mov_b32 v17, v4
  v_mov_b32 v16, v4
  s_nop 1
  v_permlane32_swap_b32 v16, v17
  s_nop 1
  v_add_f32 v16, v16, v17
  v_rcp_f32 v16, v16
  s_nop 1
  v_accvgpr_read_b32 v18, a0
  v_accvgpr_read_b32 v19, a1
  v_accvgpr_read_b32 v20, a2
  v_accvgpr_read_b32 v21, a3
  v_mul_f32 v18, v18, v16
  v_mul_f32 v19, v19, v16
  v_mul_f32 v20, v20, v16
  v_mul_f32 v21, v21, v16
  v_cvt_pk_bf16_f32 v24, v18, v19
  v_cvt_pk_bf16_f32 v25, v20, v21
  v_accvgpr_read_b32 v18, a4
  v_accvgpr_read_b32 v19, a5
  v_accvgpr_read_b32 v20, a6
  v_accvgpr_read_b32 v21, a7
  v_mul_f32 v18, v18, v16
  v_mul_f32 v19, v19, v16
  v_mul_f32 v20, v20, v16
  v_mul_f32 v21, v21, v16
  v_cvt_pk_bf16_f32 v26, v18, v19
  v_cvt_pk_bf16_f32 v27, v20, v21
  s_nop 1
  v_permlane32_swap_b32 v24, v26
  v_permlane32_swap_b32 v25, v27
  buffer_store_dwordx4 v[24:27], v15, s[12:15], s29 offen offset:0
  v_accvgpr_read_b32 v18, a8
  v_accvgpr_read_b32 v19, a9
  v_accvgpr_read_b32 v20, a10
  v_accvgpr_read_b32 v21, a11
  v_mul_f32 v18, v18, v16
  v_mul_f32 v19, v19, v16
  v_mul_f32 v20, v20, v16
  v_mul_f32 v21, v21, v16
  v_cvt_pk_bf16_f32 v28, v18, v19
  v_cvt_pk_bf16_f32 v29, v20, v21
  v_accvgpr_read_b32 v18, a12
  v_accvgpr_read_b32 v19, a13
  v_accvgpr_read_b32 v20, a14
  v_accvgpr_read_b32 v21, a15
  v_mul_f32 v18, v18, v16
  v_mul_f32 v19, v19, v16
  v_mul_f32 v20, v20, v16
  v_mul_f32 v21, v21, v16
  v_cvt_pk_bf16_f32 v30, v18, v19
  v_cvt_pk_bf16_f32 v31, v20, v21
  s_nop 1
  v_permlane32_swap_b32 v28, v30
  v_permlane32_swap_b32 v29, v31
  buffer_store_dwordx4 v[28:31], v15, s[12:15], s29 offen offset:32
  v_accvgpr_read_b32 v18, a16
  v_accvgpr_read_b32 v19, a17
  v_accvgpr_read_b32 v20, a18
  v_accvgpr_read_b32 v21, a19
  v_mul_f32 v18, v18, v16
  v_mul_f32 v19, v19, v16
  v_mul_f32 v20, v20, v16
  v_mul_f32 v21, v21, v16
  v_cvt_pk_bf16_f32 v32, v18, v19
  v_cvt_pk_bf16_f32 v33, v20, v21
  v_accvgpr_read_b32 v18, a20
  v_accvgpr_read_b32 v19, a21
  v_accvgpr_read_b32 v20, a22
  v_accvgpr_read_b32 v21, a23
  v_mul_f32 v18, v18, v16
  v_mul_f32 v19, v19, v16
  v_mul_f32 v20, v20, v16
  v_mul_f32 v21, v21, v16
  v_cvt_pk_bf16_f32 v34, v18, v19
  v_cvt_pk_bf16_f32 v35, v20, v21
  s_nop 1
  v_permlane32_swap_b32 v32, v34
  v_permlane32_swap_b32 v33, v35
  buffer_store_dwordx4 v[32:35], v15, s[12:15], s29 offen offset:64
  v_accvgpr_read_b32 v18, a24
  v_accvgpr_read_b32 v19, a25
  v_accvgpr_read_b32 v20, a26
  v_accvgpr_read_b32 v21, a27
  v_mul_f32 v18, v18, v16
  v_mul_f32 v19, v19, v16
  v_mul_f32 v20, v20, v16
  v_mul_f32 v21, v21, v16
  v_cvt_pk_bf16_f32 v36, v18, v19
  v_cvt_pk_bf16_f32 v37, v20, v21
  v_accvgpr_read_b32 v18, a28
  v_accvgpr_read_b32 v19, a29
  v_accvgpr_read_b32 v20, a30
  v_accvgpr_read_b32 v21, a31
  v_mul_f32 v18, v18, v16
  v_mul_f32 v19, v19, v16
  v_mul_f32 v20, v20, v16
  v_mul_f32 v21, v21, v16
  v_cvt_pk_bf16_f32 v38, v18, v19
  v_cvt_pk_bf16_f32 v39, v20, v21
  s_nop 1
  v_permlane32_swap_b32 v36, v38
  v_permlane32_swap_b32 v37, v39
  buffer_store_dwordx4 v[36:39], v15, s[12:15], s29 offen offset:96
  v_accvgpr_read_b32 v18, a32
  v_accvgpr_read_b32 v19, a33
  v_accvgpr_read_b32 v20, a34
  v_accvgpr_read_b32 v21, a35
  v_mul_f32 v18, v18, v16
  v_mul_f32 v19, v19, v16
  v_mul_f32 v20, v20, v16
  v_mul_f32 v21, v21, v16
  v_cvt_pk_bf16_f32 v40, v18, v19
  v_cvt_pk_bf16_f32 v41, v20, v21
  v_accvgpr_read_b32 v18, a36
  v_accvgpr_read_b32 v19, a37
  v_accvgpr_read_b32 v20, a38
  v_accvgpr_read_b32 v21, a39
  v_mul_f32 v18, v18, v16
  v_mul_f32 v19, v19, v16
  v_mul_f32 v20, v20, v16
  v_mul_f32 v21, v21, v16
  v_cvt_pk_bf16_f32 v42, v18, v19
  v_cvt_pk_bf16_f32 v43, v20, v21
  s_nop 1
  v_permlane32_swap_b32 v40, v42
  v_permlane32_swap_b32 v41, v43
  buffer_store_dwordx4 v[40:43], v15, s[12:15], s29 offen offset:128
  v_accvgpr_read_b32 v18, a40
  v_accvgpr_read_b32 v19, a41
  v_accvgpr_read_b32 v20, a42
  v_accvgpr_read_b32 v21, a43
  v_mul_f32 v18, v18, v16
  v_mul_f32 v19, v19, v16
  v_mul_f32 v20, v20, v16
  v_mul_f32 v21, v21, v16
  v_cvt_pk_bf16_f32 v44, v18, v19
  v_cvt_pk_bf16_f32 v45, v20, v21
  v_accvgpr_read_b32 v18, a44
  v_accvgpr_read_b32 v19, a45
  v_accvgpr_read_b32 v20, a46
  v_accvgpr_read_b32 v21, a47
  v_mul_f32 v18, v18, v16
  v_mul_f32 v19, v19, v16
  v_mul_f32 v20, v20, v16
  v_mul_f32 v21, v21, v16
  v_cvt_pk_bf16_f32 v46, v18, v19
  v_cvt_pk_bf16_f32 v47, v20, v21
  s_nop 1
  v_permlane32_swap_b32 v44, v46
  v_permlane32_swap_b32 v45, v47
  buffer_store_dwordx4 v[44:47], v15, s[12:15], s29 offen offset:160
  s_lshl_b32 s29, s16, 2
  s_add_u32 s29, s29, 1
  s_mul_i32 s29, s29, 6144
  s_add_u32 s29, s29, s18
  v_mov_b32 v17, v5
  v_mov_b32 v16, v5
  s_nop 1
  v_permlane32_swap_b32 v16, v17
  s_nop 1
  v_add_f32 v16, v16, v17
  v_rcp_f32 v16, v16
  s_nop 1
  v_accvgpr_read_b32 v18, a48
  v_accvgpr_read_b32 v19, a49
  v_accvgpr_read_b32 v20, a50
  v_accvgpr_read_b32 v21, a51
  v_mul_f32 v18, v18, v16
  v_mul_f32 v19, v19, v16
  v_mul_f32 v20, v20, v16
  v_mul_f32 v21, v21, v16
  v_cvt_pk_bf16_f32 v48, v18, v19
  v_cvt_pk_bf16_f32 v49, v20, v21
  v_accvgpr_read_b32 v18, a52
  v_accvgpr_read_b32 v19, a53
  v_accvgpr_read_b32 v20, a54
  v_accvgpr_read_b32 v21, a55
  v_mul_f32 v18, v18, v16
  v_mul_f32 v19, v19, v16
  v_mul_f32 v20, v20, v16
  v_mul_f32 v21, v21, v16
  v_cvt_pk_bf16_f32 v50, v18, v19
  v_cvt_pk_bf16_f32 v51, v20, v21
  s_nop 1
  v_permlane32_swap_b32 v48, v50
  v_permlane32_swap_b32 v49, v51
  buffer_store_dwordx4 v[48:51], v15, s[12:15], s29 offen offset:0
  v_accvgpr_read_b32 v18, a56
  v_accvgpr_read_b32 v19, a57
  v_accvgpr_read_b32 v20, a58
  v_accvgpr_read_b32 v21, a59
  v_mul_f32 v18, v18, v16
  v_mul_f32 v19, v19, v16
  v_mul_f32 v20, v20, v16
  v_mul_f32 v21, v21, v16
  v_cvt_pk_bf16_f32 v52, v18, v19
  v_cvt_pk_bf16_f32 v53, v20, v21
  v_accvgpr_read_b32 v18, a60
  v_accvgpr_read_b32 v19, a61
  v_accvgpr_read_b32 v20, a62
  v_accvgpr_read_b32 v21, a63
  v_mul_f32 v18, v18, v16
  v_mul_f32 v19, v19, v16
  v_mul_f32 v20, v20, v16
  v_mul_f32 v21, v21, v16
  v_cvt_pk_bf16_f32 v54, v18, v19
  v_cvt_pk_bf16_f32 v55, v20, v21
  s_nop 1
  v_permlane32_swap_b32 v52, v54
  v_permlane32_swap_b32 v53, v55
  buffer_store_dwordx4 v[52:55], v15, s[12:15], s29 offen offset:32
  v_accvgpr_read_b32 v18, a64
  v_accvgpr_read_b32 v19, a65
  v_accvgpr_read_b32 v20, a66
  v_accvgpr_read_b32 v21, a67
  v_mul_f32 v18, v18, v16
  v_mul_f32 v19, v19, v16
  v_mul_f32 v20, v20, v16
  v_mul_f32 v21, v21, v16
  v_cvt_pk_bf16_f32 v56, v18, v19
  v_cvt_pk_bf16_f32 v57, v20, v21
  v_accvgpr_read_b32 v18, a68
  v_accvgpr_read_b32 v19, a69
  v_accvgpr_read_b32 v20, a70
  v_accvgpr_read_b32 v21, a71
  v_mul_f32 v18, v18, v16
  v_mul_f32 v19, v19, v16
  v_mul_f32 v20, v20, v16
  v_mul_f32 v21, v21, v16
  v_cvt_pk_bf16_f32 v58, v18, v19
  v_cvt_pk_bf16_f32 v59, v20, v21
  s_nop 1
  v_permlane32_swap_b32 v56, v58
  v_permlane32_swap_b32 v57, v59
  buffer_store_dwordx4 v[56:59], v15, s[12:15], s29 offen offset:64
  v_accvgpr_read_b32 v18, a72
  v_accvgpr_read_b32 v19, a73
  v_accvgpr_read_b32 v20, a74
  v_accvgpr_read_b32 v21, a75
  v_mul_f32 v18, v18, v16
  v_mul_f32 v19, v19, v16
  v_mul_f32 v20, v20, v16
  v_mul_f32 v21, v21, v16
  v_cvt_pk_bf16_f32 v60, v18, v19
  v_cvt_pk_bf16_f32 v61, v20, v21
  v_accvgpr_read_b32 v18, a76
  v_accvgpr_read_b32 v19, a77
  v_accvgpr_read_b32 v20, a78
  v_accvgpr_read_b32 v21, a79
  v_mul_f32 v18, v18, v16
  v_mul_f32 v19, v19, v16
  v_mul_f32 v20, v20, v16
  v_mul_f32 v21, v21, v16
  v_cvt_pk_bf16_f32 v62, v18, v19
  v_cvt_pk_bf16_f32 v63, v20, v21
  s_nop 1
  v_permlane32_swap_b32 v60, v62
  v_permlane32_swap_b32 v61, v63
  buffer_store_dwordx4 v[60:63], v15, s[12:15], s29 offen offset:96
  v_accvgpr_read_b32 v18, a80
  v_accvgpr_read_b32 v19, a81
  v_accvgpr_read_b32 v20, a82
  v_accvgpr_read_b32 v21, a83
  v_mul_f32 v18, v18, v16
  v_mul_f32 v19, v19, v16
  v_mul_f32 v20, v20, v16
  v_mul_f32 v21, v21, v16
  v_cvt_pk_bf16_f32 v64, v18, v19
  v_cvt_pk_bf16_f32 v65, v20, v21
  v_accvgpr_read_b32 v18, a84
  v_accvgpr_read_b32 v19, a85
  v_accvgpr_read_b32 v20, a86
  v_accvgpr_read_b32 v21, a87
  v_mul_f32 v18, v18, v16
  v_mul_f32 v19, v19, v16
  v_mul_f32 v20, v20, v16
  v_mul_f32 v21, v21, v16
  v_cvt_pk_bf16_f32 v66, v18, v19
  v_cvt_pk_bf16_f32 v67, v20, v21
  s_nop 1
  v_permlane32_swap_b32 v64, v66
  v_permlane32_swap_b32 v65, v67
  buffer_store_dwordx4 v[64:67], v15, s[12:15], s29 offen offset:128
  v_accvgpr_read_b32 v18, a88
  v_accvgpr_read_b32 v19, a89
  v_accvgpr_read_b32 v20, a90
  v_accvgpr_read_b32 v21, a91
  v_mul_f32 v18, v18, v16
  v_mul_f32 v19, v19, v16
  v_mul_f32 v20, v20, v16
  v_mul_f32 v21, v21, v16
  v_cvt_pk_bf16_f32 v68, v18, v19
  v_cvt_pk_bf16_f32 v69, v20, v21
  v_accvgpr_read_b32 v18, a92
  v_accvgpr_read_b32 v19, a93
  v_accvgpr_read_b32 v20, a94
  v_accvgpr_read_b32 v21, a95
  v_mul_f32 v18, v18, v16
  v_mul_f32 v19, v19, v16
  v_mul_f32 v20, v20, v16
  v_mul_f32 v21, v21, v16
  v_cvt_pk_bf16_f32 v70, v18, v19
  v_cvt_pk_bf16_f32 v71, v20, v21
  s_nop 1
  v_permlane32_swap_b32 v68, v70
  v_permlane32_swap_b32 v69, v71
  buffer_store_dwordx4 v[68:71], v15, s[12:15], s29 offen offset:160
  s_lshl_b32 s29, s16, 2
  s_add_u32 s29, s29, 2
  s_mul_i32 s29, s29, 6144
  s_add_u32 s29, s29, s18
  v_mov_b32 v17, v6
  v_mov_b32 v16, v6
  s_nop 1
  v_permlane32_swap_b32 v16, v17
  s_nop 1
  v_add_f32 v16, v16, v17
  v_rcp_f32 v16, v16
  s_nop 1
  v_accvgpr_read_b32 v18, a96
  v_accvgpr_read_b32 v19, a97
  v_accvgpr_read_b32 v20, a98
  v_accvgpr_read_b32 v21, a99
  v_mul_f32 v18, v18, v16
  v_mul_f32 v19, v19, v16
  v_mul_f32 v20, v20, v16
  v_mul_f32 v21, v21, v16
  v_cvt_pk_bf16_f32 v72, v18, v19
  v_cvt_pk_bf16_f32 v73, v20, v21
  v_accvgpr_read_b32 v18, a100
  v_accvgpr_read_b32 v19, a101
  v_accvgpr_read_b32 v20, a102
  v_accvgpr_read_b32 v21, a103
  v_mul_f32 v18, v18, v16
  v_mul_f32 v19, v19, v16
  v_mul_f32 v20, v20, v16
  v_mul_f32 v21, v21, v16
  v_cvt_pk_bf16_f32 v74, v18, v19
  v_cvt_pk_bf16_f32 v75, v20, v21
  s_nop 1
  v_permlane32_swap_b32 v72, v74
  v_permlane32_swap_b32 v73, v75
  buffer_store_dwordx4 v[72:75], v15, s[12:15], s29 offen offset:0
  v_accvgpr_read_b32 v18, a104
  v_accvgpr_read_b32 v19, a105
  v_accvgpr_read_b32 v20, a106
  v_accvgpr_read_b32 v21, a107
  v_mul_f32 v18, v18, v16
  v_mul_f32 v19, v19, v16
  v_mul_f32 v20, v20, v16
  v_mul_f32 v21, v21, v16
  v_cvt_pk_bf16_f32 v76, v18, v19
  v_cvt_pk_bf16_f32 v77, v20, v21
  v_accvgpr_read_b32 v18, a108
  v_accvgpr_read_b32 v19, a109
  v_accvgpr_read_b32 v20, a110
  v_accvgpr_read_b32 v21, a111
  v_mul_f32 v18, v18, v16
  v_mul_f32 v19, v19, v16
  v_mul_f32 v20, v20, v16
  v_mul_f32 v21, v21, v16
  v_cvt_pk_bf16_f32 v78, v18, v19
  v_cvt_pk_bf16_f32 v79, v20, v21
  s_nop 1
  v_permlane32_swap_b32 v76, v78
  v_permlane32_swap_b32 v77, v79
  buffer_store_dwordx4 v[76:79], v15, s[12:15], s29 offen offset:32
  v_accvgpr_read_b32 v18, a112
  v_accvgpr_read_b32 v19, a113
  v_accvgpr_read_b32 v20, a114
  v_accvgpr_read_b32 v21, a115
  v_mul_f32 v18, v18, v16
  v_mul_f32 v19, v19, v16
  v_mul_f32 v20, v20, v16
  v_mul_f32 v21, v21, v16
  v_cvt_pk_bf16_f32 v80, v18, v19
  v_cvt_pk_bf16_f32 v81, v20, v21
  v_accvgpr_read_b32 v18, a116
  v_accvgpr_read_b32 v19, a117
  v_accvgpr_read_b32 v20, a118
  v_accvgpr_read_b32 v21, a119
  v_mul_f32 v18, v18, v16
  v_mul_f32 v19, v19, v16
  v_mul_f32 v20, v20, v16
  v_mul_f32 v21, v21, v16
  v_cvt_pk_bf16_f32 v82, v18, v19
  v_cvt_pk_bf16_f32 v83, v20, v21
  s_nop 1
  v_permlane32_swap_b32 v80, v82
  v_permlane32_swap_b32 v81, v83
  buffer_store_dwordx4 v[80:83], v15, s[12:15], s29 offen offset:64
  v_accvgpr_read_b32 v18, a120
  v_accvgpr_read_b32 v19, a121
  v_accvgpr_read_b32 v20, a122
  v_accvgpr_read_b32 v21, a123
  v_mul_f32 v18, v18, v16
  v_mul_f32 v19, v19, v16
  v_mul_f32 v20, v20, v16
  v_mul_f32 v21, v21, v16
  v_cvt_pk_bf16_f32 v84, v18, v19
  v_cvt_pk_bf16_f32 v85, v20, v21
  v_accvgpr_read_b32 v18, a124
  v_accvgpr_read_b32 v19, a125
  v_accvgpr_read_b32 v20, a126
  v_accvgpr_read_b32 v21, a127
  v_mul_f32 v18, v18, v16
  v_mul_f32 v19, v19, v16
  v_mul_f32 v20, v20, v16
  v_mul_f32 v21, v21, v16
  v_cvt_pk_bf16_f32 v86, v18, v19
  v_cvt_pk_bf16_f32 v87, v20, v21
  s_nop 1
  v_permlane32_swap_b32 v84, v86
  v_permlane32_swap_b32 v85, v87
  buffer_store_dwordx4 v[84:87], v15, s[12:15], s29 offen offset:96
  v_accvgpr_read_b32 v18, a128
  v_accvgpr_read_b32 v19, a129
  v_accvgpr_read_b32 v20, a130
  v_accvgpr_read_b32 v21, a131
  v_mul_f32 v18, v18, v16
  v_mul_f32 v19, v19, v16
  v_mul_f32 v20, v20, v16
  v_mul_f32 v21, v21, v16
  v_cvt_pk_bf16_f32 v88, v18, v19
  v_cvt_pk_bf16_f32 v89, v20, v21
  v_accvgpr_read_b32 v18, a132
  v_accvgpr_read_b32 v19, a133
  v_accvgpr_read_b32 v20, a134
  v_accvgpr_read_b32 v21, a135
  v_mul_f32 v18, v18, v16
  v_mul_f32 v19, v19, v16
  v_mul_f32 v20, v20, v16
  v_mul_f32 v21, v21, v16
  v_cvt_pk_bf16_f32 v90, v18, v19
  v_cvt_pk_bf16_f32 v91, v20, v21
  s_nop 1
  v_permlane32_swap_b32 v88, v90
  v_permlane32_swap_b32 v89, v91
  buffer_store_dwordx4 v[88:91], v15, s[12:15], s29 offen offset:128
  v_accvgpr_read_b32 v18, a136
  v_accvgpr_read_b32 v19, a137
  v_accvgpr_read_b32 v20, a138
  v_accvgpr_read_b32 v21, a139
  v_mul_f32 v18, v18, v16
  v_mul_f32 v19, v19, v16
  v_mul_f32 v20, v20, v16
  v_mul_f32 v21, v21, v16
  v_cvt_pk_bf16_f32 v92, v18, v19
  v_cvt_pk_bf16_f32 v93, v20, v21
  v_accvgpr_read_b32 v18, a140
  v_accvgpr_read_b32 v19, a141
  v_accvgpr_read_b32 v20, a142
  v_accvgpr_read_b32 v21, a143
  v_mul_f32 v18, v18, v16
  v_mul_f32 v19, v19, v16
  v_mul_f32 v20, v20, v16
  v_mul_f32 v21, v21, v16
  v_cvt_pk_bf16_f32 v94, v18, v19
  v_cvt_pk_bf16_f32 v95, v20, v21
  s_nop 1
  v_permlane32_swap_b32 v92, v94
  v_permlane32_swap_b32 v93, v95
  buffer_store_dwordx4 v[92:95], v15, s[12:15], s29 offen offset:160
  s_lshl_b32 s29, s16, 2
  s_add_u32 s29, s29, 3
  s_mul_i32 s29, s29, 6144
  s_add_u32 s29, s29, s18
  v_mov_b32 v17, v7
  v_mov_b32 v16, v7
  s_nop 1
  v_permlane32_swap_b32 v16, v17
  s_nop 1
  v_add_f32 v16, v16, v17
  v_rcp_f32 v16, v16
  s_nop 1
  v_accvgpr_read_b32 v18, a144
  v_accvgpr_read_b32 v19, a145
  v_accvgpr_read_b32 v20, a146
  v_accvgpr_read_b32 v21, a147
  v_mul_f32 v18, v18, v16
  v_mul_f32 v19, v19, v16
  v_mul_f32 v20, v20, v16
  v_mul_f32 v21, v21, v16
  v_cvt_pk_bf16_f32 v96, v18, v19
  v_cvt_pk_bf16_f32 v97, v20, v21
  v_accvgpr_read_b32 v18, a148
  v_accvgpr_read_b32 v19, a149
  v_accvgpr_read_b32 v20, a150
  v_accvgpr_read_b32 v21, a151
  v_mul_f32 v18, v18, v16
  v_mul_f32 v19, v19, v16
  v_mul_f32 v20, v20, v16
  v_mul_f32 v21, v21, v16
  v_cvt_pk_bf16_f32 v98, v18, v19
  v_cvt_pk_bf16_f32 v99, v20, v21
  s_nop 1
  v_permlane32_swap_b32 v96, v98
  v_permlane32_swap_b32 v97, v99
  buffer_store_dwordx4 v[96:99], v15, s[12:15], s29 offen offset:0
  v_accvgpr_read_b32 v18, a152
  v_accvgpr_read_b32 v19, a153
  v_accvgpr_read_b32 v20, a154
  v_accvgpr_read_b32 v21, a155
  v_mul_f32 v18, v18, v16
  v_mul_f32 v19, v19, v16
  v_mul_f32 v20, v20, v16
  v_mul_f32 v21, v21, v16
  v_cvt_pk_bf16_f32 v100, v18, v19
  v_cvt_pk_bf16_f32 v101, v20, v21
  v_accvgpr_read_b32 v18, a156
  v_accvgpr_read_b32 v19, a157
  v_accvgpr_read_b32 v20, a158
  v_accvgpr_read_b32 v21, a159
  v_mul_f32 v18, v18, v16
  v_mul_f32 v19, v19, v16
  v_mul_f32 v20, v20, v16
  v_mul_f32 v21, v21, v16
  v_cvt_pk_bf16_f32 v102, v18, v19
  v_cvt_pk_bf16_f32 v103, v20, v21
  s_nop 1
  v_permlane32_swap_b32 v100, v102
  v_permlane32_swap_b32 v101, v103
  buffer_store_dwordx4 v[100:103], v15, s[12:15], s29 offen offset:32
  v_accvgpr_read_b32 v18, a160
  v_accvgpr_read_b32 v19, a161
  v_accvgpr_read_b32 v20, a162
  v_accvgpr_read_b32 v21, a163
  v_mul_f32 v18, v18, v16
  v_mul_f32 v19, v19, v16
  v_mul_f32 v20, v20, v16
  v_mul_f32 v21, v21, v16
  v_cvt_pk_bf16_f32 v104, v18, v19
  v_cvt_pk_bf16_f32 v105, v20, v21
  v_accvgpr_read_b32 v18, a164
  v_accvgpr_read_b32 v19, a165
  v_accvgpr_read_b32 v20, a166
  v_accvgpr_read_b32 v21, a167
  v_mul_f32 v18, v18, v16
  v_mul_f32 v19, v19, v16
  v_mul_f32 v20, v20, v16
  v_mul_f32 v21, v21, v16
  v_cvt_pk_bf16_f32 v106, v18, v19
  v_cvt_pk_bf16_f32 v107, v20, v21
  s_nop 1
  v_permlane32_swap_b32 v104, v106
  v_permlane32_swap_b32 v105, v107
  buffer_store_dwordx4 v[104:107], v15, s[12:15], s29 offen offset:64
  v_accvgpr_read_b32 v18, a168
  v_accvgpr_read_b32 v19, a169
  v_accvgpr_read_b32 v20, a170
  v_accvgpr_read_b32 v21, a171
  v_mul_f32 v18, v18, v16
  v_mul_f32 v19, v19, v16
  v_mul_f32 v20, v20, v16
  v_mul_f32 v21, v21, v16
  v_cvt_pk_bf16_f32 v108, v18, v19
  v_cvt_pk_bf16_f32 v109, v20, v21
  v_accvgpr_read_b32 v18, a172
  v_accvgpr_read_b32 v19, a173
  v_accvgpr_read_b32 v20, a174
  v_accvgpr_read_b32 v21, a175
  v_mul_f32 v18, v18, v16
  v_mul_f32 v19, v19, v16
  v_mul_f32 v20, v20, v16
  v_mul_f32 v21, v21, v16
  v_cvt_pk_bf16_f32 v110, v18, v19
  v_cvt_pk_bf16_f32 v111, v20, v21
  s_nop 1
  v_permlane32_swap_b32 v108, v110
  v_permlane32_swap_b32 v109, v111
  buffer_store_dwordx4 v[108:111], v15, s[12:15], s29 offen offset:96
  v_accvgpr_read_b32 v18, a176
  v_accvgpr_read_b32 v19, a177
  v_accvgpr_read_b32 v20, a178
  v_accvgpr_read_b32 v21, a179
  v_mul_f32 v18, v18, v16
  v_mul_f32 v19, v19, v16
  v_mul_f32 v20, v20, v16
  v_mul_f32 v21, v21, v16
  v_cvt_pk_bf16_f32 v112, v18, v19
  v_cvt_pk_bf16_f32 v113, v20, v21
  v_accvgpr_read_b32 v18, a180
  v_accvgpr_read_b32 v19, a181
  v_accvgpr_read_b32 v20, a182
  v_accvgpr_read_b32 v21, a183
  v_mul_f32 v18, v18, v16
  v_mul_f32 v19, v19, v16
  v_mul_f32 v20, v20, v16
  v_mul_f32 v21, v21, v16
  v_cvt_pk_bf16_f32 v114, v18, v19
  v_cvt_pk_bf16_f32 v115, v20, v21
  s_nop 1
  v_permlane32_swap_b32 v112, v114
  v_permlane32_swap_b32 v113, v115
  buffer_store_dwordx4 v[112:115], v15, s[12:15], s29 offen offset:128
  v_accvgpr_read_b32 v18, a184
  v_accvgpr_read_b32 v19, a185
  v_accvgpr_read_b32 v20, a186
  v_accvgpr_read_b32 v21, a187
  v_mul_f32 v18, v18, v16
  v_mul_f32 v19, v19, v16
  v_mul_f32 v20, v20, v16
  v_mul_f32 v21, v21, v16
  v_cvt_pk_bf16_f32 v116, v18, v19
  v_cvt_pk_bf16_f32 v117, v20, v21
  v_accvgpr_read_b32 v18, a188
  v_accvgpr_read_b32 v19, a189
  v_accvgpr_read_b32 v20, a190
  v_accvgpr_read_b32 v21, a191
  v_mul_f32 v18, v18, v16
  v_mul_f32 v19, v19, v16
  v_mul_f32 v20, v20, v16
  v_mul_f32 v21, v21, v16
  v_cvt_pk_bf16_f32 v118, v18, v19
  v_cvt_pk_bf16_f32 v119, v20, v21
  s_nop 1
  v_permlane32_swap_b32 v116, v118
  v_permlane32_swap_b32 v117, v119
  buffer_store_dwordx4 v[116:119], v15, s[12:15], s29 offen offset:160
  v_accvgpr_read_b32 v208, a192
  v_accvgpr_read_b32 v209, a193
  v_accvgpr_read_b32 v210, a194
  v_accvgpr_read_b32 v211, a195
  v_accvgpr_read_b32 v212, a196
  v_accvgpr_read_b32 v213, a197
  v_accvgpr_read_b32 v214, a198
  v_accvgpr_read_b32 v215, a199
  v_accvgpr_read_b32 v216, a200
  v_accvgpr_read_b32 v217, a201
  v_accvgpr_read_b32 v218, a202
  v_accvgpr_read_b32 v219, a203
  v_accvgpr_read_b32 v220, a204
  v_accvgpr_read_b32 v221, a205
  v_accvgpr_read_b32 v222, a206
  v_accvgpr_read_b32 v223, a207
  v_accvgpr_read_b32 v224, a208
  v_accvgpr_read_b32 v225, a209
  v_accvgpr_read_b32 v226, a210
  v_accvgpr_read_b32 v227, a211
  v_accvgpr_read_b32 v228, a212
  v_accvgpr_read_b32 v229, a213
  v_accvgpr_read_b32 v230, a214
  v_accvgpr_read_b32 v231, a215
  v_accvgpr_read_b32 v232, a216
  v_accvgpr_read_b32 v233, a217
  v_accvgpr_read_b32 v234, a218
  v_accvgpr_read_b32 v235, a219
  v_accvgpr_read_b32 v236, a220
  v_accvgpr_read_b32 v237, a221
  v_accvgpr_read_b32 v238, a222
  v_accvgpr_read_b32 v239, a223
  v_accvgpr_read_b32 v240, a224
  v_accvgpr_read_b32 v241, a225
  v_accvgpr_read_b32 v242, a226
  v_accvgpr_read_b32 v243, a227
  v_accvgpr_read_b32 v244, a228
  v_accvgpr_read_b32 v245, a229
  v_accvgpr_read_b32 v246, a230
  v_accvgpr_read_b32 v247, a231
  v_accvgpr_read_b32 v248, a232
  v_accvgpr_read_b32 v249, a233
  v_accvgpr_read_b32 v250, a234
  v_accvgpr_read_b32 v251, a235
  v_accvgpr_read_b32 v252, a236
  v_accvgpr_read_b32 v253, a237
  v_accvgpr_read_b32 v254, a238
  v_accvgpr_read_b32 v255, a239
  s_lshr_b32 s29, s16, 1
  s_mul_i32 s29, s29, 16384
  v_add_u32 v18, s29, v14
  s_barrier
  s_cmp_eq_u32 s17, 0
  s_cbranch_scc1 Lmerge_even
  ds_write_b128 v18, v[208:211] offset:0
  ds_write_b128 v18, v[212:215] offset:1024
  ds_write_b128 v18, v[216:219] offset:2048
  ds_write_b128 v18, v[220:223] offset:3072
  ds_write_b128 v18, v[224:227] offset:4096
  ds_write_b128 v18, v[228:231] offset:5120
  ds_write_b128 v18, v[232:235] offset:6144
  ds_write_b128 v18, v[236:239] offset:7168
  ds_write_b128 v18, v[240:243] offset:8192
  ds_write_b128 v18, v[244:247] offset:9216
  ds_write_b128 v18, v[248:251] offset:10240
  ds_write_b128 v18, v[252:255] offset:11264
  v_mov_b32 v20, v8
  v_mov_b32 v21, v13
  v_mov_b32 v22, 0
  v_mov_b32 v23, 0
  ds_write_b128 v18, v[20:23] offset:12288
  s_waitcnt lgkmcnt(0)
  s_barrier
  s_branch Lattn_end
Lmerge_even:
  s_barrier
  ds_read_b128 v[144:147], v18 offset:0
  ds_read_b128 v[148:151], v18 offset:1024
  ds_read_b128 v[152:155], v18 offset:2048
  ds_read_b128 v[156:159], v18 offset:3072
  ds_read_b128 v[160:163], v18 offset:4096
  ds_read_b128 v[164:167], v18 offset:5120
  ds_read_b128 v[168:171], v18 offset:6144
  ds_read_b128 v[172:175], v18 offset:7168
  ds_read_b128 v[176:179], v18 offset:8192
  ds_read_b128 v[180:183], v18 offset:9216
  ds_read_b128 v[184:187], v18 offset:10240
  ds_read_b128 v[188:191], v18 offset:11264
  ds_read_b128 v[20:23], v18 offset:12288
  s_waitcnt lgkmcnt(0)
  v_min_f32 v22, v13, v21
  v_sub_f32 v16, v22, v13
  v_sub_f32 v17, v22, v21
  v_exp_f32 v16, v16
  v_exp_f32 v17, v17
  s_nop 1
  v_mul_f32 v208, v208, v16
  v_fmac_f32 v208, v144, v17
  v_mul_f32 v209, v209, v16
  v_fmac_f32 v209, v145, v17
  v_mul_f32 v210, v210, v16
  v_fmac_f32 v210, v146, v17
  v_mul_f32 v211, v211, v16
  v_fmac_f32 v211, v147, v17
  v_mul_f32 v212, v212, v16
  v_fmac_f32 v212, v148, v17
  v_mul_f32 v213, v213, v16
  v_fmac_f32 v213, v149, v17
  v_mul_f32 v214, v214, v16
  v_fmac_f32 v214, v150, v17
  v_mul_f32 v215, v215, v16
  v_fmac_f32 v215, v151, v17
  v_mul_f32 v216, v216, v16
  v_fmac_f32 v216, v152, v17
  v_mul_f32 v217, v217, v16
  v_fmac_f32 v217, v153, v17
  v_mul_f32 v218, v218, v16
  v_fmac_f32 v218, v154, v17
  v_mul_f32 v219, v219, v16
  v_fmac_f32 v219, v155, v17
  v_mul_f32 v220, v220, v16
  v_fmac_f32 v220, v156, v17
  v_mul_f32 v221, v221, v16
  v_fmac_f32 v221, v157, v17
  v_mul_f32 v222, v222, v16
  v_fmac_f32 v222, v158, v17
  v_mul_f32 v223, v223, v16
  v_fmac_f32 v223, v159, v17
  v_mul_f32 v224, v224, v16
  v_fmac_f32 v224, v160, v17
  v_mul_f32 v225, v225, v16
  v_fmac_f32 v225, v161, v17
  v_mul_f32 v226, v226, v16
  v_fmac_f32 v226, v162, v17
  v_mul_f32 v227, v227, v16
  v_fmac_f32 v227, v163, v17
  v_mul_f32 v228, v228, v16
  v_fmac_f32 v228, v164, v17
  v_mul_f32 v229, v229, v16
  v_fmac_f32 v229, v165, v17
  v_mul_f32 v230, v230, v16
  v_fmac_f32 v230, v166, v17
  v_mul_f32 v231, v231, v16
  v_fmac_f32 v231, v167, v17
  v_mul_f32 v232, v232, v16
  v_fmac_f32 v232, v168, v17
  v_mul_f32 v233, v233, v16
  v_fmac_f32 v233, v169, v17
  v_mul_f32 v234, v234, v16
  v_fmac_f32 v234, v170, v17
  v_mul_f32 v235, v235, v16
  v_fmac_f32 v235, v171, v17
  v_mul_f32 v236, v236, v16
  v_fmac_f32 v236, v172, v17
  v_mul_f32 v237, v237, v16
  v_fmac_f32 v237, v173, v17
  v_mul_f32 v238, v238, v16
  v_fmac_f32 v238, v174, v17
  v_mul_f32 v239, v239, v16
  v_fmac_f32 v239, v175, v17
  v_mul_f32 v240, v240, v16
  v_fmac_f32 v240, v176, v17
  v_mul_f32 v241, v241, v16
  v_fmac_f32 v241, v177, v17
  v_mul_f32 v242, v242, v16
  v_fmac_f32 v242, v178, v17
  v_mul_f32 v243, v243, v16
  v_fmac_f32 v243, v179, v17
  v_mul_f32 v244, v244, v16
  v_fmac_f32 v244, v180, v17
  v_mul_f32 v245, v245, v16
  v_fmac_f32 v245, v181, v17
  v_mul_f32 v246, v246, v16
  v_fmac_f32 v246, v182, v17
  v_mul_f32 v247, v247, v16
  v_fmac_f32 v247, v183, v17
  v_mul_f32 v248, v248, v16
  v_fmac_f32 v248, v184, v17
  v_mul_f32 v249, v249, v16
  v_fmac_f32 v249, v185, v17
  v_mul_f32 v250, v250, v16
  v_fmac_f32 v250, v186, v17
  v_mul_f32 v251, v251, v16
  v_fmac_f32 v251, v187, v17
  v_mul_f32 v252, v252, v16
  v_fmac_f32 v252, v188, v17
  v_mul_f32 v253, v253, v16
  v_fmac_f32 v253, v189, v17
  v_mul_f32 v254, v254, v16
  v_fmac_f32 v254, v190, v17
  v_mul_f32 v255, v255, v16
  v_fmac_f32 v255, v191, v17
  v_mul_f32 v8, v8, v16
  v_fmac_f32 v8, v20, v17
  s_lshr_b32 s29, s16, 1
  s_add_u32 s29, s29, 16
  s_mul_i32 s29, s29, 6144
  s_add_u32 s29, s29, s18
  v_mov_b32 v17, v8
  v_mov_b32 v16, v8
  s_nop 1
  v_permlane32_swap_b32 v16, v17
  s_nop 1
  v_add_f32 v16, v16, v17
  v_rcp_f32 v16, v16
  s_nop 1
  v_mov_b32 v18, v208
  v_mov_b32 v19, v209
  v_mov_b32 v20, v210
  v_mov_b32 v21, v211
  v_mul_f32 v18, v18, v16
  v_mul_f32 v19, v19, v16
  v_mul_f32 v20, v20, v16
  v_mul_f32 v21, v21, v16
  v_cvt_pk_bf16_f32 v120, v18, v19
  v_cvt_pk_bf16_f32 v121, v20, v21
  v_mov_b32 v18, v212
  v_mov_b32 v19, v213
  v_mov_b32 v20, v214
  v_mov_b32 v21, v215
  v_mul_f32 v18, v18, v16
  v_mul_f32 v19, v19, v16
  v_mul_f32 v20, v20, v16
  v_mul_f32 v21, v21, v16
  v_cvt_pk_bf16_f32 v122, v18, v19
  v_cvt_pk_bf16_f32 v123, v20, v21
  s_nop 1
  v_permlane32_swap_b32 v120, v122
  v_permlane32_swap_b32 v121, v123
  buffer_store_dwordx4 v[120:123], v15, s[12:15], s29 offen offset:0
  v_mov_b32 v18, v216
  v_mov_b32 v19, v217
  v_mov_b32 v20, v218
  v_mov_b32 v21, v219
  v_mul_f32 v18, v18, v16
  v_mul_f32 v19, v19, v16
  v_mul_f32 v20, v20, v16
  v_mul_f32 v21, v21, v16
  v_cvt_pk_bf16_f32 v124, v18, v19
  v_cvt_pk_bf16_f32 v125, v20, v21
  v_mov_b32 v18, v220
  v_mov_b32 v19, v221
  v_mov_b32 v20, v222
  v_mov_b32 v21, v223
  v_mul_f32 v18, v18, v16
  v_mul_f32 v19, v19, v16
  v_mul_f32 v20, v20, v16
  v_mul_f32 v21, v21, v16
  v_cvt_pk_bf16_f32 v126, v18, v19
  v_cvt_pk_bf16_f32 v127, v20, v21
  s_nop 1
  v_permlane32_swap_b32 v124, v126
  v_permlane32_swap_b32 v125, v127
  buffer_store_dwordx4 v[124:127], v15, s[12:15], s29 offen offset:32
  v_mov_b32 v18, v224
  v_mov_b32 v19, v225
  v_mov_b32 v20, v226
  v_mov_b32 v21, v227
  v_mul_f32 v18, v18, v16
  v_mul_f32 v19, v19, v16
  v_mul_f32 v20, v20, v16
  v_mul_f32 v21, v21, v16
  v_cvt_pk_bf16_f32 v128, v18, v19
  v_cvt_pk_bf16_f32 v129, v20, v21
  v_mov_b32 v18, v228
  v_mov_b32 v19, v229
  v_mov_b32 v20, v230
  v_mov_b32 v21, v231
  v_mul_f32 v18, v18, v16
  v_mul_f32 v19, v19, v16
  v_mul_f32 v20, v20, v16
  v_mul_f32 v21, v21, v16
  v_cvt_pk_bf16_f32 v130, v18, v19
  v_cvt_pk_bf16_f32 v131, v20, v21
  s_nop 1
  v_permlane32_swap_b32 v128, v130
  v_permlane32_swap_b32 v129, v131
  buffer_store_dwordx4 v[128:131], v15, s[12:15], s29 offen offset:64
  v_mov_b32 v18, v232
  v_mov_b32 v19, v233
  v_mov_b32 v20, v234
  v_mov_b32 v21, v235
  v_mul_f32 v18, v18, v16
  v_mul_f32 v19, v19, v16
  v_mul_f32 v20, v20, v16
  v_mul_f32 v21, v21, v16
  v_cvt_pk_bf16_f32 v132, v18, v19
  v_cvt_pk_bf16_f32 v133, v20, v21
  v_mov_b32 v18, v236
  v_mov_b32 v19, v237
  v_mov_b32 v20, v238
  v_mov_b32 v21, v239
  v_mul_f32 v18, v18, v16
  v_mul_f32 v19, v19, v16
  v_mul_f32 v20, v20, v16
  v_mul_f32 v21, v21, v16
  v_cvt_pk_bf16_f32 v134, v18, v19
  v_cvt_pk_bf16_f32 v135, v20, v21
  s_nop 1
  v_permlane32_swap_b32 v132, v134
  v_permlane32_swap_b32 v133, v135
  buffer_store_dwordx4 v[132:135], v15, s[12:15], s29 offen offset:96
  v_mov_b32 v18, v240
  v_mov_b32 v19, v241
  v_mov_b32 v20, v242
  v_mov_b32 v21, v243
  v_mul_f32 v18, v18, v16
  v_mul_f32 v19, v19, v16
  v_mul_f32 v20, v20, v16
  v_mul_f32 v21, v21, v16
  v_cvt_pk_bf16_f32 v136, v18, v19
  v_cvt_pk_bf16_f32 v137, v20, v21
  v_mov_b32 v18, v244
  v_mov_b32 v19, v245
  v_mov_b32 v20, v246
  v_mov_b32 v21, v247
  v_mul_f32 v18, v18, v16
  v_mul_f32 v19, v19, v16
  v_mul_f32 v20, v20, v16
  v_mul_f32 v21, v21, v16
  v_cvt_pk_bf16_f32 v138, v18, v19
  v_cvt_pk_bf16_f32 v139, v20, v21
  s_nop 1
  v_permlane32_swap_b32 v136, v138
  v_permlane32_swap_b32 v137, v139
  buffer_store_dwordx4 v[136:139], v15, s[12:15], s29 offen offset:128
  v_mov_b32 v18, v248
  v_mov_b32 v19, v249
  v_mov_b32 v20, v250
  v_mov_b32 v21, v251
  v_mul_f32 v18, v18, v16
  v_mul_f32 v19, v19, v16
  v_mul_f32 v20, v20, v16
  v_mul_f32 v21, v21, v16
  v_cvt_pk_bf16_f32 v140, v18, v19
  v_cvt_pk_bf16_f32 v141, v20, v21
  v_mov_b32 v18, v252
  v_mov_b32 v19, v253
  v_mov_b32 v20, v254
  v_mov_b32 v21, v255
  v_mul_f32 v18, v18, v16
  v_mul_f32 v19, v19, v16
  v_mul_f32 v20, v20, v16
  v_mul_f32 v21, v21, v16
  v_cvt_pk_bf16_f32 v142, v18, v19
  v_cvt_pk_bf16_f32 v143, v20, v21
  s_nop 1
  v_permlane32_swap_b32 v140, v142
  v_permlane32_swap_b32 v141, v143
  buffer_store_dwordx4 v[140:143], v15, s[12:15], s29 offen offset:160
Lattn_end:
Lattn_exit:
  s_endpgm
Lslow_0:
  s_nop 7
  v_max3_f32 v16, v144, v145, v146
  v_max3_f32 v16, v16, v147, v148
  v_max3_f32 v16, v16, v149, v150
  v_max3_f32 v16, v16, v151, v152
  v_max3_f32 v16, v16, v153, v154
  v_max3_f32 v16, v16, v155, v156
  v_max3_f32 v16, v16, v157, v158
  v_max_f32 v16, v16, v159
  v_mov_b32 v17, v16
  s_nop 1
  v_permlane32_swap_b32 v16, v17
  s_nop 1
  v_max_f32 v16, v16, v17
  v_ceil_f32 v16, v16
  v_max_f32 v16, s26, v16
  v_sub_f32 v9, v9, v16
  v_sub_f32 v144, v144, v16
  v_sub_f32 v145, v145, v16
  v_sub_f32 v146, v146, v16
  v_sub_f32 v147, v147, v16
  v_sub_f32 v148, v148, v16
  v_sub_f32 v149, v149, v16
  v_sub_f32 v150, v150, v16
  v_sub_f32 v151, v151, v16
  v_sub_f32 v152, v152, v16
  v_sub_f32 v153, v153, v16
  v_sub_f32 v154, v154, v16
  v_sub_f32 v155, v155, v16
  v_sub_f32 v156, v156, v16
  v_sub_f32 v157, v157, v16
  v_sub_f32 v158, v158, v16
  v_sub_f32 v159, v159, v16
  v_max_f32 v17, 0, v16
  v_exp_f32_e64 v17, -v17
  s_nop 1
  v_mul_f32 v4, v4, v17
  v_accvgpr_read_b32 v18, a0
  v_mul_f32 v18, v18, v17
  v_accvgpr_write_b32 a0, v18
  v_accvgpr_read_b32 v19, a1
  v_mul_f32 v19, v19, v17
  v_accvgpr_write_b32 a1, v19
  v_accvgpr_read_b32 v18, a2
  v_mul_f32 v18, v18, v17
  v_accvgpr_write_b32 a2, v18
  v_accvgpr_read_b32 v19, a3
  v_mul_f32 v19, v19, v17
  v_accvgpr_write_b32 a3, v19
  v_accvgpr_read_b32 v18, a4
  v_mul_f32 v18, v18, v17
  v_accvgpr_write_b32 a4, v18
  v_accvgpr_read_b32 v19, a5
  v_mul_f32 v19, v19, v17
  v_accvgpr_write_b32 a5, v19
  v_accvgpr_read_b32 v18, a6
  v_mul_f32 v18, v18, v17
  v_accvgpr_write_b32 a6, v18
  v_accvgpr_read_b32 v19, a7
  v_mul_f32 v19, v19, v17
  v_accvgpr_write_b32 a7, v19
  v_accvgpr_read_b32 v18, a8
  v_mul_f32 v18, v18, v17
  v_accvgpr_write_b32 a8, v18
  v_accvgpr_read_b32 v19, a9
  v_mul_f32 v19, v19, v17
  v_accvgpr_write_b32 a9, v19
  v_accvgpr_read_b32 v18, a10
  v_mul_f32 v18, v18, v17
  v_accvgpr_write_b32 a10, v18
  v_accvgpr_read_b32 v19, a11
  v_mul_f32 v19, v19, v17
  v_accvgpr_write_b32 a11, v19
  v_accvgpr_read_b32 v18, a12
  v_mul_f32 v18, v18, v17
  v_accvgpr_write_b32 a12, v18
  v_accvgpr_read_b32 v19, a13
  v_mul_f32 v19, v19, v17
  v_accvgpr_write_b32 a13, v19
  v_accvgpr_read_b32 v18, a14
  v_mul_f32 v18, v18, v17
  v_accvgpr_write_b32 a14, v18
  v_accvgpr_read_b32 v19, a15
  v_mul_f32 v19, v19, v17
  v_accvgpr_write_b32 a15, v19
  v_accvgpr_read_b32 v18, a16
  v_mul_f32 v18, v18, v17
  v_accvgpr_write_b32 a16, v18
  v_accvgpr_read_b32 v19, a17
  v_mul_f32 v19, v19, v17
  v_accvgpr_write_b32 a17, v19
  v_accvgpr_read_b32 v18, a18
  v_mul_f32 v18, v18, v17
  v_accvgpr_write_b32 a18, v18
  v_accvgpr_read_b32 v19, a19
  v_mul_f32 v19, v19, v17
  v_accvgpr_write_b32 a19, v19
  v_accvgpr_read_b32 v18, a20
  v_mul_f32 v18, v18, v17
  v_accvgpr_write_b32 a20, v18
  v_accvgpr_read_b32 v19, a21
  v_mul_f32 v19, v19, v17
  v_accvgpr_write_b32 a21, v19
  v_accvgpr_read_b32 v18, a22
  v_mul_f32 v18, v18, v17
  v_accvgpr_write_b32 a22, v18
  v_accvgpr_read_b32 v19, a23
  v_mul_f32 v19, v19, v17
  v_accvgpr_write_b32 a23, v19
  v_accvgpr_read_b32 v18, a24
  v_mul_f32 v18, v18, v17
  v_accvgpr_write_b32 a24, v18
  v_accvgpr_read_b32 v19, a25
  v_mul_f32 v19, v19, v17
  v_accvgpr_write_b32 a25, v19
  v_accvgpr_read_b32 v18, a26
  v_mul_f32 v18, v18, v17
  v_accvgpr_write_b32 a26, v18
  v_accvgpr_read_b32 v19, a27
  v_mul_f32 v19, v19, v17
  v_accvgpr_write_b32 a27, v19
  v_accvgpr_read_b32 v18, a28
  v_mul_f32 v18, v18, v17
  v_accvgpr_write_b32 a28, v18
  v_accvgpr_read_b32 v19, a29
  v_mul_f32 v19, v19, v17
  v_accvgpr_write_b32 a29, v19
  v_accvgpr_read_b32 v18, a30
  v_mul_f32 v18, v18, v17
  v_accvgpr_write_b32 a30, v18
  v_accvgpr_read_b32 v19, a31
  v_mul_f32 v19, v19, v17
  v_accvgpr_write_b32 a31, v19
  v_accvgpr_read_b32 v18, a32
  v_mul_f32 v18, v18, v17
  v_accvgpr_write_b32 a32, v18
  v_accvgpr_read_b32 v19, a33
  v_mul_f32 v19, v19, v17
  v_accvgpr_write_b32 a33, v19
  v_accvgpr_read_b32 v18, a34
  v_mul_f32 v18, v18, v17
  v_accvgpr_write_b32 a34, v18
  v_accvgpr_read_b32 v19, a35
  v_mul_f32 v19, v19, v17
  v_accvgpr_write_b32 a35, v19
  v_accvgpr_read_b32 v18, a36
  v_mul_f32 v18, v18, v17
  v_accvgpr_write_b32 a36, v18
  v_accvgpr_read_b32 v19, a37
  v_mul_f32 v19, v19, v17
  v_accvgpr_write_b32 a37, v19
  v_accvgpr_read_b32 v18, a38
  v_mul_f32 v18, v18, v17
  v_accvgpr_write_b32 a38, v18
  v_accvgpr_read_b32 v19, a39
  v_mul_f32 v19, v19, v17
  v_accvgpr_write_b32 a39, v19
  v_accvgpr_read_b32 v18, a40
  v_mul_f32 v18, v18, v17
  v_accvgpr_write_b32 a40, v18
  v_accvgpr_read_b32 v19, a41
  v_mul_f32 v19, v19, v17
  v_accvgpr_write_b32 a41, v19
  v_accvgpr_read_b32 v18, a42
  v_mul_f32 v18, v18, v17
  v_accvgpr_write_b32 a42, v18
  v_accvgpr_read_b32 v19, a43
  v_mul_f32 v19, v19, v17
  v_accvgpr_write_b32 a43, v19
  v_accvgpr_read_b32 v18, a44
  v_mul_f32 v18, v18, v17
  v_accvgpr_write_b32 a44, v18
  v_accvgpr_read_b32 v19, a45
  v_mul_f32 v19, v19, v17
  v_accvgpr_write_b32 a45, v19
  v_accvgpr_read_b32 v18, a46
  v_mul_f32 v18, v18, v17
  v_accvgpr_write_b32 a46, v18
  v_accvgpr_read_b32 v19, a47
  v_mul_f32 v19, v19, v17
  v_accvgpr_write_b32 a47, v19
  v_mov_b32 v20, v9
  v_mov_b32 v21, v9
  v_mov_b32 v22, v9
  v_mov_b32 v23, v9
  ds_write_b128 v3, v[20:23] offset:0
  v_exp_f32 v16, v144
  v_exp_f32 v17, v145
  v_exp_f32 v18, v146
  v_exp_f32 v19, v147
  v_add_f32 v0, v16, v17
  v_cvt_pk_bf16_f32 v176, v16, v17
  v_exp_f32 v16, v148
  v_exp_f32 v17, v149
  v_add_f32 v0, v0, v18
  v_add_f32 v0, v0, v19
  v_cvt_pk_bf16_f32 v177, v18, v19
  v_exp_f32 v18, v150
  v_exp_f32 v19, v151
  v_add_f32 v0, v0, v16
  v_add_f32 v0, v0, v17
  v_cvt_pk_bf16_f32 v178, v16, v17
  v_exp_f32 v16, v152
  v_exp_f32 v17, v153
  v_add_f32 v0, v0, v18
  v_add_f32 v0, v0, v19
  v_cvt_pk_bf16_f32 v179, v18, v19
  v_exp_f32 v18, v154
  v_exp_f32 v19, v155
  v_add_f32 v0, v0, v16
  v_add_f32 v0, v0, v17
  v_cvt_pk_bf16_f32 v180, v16, v17
  v_exp_f32 v16, v156
  v_exp_f32 v17, v157
  v_add_f32 v0, v0, v18
  v_add_f32 v0, v0, v19
  v_cvt_pk_bf16_f32 v181, v18, v19
  v_exp_f32 v18, v158
  v_exp_f32 v19, v159
  v_add_f32 v0, v0, v16
  v_add_f32 v0, v0, v17
  v_cvt_pk_bf16_f32 v182, v16, v17
  v_add_f32 v0, v0, v18
  v_add_f32 v0, v0, v19
  v_cvt_pk_bf16_f32 v183, v18, v19
  s_waitcnt lgkmcnt(0)
  s_nop 1
  s_branch Lret_0
Lslow_1:
  s_nop 7
  v_max3_f32 v16, v160, v161, v162
  v_max3_f32 v16, v16, v163, v164
  v_max3_f32 v16, v16, v165, v166
  v_max3_f32 v16, v16, v167, v168
  v_max3_f32 v16, v16, v169, v170
  v_max3_f32 v16, v16, v171, v172
  v_max3_f32 v16, v16, v173, v174
  v_max_f32 v16, v16, v175
  v_mov_b32 v17, v16
  s_nop 1
  v_permlane32_swap_b32 v16, v17
  s_nop 1
  v_max_f32 v16, v16, v17
  v_ceil_f32 v16, v16
  v_max_f32 v16, s26, v16
  v_sub_f32 v10, v10, v16
  v_sub_f32 v160, v160, v16
  v_sub_f32 v161, v161, v16
  v_sub_f32 v162, v162, v16
  v_sub_f32 v163, v163, v16
  v_sub_f32 v164, v164, v16
  v_sub_f32 v165, v165, v16
  v_sub_f32 v166, v166, v16
  v_sub_f32 v167, v167, v16
  v_sub_f32 v168, v168, v16
  v_sub_f32 v169, v169, v16
  v_sub_f32 v170, v170, v16
  v_sub_f32 v171, v171, v16
  v_sub_f32 v172, v172, v16
  v_sub_f32 v173, v173, v16
  v_sub_f32 v174, v174, v16
  v_sub_f32 v175, v175, v16
  v_max_f32 v17, 0, v16
  v_exp_f32_e64 v17, -v17
  s_nop 1
  v_mul_f32 v5, v5, v17
  v_accvgpr_read_b32 v18, a48
  v_mul_f32 v18, v18, v17
  v_accvgpr_write_b32 a48, v18
  v_accvgpr_read_b32 v19, a49
  v_mul_f32 v19, v19, v17
  v_accvgpr_write_b32 a49, v19
  v_accvgpr_read_b32 v18, a50
  v_mul_f32 v18, v18, v17
  v_accvgpr_write_b32 a50, v18
  v_accvgpr_read_b32 v19, a51
  v_mul_f32 v19, v19, v17
  v_accvgpr_write_b32 a51, v19
  v_accvgpr_read_b32 v18, a52
  v_mul_f32 v18, v18, v17
  v_accvgpr_write_b32 a52, v18
  v_accvgpr_read_b32 v19, a53
  v_mul_f32 v19, v19, v17
  v_accvgpr_write_b32 a53, v19
  v_accvgpr_read_b32 v18, a54
  v_mul_f32 v18, v18, v17
  v_accvgpr_write_b32 a54, v18
  v_accvgpr_read_b32 v19, a55
  v_mul_f32 v19, v19, v17
  v_accvgpr_write_b32 a55, v19
  v_accvgpr_read_b32 v18, a56
  v_mul_f32 v18, v18, v17
  v_accvgpr_write_b32 a56, v18
  v_accvgpr_read_b32 v19, a57
  v_mul_f32 v19, v19, v17
  v_accvgpr_write_b32 a57, v19
  v_accvgpr_read_b32 v18, a58
  v_mul_f32 v18, v18, v17
  v_accvgpr_write_b32 a58, v18
  v_accvgpr_read_b32 v19, a59
  v_mul_f32 v19, v19, v17
  v_accvgpr_write_b32 a59, v19
  v_accvgpr_read_b32 v18, a60
  v_mul_f32 v18, v18, v17
  v_accvgpr_write_b32 a60, v18
  v_accvgpr_read_b32 v19, a61
  v_mul_f32 v19, v19, v17
  v_accvgpr_write_b32 a61, v19
  v_accvgpr_read_b32 v18, a62
  v_mul_f32 v18, v18, v17
  v_accvgpr_write_b32 a62, v18
  v_accvgpr_read_b32 v19, a63
  v_mul_f32 v19, v19, v17
  v_accvgpr_write_b32 a63, v19
  v_accvgpr_read_b32 v18, a64
  v_mul_f32 v18, v18, v17
  v_accvgpr_write_b32 a64, v18
  v_accvgpr_read_b32 v19, a65
  v_mul_f32 v19, v19, v17
  v_accvgpr_write_b32 a65, v19
  v_accvgpr_read_b32 v18, a66
  v_mul_f32 v18, v18, v17
  v_accvgpr_write_b32 a66, v18
  v_accvgpr_read_b32 v19, a67
  v_mul_f32 v19, v19, v17
  v_accvgpr_write_b32 a67, v19
  v_accvgpr_read_b32 v18, a68
  v_mul_f32 v18, v18, v17
  v_accvgpr_write_b32 a68, v18
  v_accvgpr_read_b32 v19, a69
  v_mul_f32 v19, v19, v17
  v_accvgpr_write_b32 a69, v19
  v_accvgpr_read_b32 v18, a70
  v_mul_f32 v18, v18, v17
  v_accvgpr_write_b32 a70, v18
  v_accvgpr_read_b32 v19, a71
  v_mul_f32 v19, v19, v17
  v_accvgpr_write_b32 a71, v19
  v_accvgpr_read_b32 v18, a72
  v_mul_f32 v18, v18, v17
  v_accvgpr_write_b32 a72, v18
  v_accvgpr_read_b32 v19, a73
  v_mul_f32 v19, v19, v17
  v_accvgpr_write_b32 a73, v19
  v_accvgpr_read_b32 v18, a74
  v_mul_f32 v18, v18, v17
  v_accvgpr_write_b32 a74, v18
  v_accvgpr_read_b32 v19, a75
  v_mul_f32 v19, v19, v17
  v_accvgpr_write_b32 a75, v19
  v_accvgpr_read_b32 v18, a76
  v_mul_f32 v18, v18, v17
  v_accvgpr_write_b32 a76, v18
  v_accvgpr_read_b32 v19, a77
  v_mul_f32 v19, v19, v17
  v_accvgpr_write_b32 a77, v19
  v_accvgpr_read_b32 v18, a78
  v_mul_f32 v18, v18, v17
  v_accvgpr_write_b32 a78, v18
  v_accvgpr_read_b32 v19, a79
  v_mul_f32 v19, v19, v17
  v_accvgpr_write_b32 a79, v19
  v_accvgpr_read_b32 v18, a80
  v_mul_f32 v18, v18, v17
  v_accvgpr_write_b32 a80, v18
  v_accvgpr_read_b32 v19, a81
  v_mul_f32 v19, v19, v17
  v_accvgpr_write_b32 a81, v19
  v_accvgpr_read_b32 v18, a82
  v_mul_f32 v18, v18, v17
  v_accvgpr_write_b32 a82, v18
  v_accvgpr_read_b32 v19, a83
  v_mul_f32 v19, v19, v17
  v_accvgpr_write_b32 a83, v19
  v_accvgpr_read_b32 v18, a84
  v_mul_f32 v18, v18, v17
  v_accvgpr_write_b32 a84, v18
  v_accvgpr_read_b32 v19, a85
  v_mul_f32 v19, v19, v17
  v_accvgpr_write_b32 a85, v19
  v_accvgpr_read_b32 v18, a86
  v_mul_f32 v18, v18, v17
  v_accvgpr_write_b32 a86, v18
  v_accvgpr_read_b32 v19, a87
  v_mul_f32 v19, v19, v17
  v_accvgpr_write_b32 a87, v19
  v_accvgpr_read_b32 v18, a88
  v_mul_f32 v18, v18, v17
  v_accvgpr_write_b32 a88, v18
  v_accvgpr_read_b32 v19, a89
  v_mul_f32 v19, v19, v17
  v_accvgpr_write_b32 a89, v19
  v_accvgpr_read_b32 v18, a90
  v_mul_f32 v18, v18, v17
  v_accvgpr_write_b32 a90, v18
  v_accvgpr_read_b32 v19, a91
  v_mul_f32 v19, v19, v17
  v_accvgpr_write_b32 a91, v19
  v_accvgpr_read_b32 v18, a92
  v_mul_f32 v18, v18, v17
  v_accvgpr_write_b32 a92, v18
  v_accvgpr_read_b32 v19, a93
  v_mul_f32 v19, v19, v17
  v_accvgpr_write_b32 a93, v19
  v_accvgpr_read_b32 v18, a94
  v_mul_f32 v18, v18, v17
  v_accvgpr_write_b32 a94, v18
  v_accvgpr_read_b32 v19, a95
  v_mul_f32 v19, v19, v17
  v_accvgpr_write_b32 a95, v19
  v_mov_b32 v20, v10
  v_mov_b32 v21, v10
  v_mov_b32 v22, v10
  v_mov_b32 v23, v10
  ds_write_b128 v3, v[20:23] offset:1024
  v_exp_f32 v16, v160
  v_exp_f32 v17, v161
  v_exp_f32 v18, v162
  v_exp_f32 v19, v163
  v_add_f32 v0, v16, v17
  v_cvt_pk_bf16_f32 v184, v16, v17
  v_exp_f32 v16, v164
  v_exp_f32 v17, v165
  v_add_f32 v0, v0, v18
  v_add_f32 v0, v0, v19
  v_cvt_pk_bf16_f32 v185, v18, v19
  v_exp_f32 v18, v166
  v_exp_f32 v19, v167
  v_add_f32 v0, v0, v16
  v_add_f32 v0, v0, v17
  v_cvt_pk_bf16_f32 v186, v16, v17
  v_exp_f32 v16, v168
  v_exp_f32 v17, v169
  v_add_f32 v0, v0, v18
  v_add_f32 v0, v0, v19
  v_cvt_pk_bf16_f32 v187, v18, v19
  v_exp_f32 v18, v170
  v_exp_f32 v19, v171
  v_add_f32 v0, v0, v16
  v_add_f32 v0, v0, v17
  v_cvt_pk_bf16_f32 v188, v16, v17
  v_exp_f32 v16, v172
  v_exp_f32 v17, v173
  v_add_f32 v0, v0, v18
  v_add_f32 v0, v0, v19
  v_cvt_pk_bf16_f32 v189, v18, v19
  v_exp_f32 v18, v174
  v_exp_f32 v19, v175
  v_add_f32 v0, v0, v16
  v_add_f32 v0, v0, v17
  v_cvt_pk_bf16_f32 v190, v16, v17
  v_add_f32 v0, v0, v18
  v_add_f32 v0, v0, v19
  v_cvt_pk_bf16_f32 v191, v18, v19
  s_waitcnt lgkmcnt(0)
  s_nop 1
  s_branch Lret_1
Lslow_2:
  s_nop 7
  v_max3_f32 v16, v144, v145, v146
  v_max3_f32 v16, v16, v147, v148
  v_max3_f32 v16, v16, v149, v150
  v_max3_f32 v16, v16, v151, v152
  v_max3_f32 v16, v16, v153, v154
  v_max3_f32 v16, v16, v155, v156
  v_max3_f32 v16, v16, v157, v158
  v_max_f32 v16, v16, v159
  v_mov_b32 v17, v16
  s_nop 1
  v_permlane32_swap_b32 v16, v17
  s_nop 1
  v_max_f32 v16, v16, v17
  v_ceil_f32 v16, v16
  v_max_f32 v16, s26, v16
  v_sub_f32 v11, v11, v16
  v_sub_f32 v144, v144, v16
  v_sub_f32 v145, v145, v16
  v_sub_f32 v146, v146, v16
  v_sub_f32 v147, v147, v16
  v_sub_f32 v148, v148, v16
  v_sub_f32 v149, v149, v16
  v_sub_f32 v150, v150, v16
  v_sub_f32 v151, v151, v16
  v_sub_f32 v152, v152, v16
  v_sub_f32 v153, v153, v16
  v_sub_f32 v154, v154, v16
  v_sub_f32 v155, v155, v16
  v_sub_f32 v156, v156, v16
  v_sub_f32 v157, v157, v16
  v_sub_f32 v158, v158, v16
  v_sub_f32 v159, v159, v16
  v_max_f32 v17, 0, v16
  v_exp_f32_e64 v17, -v17
  s_nop 1
  v_mul_f32 v6, v6, v17
  v_accvgpr_read_b32 v18, a96
  v_mul_f32 v18, v18, v17
  v_accvgpr_write_b32 a96, v18
  v_accvgpr_read_b32 v19, a97
  v_mul_f32 v19, v19, v17
  v_accvgpr_write_b32 a97, v19
  v_accvgpr_read_b32 v18, a98
  v_mul_f32 v18, v18, v17
  v_accvgpr_write_b32 a98, v18
  v_accvgpr_read_b32 v19, a99
  v_mul_f32 v19, v19, v17
  v_accvgpr_write_b32 a99, v19
  v_accvgpr_read_b32 v18, a100
  v_mul_f32 v18, v18, v17
  v_accvgpr_write_b32 a100, v18
  v_accvgpr_read_b32 v19, a101
  v_mul_f32 v19, v19, v17
  v_accvgpr_write_b32 a101, v19
  v_accvgpr_read_b32 v18, a102
  v_mul_f32 v18, v18, v17
  v_accvgpr_write_b32 a102, v18
  v_accvgpr_read_b32 v19, a103
  v_mul_f32 v19, v19, v17
  v_accvgpr_write_b32 a103, v19
  v_accvgpr_read_b32 v18, a104
  v_mul_f32 v18, v18, v17
  v_accvgpr_write_b32 a104, v18
  v_accvgpr_read_b32 v19, a105
  v_mul_f32 v19, v19, v17
  v_accvgpr_write_b32 a105, v19
  v_accvgpr_read_b32 v18, a106
  v_mul_f32 v18, v18, v17
  v_accvgpr_write_b32 a106, v18
  v_accvgpr_read_b32 v19, a107
  v_mul_f32 v19, v19, v17
  v_accvgpr_write_b32 a107, v19
  v_accvgpr_read_b32 v18, a108
  v_mul_f32 v18, v18, v17
  v_accvgpr_write_b32 a108, v18
  v_accvgpr_read_b32 v19, a109
  v_mul_f32 v19, v19, v17
  v_accvgpr_write_b32 a109, v19
  v_accvgpr_read_b32 v18, a110
  v_mul_f32 v18, v18, v17
  v_accvgpr_write_b32 a110, v18
  v_accvgpr_read_b32 v19, a111
  v_mul_f32 v19, v19, v17
  v_accvgpr_write_b32 a111, v19
  v_accvgpr_read_b32 v18, a112
  v_mul_f32 v18, v18, v17
  v_accvgpr_write_b32 a112, v18
  v_accvgpr_read_b32 v19, a113
  v_mul_f32 v19, v19, v17
  v_accvgpr_write_b32 a113, v19
  v_accvgpr_read_b32 v18, a114
  v_mul_f32 v18, v18, v17
  v_accvgpr_write_b32 a114, v18
  v_accvgpr_read_b32 v19, a115
  v_mul_f32 v19, v19, v17
  v_accvgpr_write_b32 a115, v19
  v_accvgpr_read_b32 v18, a116
  v_mul_f32 v18, v18, v17
  v_accvgpr_write_b32 a116, v18
  v_accvgpr_read_b32 v19, a117
  v_mul_f32 v19, v19, v17
  v_accvgpr_write_b32 a117, v19
  v_accvgpr_read_b32 v18, a118
  v_mul_f32 v18, v18, v17
  v_accvgpr_write_b32 a118, v18
  v_accvgpr_read_b32 v19, a119
  v_mul_f32 v19, v19, v17
  v_accvgpr_write_b32 a119, v19
  v_accvgpr_read_b32 v18, a120
  v_mul_f32 v18, v18, v17
  v_accvgpr_write_b32 a120, v18
  v_accvgpr_read_b32 v19, a121
  v_mul_f32 v19, v19, v17
  v_accvgpr_write_b32 a121, v19
  v_accvgpr_read_b32 v18, a122
  v_mul_f32 v18, v18, v17
  v_accvgpr_write_b32 a122, v18
  v_accvgpr_read_b32 v19, a123
  v_mul_f32 v19, v19, v17
  v_accvgpr_write_b32 a123, v19
  v_accvgpr_read_b32 v18, a124
  v_mul_f32 v18, v18, v17
  v_accvgpr_write_b32 a124, v18
  v_accvgpr_read_b32 v19, a125
  v_mul_f32 v19, v19, v17
  v_accvgpr_write_b32 a125, v19
  v_accvgpr_read_b32 v18, a126
  v_mul_f32 v18, v18, v17
  v_accvgpr_write_b32 a126, v18
  v_accvgpr_read_b32 v19, a127
  v_mul_f32 v19, v19, v17
  v_accvgpr_write_b32 a127, v19
  v_accvgpr_read_b32 v18, a128
  v_mul_f32 v18, v18, v17
  v_accvgpr_write_b32 a128, v18
  v_accvgpr_read_b32 v19, a129
  v_mul_f32 v19, v19, v17
  v_accvgpr_write_b32 a129, v19
  v_accvgpr_read_b32 v18, a130
  v_mul_f32 v18, v18, v17
  v_accvgpr_write_b32 a130, v18
  v_accvgpr_read_b32 v19, a131
  v_mul_f32 v19, v19, v17
  v_accvgpr_write_b32 a131, v19
  v_accvgpr_read_b32 v18, a132
  v_mul_f32 v18, v18, v17
  v_accvgpr_write_b32 a132, v18
  v_accvgpr_read_b32 v19, a133
  v_mul_f32 v19, v19, v17
  v_accvgpr_write_b32 a133, v19
  v_accvgpr_read_b32 v18, a134
  v_mul_f32 v18, v18, v17
  v_accvgpr_write_b32 a134, v18
  v_accvgpr_read_b32 v19, a135
  v_mul_f32 v19, v19, v17
  v_accvgpr_write_b32 a135, v19
  v_accvgpr_read_b32 v18, a136
  v_mul_f32 v18, v18, v17
  v_accvgpr_write_b32 a136, v18
  v_accvgpr_read_b32 v19, a137
  v_mul_f32 v19, v19, v17
  v_accvgpr_write_b32 a137, v19
  v_accvgpr_read_b32 v18, a138
  v_mul_f32 v18, v18, v17
  v_accvgpr_write_b32 a138, v18
  v_accvgpr_read_b32 v19, a139
  v_mul_f32 v19, v19, v17
  v_accvgpr_write_b32 a139, v19
  v_accvgpr_read_b32 v18, a140
  v_mul_f32 v18, v18, v17
  v_accvgpr_write_b32 a140, v18
  v_accvgpr_read_b32 v19, a141
  v_mul_f32 v19, v19, v17
  v_accvgpr_write_b32 a141, v19
  v_accvgpr_read_b32 v18, a142
  v_mul_f32 v18, v18, v17
  v_accvgpr_write_b32 a142, v18
  v_accvgpr_read_b32 v19, a143
  v_mul_f32 v19, v19, v17
  v_accvgpr_write_b32 a143, v19
  v_mov_b32 v20, v11
  v_mov_b32 v21, v11
  v_mov_b32 v22, v11
  v_mov_b32 v23, v11
  ds_write_b128 v3, v[20:23] offset:2048
  v_exp_f32 v16, v144
  v_exp_f32 v17, v145
  v_exp_f32 v18, v146
  v_exp_f32 v19, v147
  v_add_f32 v0, v16, v17
  v_cvt_pk_bf16_f32 v176, v16, v17
  v_exp_f32 v16, v148
  v_exp_f32 v17, v149
  v_add_f32 v0, v0, v18
  v_add_f32 v0, v0, v19
  v_cvt_pk_bf16_f32 v177, v18, v19
  v_exp_f32 v18, v150
  v_exp_f32 v19, v151
  v_add_f32 v0, v0, v16
  v_add_f32 v0, v0, v17
  v_cvt_pk_bf16_f32 v178, v16, v17
  v_exp_f32 v16, v152
  v_exp_f32 v17, v153
  v_add_f32 v0, v0, v18
  v_add_f32 v0, v0, v19
  v_cvt_pk_bf16_f32 v179, v18, v19
  v_exp_f32 v18, v154
  v_exp_f32 v19, v155
  v_add_f32 v0, v0, v16
  v_add_f32 v0, v0, v17
  v_cvt_pk_bf16_f32 v180, v16, v17
  v_exp_f32 v16, v156
  v_exp_f32 v17, v157
  v_add_f32 v0, v0, v18
  v_add_f32 v0, v0, v19
  v_cvt_pk_bf16_f32 v181, v18, v19
  v_exp_f32 v18, v158
  v_exp_f32 v19, v159
  v_add_f32 v0, v0, v16
  v_add_f32 v0, v0, v17
  v_cvt_pk_bf16_f32 v182, v16, v17
  v_add_f32 v0, v0, v18
  v_add_f32 v0, v0, v19
  v_cvt_pk_bf16_f32 v183, v18, v19
  s_waitcnt lgkmcnt(0)
  s_nop 1
  s_branch Lret_2
Lslow_3:
  s_nop 7
  v_max3_f32 v16, v160, v161, v162
  v_max3_f32 v16, v16, v163, v164
  v_max3_f32 v16, v16, v165, v166
  v_max3_f32 v16, v16, v167, v168
  v_max3_f32 v16, v16, v169, v170
  v_max3_f32 v16, v16, v171, v172
  v_max3_f32 v16, v16, v173, v174
  v_max_f32 v16, v16, v175
  v_mov_b32 v17, v16
  s_nop 1
  v_permlane32_swap_b32 v16, v17
  s_nop 1
  v_max_f32 v16, v16, v17
  v_ceil_f32 v16, v16
  v_max_f32 v16, s26, v16
  v_sub_f32 v12, v12, v16
  v_sub_f32 v160, v160, v16
  v_sub_f32 v161, v161, v16
  v_sub_f32 v162, v162, v16
  v_sub_f32 v163, v163, v16
  v_sub_f32 v164, v164, v16
  v_sub_f32 v165, v165, v16
  v_sub_f32 v166, v166, v16
  v_sub_f32 v167, v167, v16
  v_sub_f32 v168, v168, v16
  v_sub_f32 v169, v169, v16
  v_sub_f32 v170, v170, v16
  v_sub_f32 v171, v171, v16
  v_sub_f32 v172, v172, v16
  v_sub_f32 v173, v173, v16
  v_sub_f32 v174, v174, v16
  v_sub_f32 v175, v175, v16
  v_max_f32 v17, 0, v16
  v_exp_f32_e64 v17, -v17
  s_nop 1
  v_mul_f32 v7, v7, v17
  v_accvgpr_read_b32 v18, a144
  v_mul_f32 v18, v18, v17
  v_accvgpr_write_b32 a144, v18
  v_accvgpr_read_b32 v19, a145
  v_mul_f32 v19, v19, v17
  v_accvgpr_write_b32 a145, v19
  v_accvgpr_read_b32 v18, a146
  v_mul_f32 v18, v18, v17
  v_accvgpr_write_b32 a146, v18
  v_accvgpr_read_b32 v19, a147
  v_mul_f32 v19, v19, v17
  v_accvgpr_write_b32 a147, v19
  v_accvgpr_read_b32 v18, a148
  v_mul_f32 v18, v18, v17
  v_accvgpr_write_b32 a148, v18
  v_accvgpr_read_b32 v19, a149
  v_mul_f32 v19, v19, v17
  v_accvgpr_write_b32 a149, v19
  v_accvgpr_read_b32 v18, a150
  v_mul_f32 v18, v18, v17
  v_accvgpr_write_b32 a150, v18
  v_accvgpr_read_b32 v19, a151
  v_mul_f32 v19, v19, v17
  v_accvgpr_write_b32 a151, v19
  v_accvgpr_read_b32 v18, a152
  v_mul_f32 v18, v18, v17
  v_accvgpr_write_b32 a152, v18
  v_accvgpr_read_b32 v19, a153
  v_mul_f32 v19, v19, v17
  v_accvgpr_write_b32 a153, v19
  v_accvgpr_read_b32 v18, a154
  v_mul_f32 v18, v18, v17
  v_accvgpr_write_b32 a154, v18
  v_accvgpr_read_b32 v19, a155
  v_mul_f32 v19, v19, v17
  v_accvgpr_write_b32 a155, v19
  v_accvgpr_read_b32 v18, a156
  v_mul_f32 v18, v18, v17
  v_accvgpr_write_b32 a156, v18
  v_accvgpr_read_b32 v19, a157
  v_mul_f32 v19, v19, v17
  v_accvgpr_write_b32 a157, v19
  v_accvgpr_read_b32 v18, a158
  v_mul_f32 v18, v18, v17
  v_accvgpr_write_b32 a158, v18
  v_accvgpr_read_b32 v19, a159
  v_mul_f32 v19, v19, v17
  v_accvgpr_write_b32 a159, v19
  v_accvgpr_read_b32 v18, a160
  v_mul_f32 v18, v18, v17
  v_accvgpr_write_b32 a160, v18
  v_accvgpr_read_b32 v19, a161
  v_mul_f32 v19, v19, v17
  v_accvgpr_write_b32 a161, v19
  v_accvgpr_read_b32 v18, a162
  v_mul_f32 v18, v18, v17
  v_accvgpr_write_b32 a162, v18
  v_accvgpr_read_b32 v19, a163
  v_mul_f32 v19, v19, v17
  v_accvgpr_write_b32 a163, v19
  v_accvgpr_read_b32 v18, a164
  v_mul_f32 v18, v18, v17
  v_accvgpr_write_b32 a164, v18
  v_accvgpr_read_b32 v19, a165
  v_mul_f32 v19, v19, v17
  v_accvgpr_write_b32 a165, v19
  v_accvgpr_read_b32 v18, a166
  v_mul_f32 v18, v18, v17
  v_accvgpr_write_b32 a166, v18
  v_accvgpr_read_b32 v19, a167
  v_mul_f32 v19, v19, v17
  v_accvgpr_write_b32 a167, v19
  v_accvgpr_read_b32 v18, a168
  v_mul_f32 v18, v18, v17
  v_accvgpr_write_b32 a168, v18
  v_accvgpr_read_b32 v19, a169
  v_mul_f32 v19, v19, v17
  v_accvgpr_write_b32 a169, v19
  v_accvgpr_read_b32 v18, a170
  v_mul_f32 v18, v18, v17
  v_accvgpr_write_b32 a170, v18
  v_accvgpr_read_b32 v19, a171
  v_mul_f32 v19, v19, v17
  v_accvgpr_write_b32 a171, v19
  v_accvgpr_read_b32 v18, a172
  v_mul_f32 v18, v18, v17
  v_accvgpr_write_b32 a172, v18
  v_accvgpr_read_b32 v19, a173
  v_mul_f32 v19, v19, v17
  v_accvgpr_write_b32 a173, v19
  v_accvgpr_read_b32 v18, a174
  v_mul_f32 v18, v18, v17
  v_accvgpr_write_b32 a174, v18
  v_accvgpr_read_b32 v19, a175
  v_mul_f32 v19, v19, v17
  v_accvgpr_write_b32 a175, v19
  v_accvgpr_read_b32 v18, a176
  v_mul_f32 v18, v18, v17
  v_accvgpr_write_b32 a176, v18
  v_accvgpr_read_b32 v19, a177
  v_mul_f32 v19, v19, v17
  v_accvgpr_write_b32 a177, v19
  v_accvgpr_read_b32 v18, a178
  v_mul_f32 v18, v18, v17
  v_accvgpr_write_b32 a178, v18
  v_accvgpr_read_b32 v19, a179
  v_mul_f32 v19, v19, v17
  v_accvgpr_write_b32 a179, v19
  v_accvgpr_read_b32 v18, a180
  v_mul_f32 v18, v18, v17
  v_accvgpr_write_b32 a180, v18
  v_accvgpr_read_b32 v19, a181
  v_mul_f32 v19, v19, v17
  v_accvgpr_write_b32 a181, v19
  v_accvgpr_read_b32 v18, a182
  v_mul_f32 v18, v18, v17
  v_accvgpr_write_b32 a182, v18
  v_accvgpr_read_b32 v19, a183
  v_mul_f32 v19, v19, v17
  v_accvgpr_write_b32 a183, v19
  v_accvgpr_read_b32 v18, a184
  v_mul_f32 v18, v18, v17
  v_accvgpr_write_b32 a184, v18
  v_accvgpr_read_b32 v19, a185
  v_mul_f32 v19, v19, v17
  v_accvgpr_write_b32 a185, v19
  v_accvgpr_read_b32 v18, a186
  v_mul_f32 v18, v18, v17
  v_accvgpr_write_b32 a186, v18
  v_accvgpr_read_b32 v19, a187
  v_mul_f32 v19, v19, v17
  v_accvgpr_write_b32 a187, v19
  v_accvgpr_read_b32 v18, a188
  v_mul_f32 v18, v18, v17
  v_accvgpr_write_b32 a188, v18
  v_accvgpr_read_b32 v19, a189
  v_mul_f32 v19, v19, v17
  v_accvgpr_write_b32 a189, v19
  v_accvgpr_read_b32 v18, a190
  v_mul_f32 v18, v18, v17
  v_accvgpr_write_b32 a190, v18
  v_accvgpr_read_b32 v19, a191
  v_mul_f32 v19, v19, v17
  v_accvgpr_write_b32 a191, v19
  v_mov_b32 v20, v12
  v_mov_b32 v21, v12
  v_mov_b32 v22, v12
  v_mov_b32 v23, v12
  ds_write_b128 v3, v[20:23] offset:3072
  v_exp_f32 v16, v160
  v_exp_f32 v17, v161
  v_exp_f32 v18, v162
  v_exp_f32 v19, v163
  v_add_f32 v0, v16, v17
  v_cvt_pk_bf16_f32 v184, v16, v17
  v_exp_f32 v16, v164
  v_exp_f32 v17, v165
  v_add_f32 v0, v0, v18
  v_add_f32 v0, v0, v19
  v_cvt_pk_bf16_f32 v185, v18, v19
  v_exp_f32 v18, v166
  v_exp_f32 v19, v167
  v_add_f32 v0, v0, v16
  v_add_f32 v0, v0, v17
  v_cvt_pk_bf16_f32 v186, v16, v17
  v_exp_f32 v16, v168
  v_exp_f32 v17, v169
  v_add_f32 v0, v0, v18
  v_add_f32 v0, v0, v19
  v_cvt_pk_bf16_f32 v187, v18, v19
  v_exp_f32 v18, v170
  v_exp_f32 v19, v171
  v_add_f32 v0, v0, v16
  v_add_f32 v0, v0, v17
  v_cvt_pk_bf16_f32 v188, v16, v17
  v_exp_f32 v16, v172
  v_exp_f32 v17, v173
  v_add_f32 v0, v0, v18
  v_add_f32 v0, v0, v19
  v_cvt_pk_bf16_f32 v189, v18, v19
  v_exp_f32 v18, v174
  v_exp_f32 v19, v175
  v_add_f32 v0, v0, v16
  v_add_f32 v0, v0, v17
  v_cvt_pk_bf16_f32 v190, v16, v17
  v_add_f32 v0, v0, v18
  v_add_f32 v0, v0, v19
  v_cvt_pk_bf16_f32 v191, v18, v19
  s_waitcnt lgkmcnt(0)
  s_nop 1
  s_branch Lret_3
Lslow_4:
  s_nop 7
  v_max3_f32 v16, v144, v145, v146
  v_max3_f32 v16, v16, v147, v148
  v_max3_f32 v16, v16, v149, v150
  v_max3_f32 v16, v16, v151, v152
  v_max3_f32 v16, v16, v153, v154
  v_max3_f32 v16, v16, v155, v156
  v_max3_f32 v16, v16, v157, v158
  v_max_f32 v16, v16, v159
  v_mov_b32 v17, v16
  s_nop 1
  v_permlane32_swap_b32 v16, v17
  s_nop 1
  v_max_f32 v16, v16, v17
  v_ceil_f32 v16, v16
  v_max_f32 v16, s26, v16
  v_sub_f32 v13, v13, v16
  v_sub_f32 v144, v144, v16
  v_sub_f32 v145, v145, v16
  v_sub_f32 v146, v146, v16
  v_sub_f32 v147, v147, v16
  v_sub_f32 v148, v148, v16
  v_sub_f32 v149, v149, v16
  v_sub_f32 v150, v150, v16
  v_sub_f32 v151, v151, v16
  v_sub_f32 v152, v152, v16
  v_sub_f32 v153, v153, v16
  v_sub_f32 v154, v154, v16
  v_sub_f32 v155, v155, v16
  v_sub_f32 v156, v156, v16
  v_sub_f32 v157, v157, v16
  v_sub_f32 v158, v158, v16
  v_sub_f32 v159, v159, v16
  v_max_f32 v17, 0, v16
  v_exp_f32_e64 v17, -v17
  s_nop 1
  v_mul_f32 v8, v8, v17
  v_accvgpr_read_b32 v18, a192
  v_mul_f32 v18, v18, v17
  v_accvgpr_write_b32 a192, v18
  v_accvgpr_read_b32 v19, a193
  v_mul_f32 v19, v19, v17
  v_accvgpr_write_b32 a193, v19
  v_accvgpr_read_b32 v18, a194
  v_mul_f32 v18, v18, v17
  v_accvgpr_write_b32 a194, v18
  v_accvgpr_read_b32 v19, a195
  v_mul_f32 v19, v19, v17
  v_accvgpr_write_b32 a195, v19
  v_accvgpr_read_b32 v18, a196
  v_mul_f32 v18, v18, v17
  v_accvgpr_write_b32 a196, v18
  v_accvgpr_read_b32 v19, a197
  v_mul_f32 v19, v19, v17
  v_accvgpr_write_b32 a197, v19
  v_accvgpr_read_b32 v18, a198
  v_mul_f32 v18, v18, v17
  v_accvgpr_write_b32 a198, v18
  v_accvgpr_read_b32 v19, a199
  v_mul_f32 v19, v19, v17
  v_accvgpr_write_b32 a199, v19
  v_accvgpr_read_b32 v18, a200
  v_mul_f32 v18, v18, v17
  v_accvgpr_write_b32 a200, v18
  v_accvgpr_read_b32 v19, a201
  v_mul_f32 v19, v19, v17
  v_accvgpr_write_b32 a201, v19
  v_accvgpr_read_b32 v18, a202
  v_mul_f32 v18, v18, v17
  v_accvgpr_write_b32 a202, v18
  v_accvgpr_read_b32 v19, a203
  v_mul_f32 v19, v19, v17
  v_accvgpr_write_b32 a203, v19
  v_accvgpr_read_b32 v18, a204
  v_mul_f32 v18, v18, v17
  v_accvgpr_write_b32 a204, v18
  v_accvgpr_read_b32 v19, a205
  v_mul_f32 v19, v19, v17
  v_accvgpr_write_b32 a205, v19
  v_accvgpr_read_b32 v18, a206
  v_mul_f32 v18, v18, v17
  v_accvgpr_write_b32 a206, v18
  v_accvgpr_read_b32 v19, a207
  v_mul_f32 v19, v19, v17
  v_accvgpr_write_b32 a207, v19
  v_accvgpr_read_b32 v18, a208
  v_mul_f32 v18, v18, v17
  v_accvgpr_write_b32 a208, v18
  v_accvgpr_read_b32 v19, a209
  v_mul_f32 v19, v19, v17
  v_accvgpr_write_b32 a209, v19
  v_accvgpr_read_b32 v18, a210
  v_mul_f32 v18, v18, v17
  v_accvgpr_write_b32 a210, v18
  v_accvgpr_read_b32 v19, a211
  v_mul_f32 v19, v19, v17
  v_accvgpr_write_b32 a211, v19
  v_accvgpr_read_b32 v18, a212
  v_mul_f32 v18, v18, v17
  v_accvgpr_write_b32 a212, v18
  v_accvgpr_read_b32 v19, a213
  v_mul_f32 v19, v19, v17
  v_accvgpr_write_b32 a213, v19
  v_accvgpr_read_b32 v18, a214
  v_mul_f32 v18, v18, v17
  v_accvgpr_write_b32 a214, v18
  v_accvgpr_read_b32 v19, a215
  v_mul_f32 v19, v19, v17
  v_accvgpr_write_b32 a215, v19
  v_accvgpr_read_b32 v18, a216
  v_mul_f32 v18, v18, v17
  v_accvgpr_write_b32 a216, v18
  v_accvgpr_read_b32 v19, a217
  v_mul_f32 v19, v19, v17
  v_accvgpr_write_b32 a217, v19
  v_accvgpr_read_b32 v18, a218
  v_mul_f32 v18, v18, v17
  v_accvgpr_write_b32 a218, v18
  v_accvgpr_read_b32 v19, a219
  v_mul_f32 v19, v19, v17
  v_accvgpr_write_b32 a219, v19
  v_accvgpr_read_b32 v18, a220
  v_mul_f32 v18, v18, v17
  v_accvgpr_write_b32 a220, v18
  v_accvgpr_read_b32 v19, a221
  v_mul_f32 v19, v19, v17
  v_accvgpr_write_b32 a221, v19
  v_accvgpr_read_b32 v18, a222
  v_mul_f32 v18, v18, v17
  v_accvgpr_write_b32 a222, v18
  v_accvgpr_read_b32 v19, a223
  v_mul_f32 v19, v19, v17
  v_accvgpr_write_b32 a223, v19
  v_accvgpr_read_b32 v18, a224
  v_mul_f32 v18, v18, v17
  v_accvgpr_write_b32 a224, v18
  v_accvgpr_read_b32 v19, a225
  v_mul_f32 v19, v19, v17
  v_accvgpr_write_b32 a225, v19
  v_accvgpr_read_b32 v18, a226
  v_mul_f32 v18, v18, v17
  v_accvgpr_write_b32 a226, v18
  v_accvgpr_read_b32 v19, a227
  v_mul_f32 v19, v19, v17
  v_accvgpr_write_b32 a227, v19
  v_accvgpr_read_b32 v18, a228
  v_mul_f32 v18, v18, v17
  v_accvgpr_write_b32 a228, v18
  v_accvgpr_read_b32 v19, a229
  v_mul_f32 v19, v19, v17
  v_accvgpr_write_b32 a229, v19
  v_accvgpr_read_b32 v18, a230
  v_mul_f32 v18, v18, v17
  v_accvgpr_write_b32 a230, v18
  v_accvgpr_read_b32 v19, a231
  v_mul_f32 v19, v19, v17
  v_accvgpr_write_b32 a231, v19
  v_accvgpr_read_b32 v18, a232
  v_mul_f32 v18, v18, v17
  v_accvgpr_write_b32 a232, v18
  v_accvgpr_read_b32 v19, a233
  v_mul_f32 v19, v19, v17
  v_accvgpr_write_b32 a233, v19
  v_accvgpr_read_b32 v18, a234
  v_mul_f32 v18, v18, v17
  v_accvgpr_write_b32 a234, v18
  v_accvgpr_read_b32 v19, a235
  v_mul_f32 v19, v19, v17
  v_accvgpr_write_b32 a235, v19
  v_accvgpr_read_b32 v18, a236
  v_mul_f32 v18, v18, v17
  v_accvgpr_write_b32 a236, v18
  v_accvgpr_read_b32 v19, a237
  v_mul_f32 v19, v19, v17
  v_accvgpr_write_b32 a237, v19
  v_accvgpr_read_b32 v18, a238
  v_mul_f32 v18, v18, v17
  v_accvgpr_write_b32 a238, v18
  v_accvgpr_read_b32 v19, a239
  v_mul_f32 v19, v19, v17
  v_accvgpr_write_b32 a239, v19
  v_mov_b32 v20, v13
  v_mov_b32 v21, v13
  v_mov_b32 v22, v13
  v_mov_b32 v23, v13
  ds_write_b128 v3, v[20:23] offset:4096
  v_exp_f32 v16, v144
  v_exp_f32 v17, v145
  v_exp_f32 v18, v146
  v_exp_f32 v19, v147
  v_add_f32 v0, v16, v17
  v_cvt_pk_bf16_f32 v176, v16, v17
  v_exp_f32 v16, v148
  v_exp_f32 v17, v149
  v_add_f32 v0, v0, v18
  v_add_f32 v0, v0, v19
  v_cvt_pk_bf16_f32 v177, v18, v19
  v_exp_f32 v18, v150
  v_exp_f32 v19, v151
  v_add_f32 v0, v0, v16
  v_add_f32 v0, v0, v17
  v_cvt_pk_bf16_f32 v178, v16, v17
  v_exp_f32 v16, v152
  v_exp_f32 v17, v153
  v_add_f32 v0, v0, v18
  v_add_f32 v0, v0, v19
  v_cvt_pk_bf16_f32 v179, v18, v19
  v_exp_f32 v18, v154
  v_exp_f32 v19, v155
  v_add_f32 v0, v0, v16
  v_add_f32 v0, v0, v17
  v_cvt_pk_bf16_f32 v180, v16, v17
  v_exp_f32 v16, v156
  v_exp_f32 v17, v157
  v_add_f32 v0, v0, v18
  v_add_f32 v0, v0, v19
  v_cvt_pk_bf16_f32 v181, v18, v19
  v_exp_f32 v18, v158
  v_exp_f32 v19, v159
  v_add_f32 v0, v0, v16
  v_add_f32 v0, v0, v17
  v_cvt_pk_bf16_f32 v182, v16, v17
  v_add_f32 v0, v0, v18
  v_add_f32 v0, v0, v19
  v_cvt_pk_bf16_f32 v183, v18, v19
  s_waitcnt lgkmcnt(0)
  s_nop 1
  s_branch Lret_4
Lslow_5:
  s_nop 7
  v_max3_f32 v16, v160, v161, v162
  v_max3_f32 v16, v16, v163, v164
  v_max3_f32 v16, v16, v165, v166
  v_max3_f32 v16, v16, v167, v168
  v_max3_f32 v16, v16, v169, v170
  v_max3_f32 v16, v16, v171, v172
  v_max3_f32 v16, v16, v173, v174
  v_max_f32 v16, v16, v175
  v_mov_b32 v17, v16
  s_nop 1
  v_permlane32_swap_b32 v16, v17
  s_nop 1
  v_max_f32 v16, v16, v17
  v_ceil_f32 v16, v16
  v_max_f32 v16, 0, v16
  v_sub_f32 v9, v9, v16
  v_sub_f32 v160, v160, v16
  v_sub_f32 v161, v161, v16
  v_sub_f32 v162, v162, v16
  v_sub_f32 v163, v163, v16
  v_sub_f32 v164, v164, v16
  v_sub_f32 v165, v165, v16
  v_sub_f32 v166, v166, v16
  v_sub_f32 v167, v167, v16
  v_sub_f32 v168, v168, v16
  v_sub_f32 v169, v169, v16
  v_sub_f32 v170, v170, v16
  v_sub_f32 v171, v171, v16
  v_sub_f32 v172, v172, v16
  v_sub_f32 v173, v173, v16
  v_sub_f32 v174, v174, v16
  v_sub_f32 v175, v175, v16
  v_max_f32 v17, 0, v16
  v_exp_f32_e64 v17, -v17
  s_nop 1
  v_mul_f32 v4, v4, v17
  v_accvgpr_read_b32 v18, a0
  v_mul_f32 v18, v18, v17
  v_accvgpr_write_b32 a0, v18
  v_accvgpr_read_b32 v19, a1
  v_mul_f32 v19, v19, v17
  v_accvgpr_write_b32 a1, v19
  v_accvgpr_read_b32 v18, a2
  v_mul_f32 v18, v18, v17
  v_accvgpr_write_b32 a2, v18
  v_accvgpr_read_b32 v19, a3
  v_mul_f32 v19, v19, v17
  v_accvgpr_write_b32 a3, v19
  v_accvgpr_read_b32 v18, a4
  v_mul_f32 v18, v18, v17
  v_accvgpr_write_b32 a4, v18
  v_accvgpr_read_b32 v19, a5
  v_mul_f32 v19, v19, v17
  v_accvgpr_write_b32 a5, v19
  v_accvgpr_read_b32 v18, a6
  v_mul_f32 v18, v18, v17
  v_accvgpr_write_b32 a6, v18
  v_accvgpr_read_b32 v19, a7
  v_mul_f32 v19, v19, v17
  v_accvgpr_write_b32 a7, v19
  v_accvgpr_read_b32 v18, a8
  v_mul_f32 v18, v18, v17
  v_accvgpr_write_b32 a8, v18
  v_accvgpr_read_b32 v19, a9
  v_mul_f32 v19, v19, v17
  v_accvgpr_write_b32 a9, v19
  v_accvgpr_read_b32 v18, a10
  v_mul_f32 v18, v18, v17
  v_accvgpr_write_b32 a10, v18
  v_accvgpr_read_b32 v19, a11
  v_mul_f32 v19, v19, v17
  v_accvgpr_write_b32 a11, v19
  v_accvgpr_read_b32 v18, a12
  v_mul_f32 v18, v18, v17
  v_accvgpr_write_b32 a12, v18
  v_accvgpr_read_b32 v19, a13
  v_mul_f32 v19, v19, v17
  v_accvgpr_write_b32 a13, v19
  v_accvgpr_read_b32 v18, a14
  v_mul_f32 v18, v18, v17
  v_accvgpr_write_b32 a14, v18
  v_accvgpr_read_b32 v19, a15
  v_mul_f32 v19, v19, v17
  v_accvgpr_write_b32 a15, v19
  v_accvgpr_read_b32 v18, a16
  v_mul_f32 v18, v18, v17
  v_accvgpr_write_b32 a16, v18
  v_accvgpr_read_b32 v19, a17
  v_mul_f32 v19, v19, v17
  v_accvgpr_write_b32 a17, v19
  v_accvgpr_read_b32 v18, a18
  v_mul_f32 v18, v18, v17
  v_accvgpr_write_b32 a18, v18
  v_accvgpr_read_b32 v19, a19
  v_mul_f32 v19, v19, v17
  v_accvgpr_write_b32 a19, v19
  v_accvgpr_read_b32 v18, a20
  v_mul_f32 v18, v18, v17
  v_accvgpr_write_b32 a20, v18
  v_accvgpr_read_b32 v19, a21
  v_mul_f32 v19, v19, v17
  v_accvgpr_write_b32 a21, v19
  v_accvgpr_read_b32 v18, a22
  v_mul_f32 v18, v18, v17
  v_accvgpr_write_b32 a22, v18
  v_accvgpr_read_b32 v19, a23
  v_mul_f32 v19, v19, v17
  v_accvgpr_write_b32 a23, v19
  v_accvgpr_read_b32 v18, a24
  v_mul_f32 v18, v18, v17
  v_accvgpr_write_b32 a24, v18
  v_accvgpr_read_b32 v19, a25
  v_mul_f32 v19, v19, v17
  v_accvgpr_write_b32 a25, v19
  v_accvgpr_read_b32 v18, a26
  v_mul_f32 v18, v18, v17
  v_accvgpr_write_b32 a26, v18
  v_accvgpr_read_b32 v19, a27
  v_mul_f32 v19, v19, v17
  v_accvgpr_write_b32 a27, v19
  v_accvgpr_read_b32 v18, a28
  v_mul_f32 v18, v18, v17
  v_accvgpr_write_b32 a28, v18
  v_accvgpr_read_b32 v19, a29
  v_mul_f32 v19, v19, v17
  v_accvgpr_write_b32 a29, v19
  v_accvgpr_read_b32 v18, a30
  v_mul_f32 v18, v18, v17
  v_accvgpr_write_b32 a30, v18
  v_accvgpr_read_b32 v19, a31
  v_mul_f32 v19, v19, v17
  v_accvgpr_write_b32 a31, v19
  v_accvgpr_read_b32 v18, a32
  v_mul_f32 v18, v18, v17
  v_accvgpr_write_b32 a32, v18
  v_accvgpr_read_b32 v19, a33
  v_mul_f32 v19, v19, v17
  v_accvgpr_write_b32 a33, v19
  v_accvgpr_read_b32 v18, a34
  v_mul_f32 v18, v18, v17
  v_accvgpr_write_b32 a34, v18
  v_accvgpr_read_b32 v19, a35
  v_mul_f32 v19, v19, v17
  v_accvgpr_write_b32 a35, v19
  v_accvgpr_read_b32 v18, a36
  v_mul_f32 v18, v18, v17
  v_accvgpr_write_b32 a36, v18
  v_accvgpr_read_b32 v19, a37
  v_mul_f32 v19, v19, v17
  v_accvgpr_write_b32 a37, v19
  v_accvgpr_read_b32 v18, a38
  v_mul_f32 v18, v18, v17
  v_accvgpr_write_b32 a38, v18
  v_accvgpr_read_b32 v19, a39
  v_mul_f32 v19, v19, v17
  v_accvgpr_write_b32 a39, v19
  v_accvgpr_read_b32 v18, a40
  v_mul_f32 v18, v18, v17
  v_accvgpr_write_b32 a40, v18
  v_accvgpr_read_b32 v19, a41
  v_mul_f32 v19, v19, v17
  v_accvgpr_write_b32 a41, v19
  v_accvgpr_read_b32 v18, a42
  v_mul_f32 v18, v18, v17
  v_accvgpr_write_b32 a42, v18
  v_accvgpr_read_b32 v19, a43
  v_mul_f32 v19, v19, v17
  v_accvgpr_write_b32 a43, v19
  v_accvgpr_read_b32 v18, a44
  v_mul_f32 v18, v18, v17
  v_accvgpr_write_b32 a44, v18
  v_accvgpr_read_b32 v19, a45
  v_mul_f32 v19, v19, v17
  v_accvgpr_write_b32 a45, v19
  v_accvgpr_read_b32 v18, a46
  v_mul_f32 v18, v18, v17
  v_accvgpr_write_b32 a46, v18
  v_accvgpr_read_b32 v19, a47
  v_mul_f32 v19, v19, v17
  v_accvgpr_write_b32 a47, v19
  v_mov_b32 v20, v9
  v_mov_b32 v21, v9
  v_mov_b32 v22, v9
  v_mov_b32 v23, v9
  ds_write_b128 v3, v[20:23] offset:0
  v_exp_f32 v16, v160
  v_exp_f32 v17, v161
  v_exp_f32 v18, v162
  v_exp_f32 v19, v163
  v_add_f32 v0, v16, v17
  v_cvt_pk_bf16_f32 v184, v16, v17
  v_exp_f32 v16, v164
  v_exp_f32 v17, v165
  v_add_f32 v0, v0, v18
  v_add_f32 v0, v0, v19
  v_cvt_pk_bf16_f32 v185, v18, v19
  v_exp_f32 v18, v166
  v_exp_f32 v19, v167
  v_add_f32 v0, v0, v16
  v_add_f32 v0, v0, v17
  v_cvt_pk_bf16_f32 v186, v16, v17
  v_exp_f32 v16, v168
  v_exp_f32 v17, v169
  v_add_f32 v0, v0, v18
  v_add_f32 v0, v0, v19
  v_cvt_pk_bf16_f32 v187, v18, v19
  v_exp_f32 v18, v170
  v_exp_f32 v19, v171
  v_add_f32 v0, v0, v16
  v_add_f32 v0, v0, v17
  v_cvt_pk_bf16_f32 v188, v16, v17
  v_exp_f32 v16, v172
  v_exp_f32 v17, v173
  v_add_f32 v0, v0, v18
  v_add_f32 v0, v0, v19
  v_cvt_pk_bf16_f32 v189, v18, v19
  v_exp_f32 v18, v174
  v_exp_f32 v19, v175
  v_add_f32 v0, v0, v16
  v_add_f32 v0, v0, v17
  v_cvt_pk_bf16_f32 v190, v16, v17
  v_add_f32 v0, v0, v18
  v_add_f32 v0, v0, v19
  v_cvt_pk_bf16_f32 v191, v18, v19
  s_waitcnt lgkmcnt(0)
  s_nop 1
  s_branch Lret_5
Lslow_6:
  s_nop 7
  v_max3_f32 v16, v144, v145, v146
  v_max3_f32 v16, v16, v147, v148
  v_max3_f32 v16, v16, v149, v150
  v_max3_f32 v16, v16, v151, v152
  v_max3_f32 v16, v16, v153, v154
  v_max3_f32 v16, v16, v155, v156
  v_max3_f32 v16, v16, v157, v158
  v_max_f32 v16, v16, v159
  v_mov_b32 v17, v16
  s_nop 1
  v_permlane32_swap_b32 v16, v17
  s_nop 1
  v_max_f32 v16, v16, v17
  v_ceil_f32 v16, v16
  v_max_f32 v16, 0, v16
  v_sub_f32 v10, v10, v16
  v_sub_f32 v144, v144, v16
  v_sub_f32 v145, v145, v16
  v_sub_f32 v146, v146, v16
  v_sub_f32 v147, v147, v16
  v_sub_f32 v148, v148, v16
  v_sub_f32 v149, v149, v16
  v_sub_f32 v150, v150, v16
  v_sub_f32 v151, v151, v16
  v_sub_f32 v152, v152, v16
  v_sub_f32 v153, v153, v16
  v_sub_f32 v154, v154, v16
  v_sub_f32 v155, v155, v16
  v_sub_f32 v156, v156, v16
  v_sub_f32 v157, v157, v16
  v_sub_f32 v158, v158, v16
  v_sub_f32 v159, v159, v16
  v_max_f32 v17, 0, v16
  v_exp_f32_e64 v17, -v17
  s_nop 1
  v_mul_f32 v5, v5, v17
  v_accvgpr_read_b32 v18, a48
  v_mul_f32 v18, v18, v17
  v_accvgpr_write_b32 a48, v18
  v_accvgpr_read_b32 v19, a49
  v_mul_f32 v19, v19, v17
  v_accvgpr_write_b32 a49, v19
  v_accvgpr_read_b32 v18, a50
  v_mul_f32 v18, v18, v17
  v_accvgpr_write_b32 a50, v18
  v_accvgpr_read_b32 v19, a51
  v_mul_f32 v19, v19, v17
  v_accvgpr_write_b32 a51, v19
  v_accvgpr_read_b32 v18, a52
  v_mul_f32 v18, v18, v17
  v_accvgpr_write_b32 a52, v18
  v_accvgpr_read_b32 v19, a53
  v_mul_f32 v19, v19, v17
  v_accvgpr_write_b32 a53, v19
  v_accvgpr_read_b32 v18, a54
  v_mul_f32 v18, v18, v17
  v_accvgpr_write_b32 a54, v18
  v_accvgpr_read_b32 v19, a55
  v_mul_f32 v19, v19, v17
  v_accvgpr_write_b32 a55, v19
  v_accvgpr_read_b32 v18, a56
  v_mul_f32 v18, v18, v17
  v_accvgpr_write_b32 a56, v18
  v_accvgpr_read_b32 v19, a57
  v_mul_f32 v19, v19, v17
  v_accvgpr_write_b32 a57, v19
  v_accvgpr_read_b32 v18, a58
  v_mul_f32 v18, v18, v17
  v_accvgpr_write_b32 a58, v18
  v_accvgpr_read_b32 v19, a59
  v_mul_f32 v19, v19, v17
  v_accvgpr_write_b32 a59, v19
  v_accvgpr_read_b32 v18, a60
  v_mul_f32 v18, v18, v17
  v_accvgpr_write_b32 a60, v18
  v_accvgpr_read_b32 v19, a61
  v_mul_f32 v19, v19, v17
  v_accvgpr_write_b32 a61, v19
  v_accvgpr_read_b32 v18, a62
  v_mul_f32 v18, v18, v17
  v_accvgpr_write_b32 a62, v18
  v_accvgpr_read_b32 v19, a63
  v_mul_f32 v19, v19, v17
  v_accvgpr_write_b32 a63, v19
  v_accvgpr_read_b32 v18, a64
  v_mul_f32 v18, v18, v17
  v_accvgpr_write_b32 a64, v18
  v_accvgpr_read_b32 v19, a65
  v_mul_f32 v19, v19, v17
  v_accvgpr_write_b32 a65, v19
  v_accvgpr_read_b32 v18, a66
  v_mul_f32 v18, v18, v17
  v_accvgpr_write_b32 a66, v18
  v_accvgpr_read_b32 v19, a67
  v_mul_f32 v19, v19, v17
  v_accvgpr_write_b32 a67, v19
  v_accvgpr_read_b32 v18, a68
  v_mul_f32 v18, v18, v17
  v_accvgpr_write_b32 a68, v18
  v_accvgpr_read_b32 v19, a69
  v_mul_f32 v19, v19, v17
  v_accvgpr_write_b32 a69, v19
  v_accvgpr_read_b32 v18, a70
  v_mul_f32 v18, v18, v17
  v_accvgpr_write_b32 a70, v18
  v_accvgpr_read_b32 v19, a71
  v_mul_f32 v19, v19, v17
  v_accvgpr_write_b32 a71, v19
  v_accvgpr_read_b32 v18, a72
  v_mul_f32 v18, v18, v17
  v_accvgpr_write_b32 a72, v18
  v_accvgpr_read_b32 v19, a73
  v_mul_f32 v19, v19, v17
  v_accvgpr_write_b32 a73, v19
  v_accvgpr_read_b32 v18, a74
  v_mul_f32 v18, v18, v17
  v_accvgpr_write_b32 a74, v18
  v_accvgpr_read_b32 v19, a75
  v_mul_f32 v19, v19, v17
  v_accvgpr_write_b32 a75, v19
  v_accvgpr_read_b32 v18, a76
  v_mul_f32 v18, v18, v17
  v_accvgpr_write_b32 a76, v18
  v_accvgpr_read_b32 v19, a77
  v_mul_f32 v19, v19, v17
  v_accvgpr_write_b32 a77, v19
  v_accvgpr_read_b32 v18, a78
  v_mul_f32 v18, v18, v17
  v_accvgpr_write_b32 a78, v18
  v_accvgpr_read_b32 v19, a79
  v_mul_f32 v19, v19, v17
  v_accvgpr_write_b32 a79, v19
  v_accvgpr_read_b32 v18, a80
  v_mul_f32 v18, v18, v17
  v_accvgpr_write_b32 a80, v18
  v_accvgpr_read_b32 v19, a81
  v_mul_f32 v19, v19, v17
  v_accvgpr_write_b32 a81, v19
  v_accvgpr_read_b32 v18, a82
  v_mul_f32 v18, v18, v17
  v_accvgpr_write_b32 a82, v18
  v_accvgpr_read_b32 v19, a83
  v_mul_f32 v19, v19, v17
  v_accvgpr_write_b32 a83, v19
  v_accvgpr_read_b32 v18, a84
  v_mul_f32 v18, v18, v17
  v_accvgpr_write_b32 a84, v18
  v_accvgpr_read_b32 v19, a85
  v_mul_f32 v19, v19, v17
  v_accvgpr_write_b32 a85, v19
  v_accvgpr_read_b32 v18, a86
  v_mul_f32 v18, v18, v17
  v_accvgpr_write_b32 a86, v18
  v_accvgpr_read_b32 v19, a87
  v_mul_f32 v19, v19, v17
  v_accvgpr_write_b32 a87, v19
  v_accvgpr_read_b32 v18, a88
  v_mul_f32 v18, v18, v17
  v_accvgpr_write_b32 a88, v18
  v_accvgpr_read_b32 v19, a89
  v_mul_f32 v19, v19, v17
  v_accvgpr_write_b32 a89, v19
  v_accvgpr_read_b32 v18, a90
  v_mul_f32 v18, v18, v17
  v_accvgpr_write_b32 a90, v18
  v_accvgpr_read_b32 v19, a91
  v_mul_f32 v19, v19, v17
  v_accvgpr_write_b32 a91, v19
  v_accvgpr_read_b32 v18, a92
  v_mul_f32 v18, v18, v17
  v_accvgpr_write_b32 a92, v18
  v_accvgpr_read_b32 v19, a93
  v_mul_f32 v19, v19, v17
  v_accvgpr_write_b32 a93, v19
  v_accvgpr_read_b32 v18, a94
  v_mul_f32 v18, v18, v17
  v_accvgpr_write_b32 a94, v18
  v_accvgpr_read_b32 v19, a95
  v_mul_f32 v19, v19, v17
  v_accvgpr_write_b32 a95, v19
  v_mov_b32 v20, v10
  v_mov_b32 v21, v10
  v_mov_b32 v22, v10
  v_mov_b32 v23, v10
  ds_write_b128 v3, v[20:23] offset:1024
  v_exp_f32 v16, v144
  v_exp_f32 v17, v145
  v_exp_f32 v18, v146
  v_exp_f32 v19, v147
  v_add_f32 v0, v16, v17
  v_cvt_pk_bf16_f32 v176, v16, v17
  v_exp_f32 v16, v148
  v_exp_f32 v17, v149
  v_add_f32 v0, v0, v18
  v_add_f32 v0, v0, v19
  v_cvt_pk_bf16_f32 v177, v18, v19
  v_exp_f32 v18, v150
  v_exp_f32 v19, v151
  v_add_f32 v0, v0, v16
  v_add_f32 v0, v0, v17
  v_cvt_pk_bf16_f32 v178, v16, v17
  v_exp_f32 v16, v152
  v_exp_f32 v17, v153
  v_add_f32 v0, v0, v18
  v_add_f32 v0, v0, v19
  v_cvt_pk_bf16_f32 v179, v18, v19
  v_exp_f32 v18, v154
  v_exp_f32 v19, v155
  v_add_f32 v0, v0, v16
  v_add_f32 v0, v0, v17
  v_cvt_pk_bf16_f32 v180, v16, v17
  v_exp_f32 v16, v156
  v_exp_f32 v17, v157
  v_add_f32 v0, v0, v18
  v_add_f32 v0, v0, v19
  v_cvt_pk_bf16_f32 v181, v18, v19
  v_exp_f32 v18, v158
  v_exp_f32 v19, v159
  v_add_f32 v0, v0, v16
  v_add_f32 v0, v0, v17
  v_cvt_pk_bf16_f32 v182, v16, v17
  v_add_f32 v0, v0, v18
  v_add_f32 v0, v0, v19
  v_cvt_pk_bf16_f32 v183, v18, v19
  s_waitcnt lgkmcnt(0)
  s_nop 1
  s_branch Lret_6
Lslow_7:
  s_nop 7
  v_max3_f32 v16, v160, v161, v162
  v_max3_f32 v16, v16, v163, v164
  v_max3_f32 v16, v16, v165, v166
  v_max3_f32 v16, v16, v167, v168
  v_max3_f32 v16, v16, v169, v170
  v_max3_f32 v16, v16, v171, v172
  v_max3_f32 v16, v16, v173, v174
  v_max_f32 v16, v16, v175
  v_mov_b32 v17, v16
  s_nop 1
  v_permlane32_swap_b32 v16, v17
  s_nop 1
  v_max_f32 v16, v16, v17
  v_ceil_f32 v16, v16
  v_max_f32 v16, 0, v16
  v_sub_f32 v11, v11, v16
  v_sub_f32 v160, v160, v16
  v_sub_f32 v161, v161, v16
  v_sub_f32 v162, v162, v16
  v_sub_f32 v163, v163, v16
  v_sub_f32 v164, v164, v16
  v_sub_f32 v165, v165, v16
  v_sub_f32 v166, v166, v16
  v_sub_f32 v167, v167, v16
  v_sub_f32 v168, v168, v16
  v_sub_f32 v169, v169, v16
  v_sub_f32 v170, v170, v16
  v_sub_f32 v171, v171, v16
  v_sub_f32 v172, v172, v16
  v_sub_f32 v173, v173, v16
  v_sub_f32 v174, v174, v16
  v_sub_f32 v175, v175, v16
  v_max_f32 v17, 0, v16
  v_exp_f32_e64 v17, -v17
  s_nop 1
  v_mul_f32 v6, v6, v17
  v_accvgpr_read_b32 v18, a96
  v_mul_f32 v18, v18, v17
  v_accvgpr_write_b32 a96, v18
  v_accvgpr_read_b32 v19, a97
  v_mul_f32 v19, v19, v17
  v_accvgpr_write_b32 a97, v19
  v_accvgpr_read_b32 v18, a98
  v_mul_f32 v18, v18, v17
  v_accvgpr_write_b32 a98, v18
  v_accvgpr_read_b32 v19, a99
  v_mul_f32 v19, v19, v17
  v_accvgpr_write_b32 a99, v19
  v_accvgpr_read_b32 v18, a100
  v_mul_f32 v18, v18, v17
  v_accvgpr_write_b32 a100, v18
  v_accvgpr_read_b32 v19, a101
  v_mul_f32 v19, v19, v17
  v_accvgpr_write_b32 a101, v19
  v_accvgpr_read_b32 v18, a102
  v_mul_f32 v18, v18, v17
  v_accvgpr_write_b32 a102, v18
  v_accvgpr_read_b32 v19, a103
  v_mul_f32 v19, v19, v17
  v_accvgpr_write_b32 a103, v19
  v_accvgpr_read_b32 v18, a104
  v_mul_f32 v18, v18, v17
  v_accvgpr_write_b32 a104, v18
  v_accvgpr_read_b32 v19, a105
  v_mul_f32 v19, v19, v17
  v_accvgpr_write_b32 a105, v19
  v_accvgpr_read_b32 v18, a106
  v_mul_f32 v18, v18, v17
  v_accvgpr_write_b32 a106, v18
  v_accvgpr_read_b32 v19, a107
  v_mul_f32 v19, v19, v17
  v_accvgpr_write_b32 a107, v19
  v_accvgpr_read_b32 v18, a108
  v_mul_f32 v18, v18, v17
  v_accvgpr_write_b32 a108, v18
  v_accvgpr_read_b32 v19, a109
  v_mul_f32 v19, v19, v17
  v_accvgpr_write_b32 a109, v19
  v_accvgpr_read_b32 v18, a110
  v_mul_f32 v18, v18, v17
  v_accvgpr_write_b32 a110, v18
  v_accvgpr_read_b32 v19, a111
  v_mul_f32 v19, v19, v17
  v_accvgpr_write_b32 a111, v19
  v_accvgpr_read_b32 v18, a112
  v_mul_f32 v18, v18, v17
  v_accvgpr_write_b32 a112, v18
  v_accvgpr_read_b32 v19, a113
  v_mul_f32 v19, v19, v17
  v_accvgpr_write_b32 a113, v19
  v_accvgpr_read_b32 v18, a114
  v_mul_f32 v18, v18, v17
  v_accvgpr_write_b32 a114, v18
  v_accvgpr_read_b32 v19, a115
  v_mul_f32 v19, v19, v17
  v_accvgpr_write_b32 a115, v19
  v_accvgpr_read_b32 v18, a116
  v_mul_f32 v18, v18, v17
  v_accvgpr_write_b32 a116, v18
  v_accvgpr_read_b32 v19, a117
  v_mul_f32 v19, v19, v17
  v_accvgpr_write_b32 a117, v19
  v_accvgpr_read_b32 v18, a118
  v_mul_f32 v18, v18, v17
  v_accvgpr_write_b32 a118, v18
  v_accvgpr_read_b32 v19, a119
  v_mul_f32 v19, v19, v17
  v_accvgpr_write_b32 a119, v19
  v_accvgpr_read_b32 v18, a120
  v_mul_f32 v18, v18, v17
  v_accvgpr_write_b32 a120, v18
  v_accvgpr_read_b32 v19, a121
  v_mul_f32 v19, v19, v17
  v_accvgpr_write_b32 a121, v19
  v_accvgpr_read_b32 v18, a122
  v_mul_f32 v18, v18, v17
  v_accvgpr_write_b32 a122, v18
  v_accvgpr_read_b32 v19, a123
  v_mul_f32 v19, v19, v17
  v_accvgpr_write_b32 a123, v19
  v_accvgpr_read_b32 v18, a124
  v_mul_f32 v18, v18, v17
  v_accvgpr_write_b32 a124, v18
  v_accvgpr_read_b32 v19, a125
  v_mul_f32 v19, v19, v17
  v_accvgpr_write_b32 a125, v19
  v_accvgpr_read_b32 v18, a126
  v_mul_f32 v18, v18, v17
  v_accvgpr_write_b32 a126, v18
  v_accvgpr_read_b32 v19, a127
  v_mul_f32 v19, v19, v17
  v_accvgpr_write_b32 a127, v19
  v_accvgpr_read_b32 v18, a128
  v_mul_f32 v18, v18, v17
  v_accvgpr_write_b32 a128, v18
  v_accvgpr_read_b32 v19, a129
  v_mul_f32 v19, v19, v17
  v_accvgpr_write_b32 a129, v19
  v_accvgpr_read_b32 v18, a130
  v_mul_f32 v18, v18, v17
  v_accvgpr_write_b32 a130, v18
  v_accvgpr_read_b32 v19, a131
  v_mul_f32 v19, v19, v17
  v_accvgpr_write_b32 a131, v19
  v_accvgpr_read_b32 v18, a132
  v_mul_f32 v18, v18, v17
  v_accvgpr_write_b32 a132, v18
  v_accvgpr_read_b32 v19, a133
  v_mul_f32 v19, v19, v17
  v_accvgpr_write_b32 a133, v19
  v_accvgpr_read_b32 v18, a134
  v_mul_f32 v18, v18, v17
  v_accvgpr_write_b32 a134, v18
  v_accvgpr_read_b32 v19, a135
  v_mul_f32 v19, v19, v17
  v_accvgpr_write_b32 a135, v19
  v_accvgpr_read_b32 v18, a136
  v_mul_f32 v18, v18, v17
  v_accvgpr_write_b32 a136, v18
  v_accvgpr_read_b32 v19, a137
  v_mul_f32 v19, v19, v17
  v_accvgpr_write_b32 a137, v19
  v_accvgpr_read_b32 v18, a138
  v_mul_f32 v18, v18, v17
  v_accvgpr_write_b32 a138, v18
  v_accvgpr_read_b32 v19, a139
  v_mul_f32 v19, v19, v17
  v_accvgpr_write_b32 a139, v19
  v_accvgpr_read_b32 v18, a140
  v_mul_f32 v18, v18, v17
  v_accvgpr_write_b32 a140, v18
  v_accvgpr_read_b32 v19, a141
  v_mul_f32 v19, v19, v17
  v_accvgpr_write_b32 a141, v19
  v_accvgpr_read_b32 v18, a142
  v_mul_f32 v18, v18, v17
  v_accvgpr_write_b32 a142, v18
  v_accvgpr_read_b32 v19, a143
  v_mul_f32 v19, v19, v17
  v_accvgpr_write_b32 a143, v19
  v_mov_b32 v20, v11
  v_mov_b32 v21, v11
  v_mov_b32 v22, v11
  v_mov_b32 v23, v11
  ds_write_b128 v3, v[20:23] offset:2048
  v_exp_f32 v16, v160
  v_exp_f32 v17, v161
  v_exp_f32 v18, v162
  v_exp_f32 v19, v163
  v_add_f32 v0, v16, v17
  v_cvt_pk_bf16_f32 v184, v16, v17
  v_exp_f32 v16, v164
  v_exp_f32 v17, v165
  v_add_f32 v0, v0, v18
  v_add_f32 v0, v0, v19
  v_cvt_pk_bf16_f32 v185, v18, v19
  v_exp_f32 v18, v166
  v_exp_f32 v19, v167
  v_add_f32 v0, v0, v16
  v_add_f32 v0, v0, v17
  v_cvt_pk_bf16_f32 v186, v16, v17
  v_exp_f32 v16, v168
  v_exp_f32 v17, v169
  v_add_f32 v0, v0, v18
  v_add_f32 v0, v0, v19
  v_cvt_pk_bf16_f32 v187, v18, v19
  v_exp_f32 v18, v170
  v_exp_f32 v19, v171
  v_add_f32 v0, v0, v16
  v_add_f32 v0, v0, v17
  v_cvt_pk_bf16_f32 v188, v16, v17
  v_exp_f32 v16, v172
  v_exp_f32 v17, v173
  v_add_f32 v0, v0, v18
  v_add_f32 v0, v0, v19
  v_cvt_pk_bf16_f32 v189, v18, v19
  v_exp_f32 v18, v174
  v_exp_f32 v19, v175
  v_add_f32 v0, v0, v16
  v_add_f32 v0, v0, v17
  v_cvt_pk_bf16_f32 v190, v16, v17
  v_add_f32 v0, v0, v18
  v_add_f32 v0, v0, v19
  v_cvt_pk_bf16_f32 v191, v18, v19
  s_waitcnt lgkmcnt(0)
  s_nop 1
  s_branch Lret_7
Lslow_8:
  s_nop 7
  v_max3_f32 v16, v144, v145, v146
  v_max3_f32 v16, v16, v147, v148
  v_max3_f32 v16, v16, v149, v150
  v_max3_f32 v16, v16, v151, v152
  v_max3_f32 v16, v16, v153, v154
  v_max3_f32 v16, v16, v155, v156
  v_max3_f32 v16, v16, v157, v158
  v_max_f32 v16, v16, v159
  v_mov_b32 v17, v16
  s_nop 1
  v_permlane32_swap_b32 v16, v17
  s_nop 1
  v_max_f32 v16, v16, v17
  v_ceil_f32 v16, v16
  v_max_f32 v16, 0, v16
  v_sub_f32 v12, v12, v16
  v_sub_f32 v144, v144, v16
  v_sub_f32 v145, v145, v16
  v_sub_f32 v146, v146, v16
  v_sub_f32 v147, v147, v16
  v_sub_f32 v148, v148, v16
  v_sub_f32 v149, v149, v16
  v_sub_f32 v150, v150, v16
  v_sub_f32 v151, v151, v16
  v_sub_f32 v152, v152, v16
  v_sub_f32 v153, v153, v16
  v_sub_f32 v154, v154, v16
  v_sub_f32 v155, v155, v16
  v_sub_f32 v156, v156, v16
  v_sub_f32 v157, v157, v16
  v_sub_f32 v158, v158, v16
  v_sub_f32 v159, v159, v16
  v_max_f32 v17, 0, v16
  v_exp_f32_e64 v17, -v17
  s_nop 1
  v_mul_f32 v7, v7, v17
  v_accvgpr_read_b32 v18, a144
  v_mul_f32 v18, v18, v17
  v_accvgpr_write_b32 a144, v18
  v_accvgpr_read_b32 v19, a145
  v_mul_f32 v19, v19, v17
  v_accvgpr_write_b32 a145, v19
  v_accvgpr_read_b32 v18, a146
  v_mul_f32 v18, v18, v17
  v_accvgpr_write_b32 a146, v18
  v_accvgpr_read_b32 v19, a147
  v_mul_f32 v19, v19, v17
  v_accvgpr_write_b32 a147, v19
  v_accvgpr_read_b32 v18, a148
  v_mul_f32 v18, v18, v17
  v_accvgpr_write_b32 a148, v18
  v_accvgpr_read_b32 v19, a149
  v_mul_f32 v19, v19, v17
  v_accvgpr_write_b32 a149, v19
  v_accvgpr_read_b32 v18, a150
  v_mul_f32 v18, v18, v17
  v_accvgpr_write_b32 a150, v18
  v_accvgpr_read_b32 v19, a151
  v_mul_f32 v19, v19, v17
  v_accvgpr_write_b32 a151, v19
  v_accvgpr_read_b32 v18, a152
  v_mul_f32 v18, v18, v17
  v_accvgpr_write_b32 a152, v18
  v_accvgpr_read_b32 v19, a153
  v_mul_f32 v19, v19, v17
  v_accvgpr_write_b32 a153, v19
  v_accvgpr_read_b32 v18, a154
  v_mul_f32 v18, v18, v17
  v_accvgpr_write_b32 a154, v18
  v_accvgpr_read_b32 v19, a155
  v_mul_f32 v19, v19, v17
  v_accvgpr_write_b32 a155, v19
  v_accvgpr_read_b32 v18, a156
  v_mul_f32 v18, v18, v17
  v_accvgpr_write_b32 a156, v18
  v_accvgpr_read_b32 v19, a157
  v_mul_f32 v19, v19, v17
  v_accvgpr_write_b32 a157, v19
  v_accvgpr_read_b32 v18, a158
  v_mul_f32 v18, v18, v17
  v_accvgpr_write_b32 a158, v18
  v_accvgpr_read_b32 v19, a159
  v_mul_f32 v19, v19, v17
  v_accvgpr_write_b32 a159, v19
  v_accvgpr_read_b32 v18, a160
  v_mul_f32 v18, v18, v17
  v_accvgpr_write_b32 a160, v18
  v_accvgpr_read_b32 v19, a161
  v_mul_f32 v19, v19, v17
  v_accvgpr_write_b32 a161, v19
  v_accvgpr_read_b32 v18, a162
  v_mul_f32 v18, v18, v17
  v_accvgpr_write_b32 a162, v18
  v_accvgpr_read_b32 v19, a163
  v_mul_f32 v19, v19, v17
  v_accvgpr_write_b32 a163, v19
  v_accvgpr_read_b32 v18, a164
  v_mul_f32 v18, v18, v17
  v_accvgpr_write_b32 a164, v18
  v_accvgpr_read_b32 v19, a165
  v_mul_f32 v19, v19, v17
  v_accvgpr_write_b32 a165, v19
  v_accvgpr_read_b32 v18, a166
  v_mul_f32 v18, v18, v17
  v_accvgpr_write_b32 a166, v18
  v_accvgpr_read_b32 v19, a167
  v_mul_f32 v19, v19, v17
  v_accvgpr_write_b32 a167, v19
  v_accvgpr_read_b32 v18, a168
  v_mul_f32 v18, v18, v17
  v_accvgpr_write_b32 a168, v18
  v_accvgpr_read_b32 v19, a169
  v_mul_f32 v19, v19, v17
  v_accvgpr_write_b32 a169, v19
  v_accvgpr_read_b32 v18, a170
  v_mul_f32 v18, v18, v17
  v_accvgpr_write_b32 a170, v18
  v_accvgpr_read_b32 v19, a171
  v_mul_f32 v19, v19, v17
  v_accvgpr_write_b32 a171, v19
  v_accvgpr_read_b32 v18, a172
  v_mul_f32 v18, v18, v17
  v_accvgpr_write_b32 a172, v18
  v_accvgpr_read_b32 v19, a173
  v_mul_f32 v19, v19, v17
  v_accvgpr_write_b32 a173, v19
  v_accvgpr_read_b32 v18, a174
  v_mul_f32 v18, v18, v17
  v_accvgpr_write_b32 a174, v18
  v_accvgpr_read_b32 v19, a175
  v_mul_f32 v19, v19, v17
  v_accvgpr_write_b32 a175, v19
  v_accvgpr_read_b32 v18, a176
  v_mul_f32 v18, v18, v17
  v_accvgpr_write_b32 a176, v18
  v_accvgpr_read_b32 v19, a177
  v_mul_f32 v19, v19, v17
  v_accvgpr_write_b32 a177, v19
  v_accvgpr_read_b32 v18, a178
  v_mul_f32 v18, v18, v17
  v_accvgpr_write_b32 a178, v18
  v_accvgpr_read_b32 v19, a179
  v_mul_f32 v19, v19, v17
  v_accvgpr_write_b32 a179, v19
  v_accvgpr_read_b32 v18, a180
  v_mul_f32 v18, v18, v17
  v_accvgpr_write_b32 a180, v18
  v_accvgpr_read_b32 v19, a181
  v_mul_f32 v19, v19, v17
  v_accvgpr_write_b32 a181, v19
  v_accvgpr_read_b32 v18, a182
  v_mul_f32 v18, v18, v17
  v_accvgpr_write_b32 a182, v18
  v_accvgpr_read_b32 v19, a183
  v_mul_f32 v19, v19, v17
  v_accvgpr_write_b32 a183, v19
  v_accvgpr_read_b32 v18, a184
  v_mul_f32 v18, v18, v17
  v_accvgpr_write_b32 a184, v18
  v_accvgpr_read_b32 v19, a185
  v_mul_f32 v19, v19, v17
  v_accvgpr_write_b32 a185, v19
  v_accvgpr_read_b32 v18, a186
  v_mul_f32 v18, v18, v17
  v_accvgpr_write_b32 a186, v18
  v_accvgpr_read_b32 v19, a187
  v_mul_f32 v19, v19, v17
  v_accvgpr_write_b32 a187, v19
  v_accvgpr_read_b32 v18, a188
  v_mul_f32 v18, v18, v17
  v_accvgpr_write_b32 a188, v18
  v_accvgpr_read_b32 v19, a189
  v_mul_f32 v19, v19, v17
  v_accvgpr_write_b32 a189, v19
  v_accvgpr_read_b32 v18, a190
  v_mul_f32 v18, v18, v17
  v_accvgpr_write_b32 a190, v18
  v_accvgpr_read_b32 v19, a191
  v_mul_f32 v19, v19, v17
  v_accvgpr_write_b32 a191, v19
  v_mov_b32 v20, v12
  v_mov_b32 v21, v12
  v_mov_b32 v22, v12
  v_mov_b32 v23, v12
  ds_write_b128 v3, v[20:23] offset:3072
  v_exp_f32 v16, v144
  v_exp_f32 v17, v145
  v_exp_f32 v18, v146
  v_exp_f32 v19, v147
  v_add_f32 v0, v16, v17
  v_cvt_pk_bf16_f32 v176, v16, v17
  v_exp_f32 v16, v148
  v_exp_f32 v17, v149
  v_add_f32 v0, v0, v18
  v_add_f32 v0, v0, v19
  v_cvt_pk_bf16_f32 v177, v18, v19
  v_exp_f32 v18, v150
  v_exp_f32 v19, v151
  v_add_f32 v0, v0, v16
  v_add_f32 v0, v0, v17
  v_cvt_pk_bf16_f32 v178, v16, v17
  v_exp_f32 v16, v152
  v_exp_f32 v17, v153
  v_add_f32 v0, v0, v18
  v_add_f32 v0, v0, v19
  v_cvt_pk_bf16_f32 v179, v18, v19
  v_exp_f32 v18, v154
  v_exp_f32 v19, v155
  v_add_f32 v0, v0, v16
  v_add_f32 v0, v0, v17
  v_cvt_pk_bf16_f32 v180, v16, v17
  v_exp_f32 v16, v156
  v_exp_f32 v17, v157
  v_add_f32 v0, v0, v18
  v_add_f32 v0, v0, v19
  v_cvt_pk_bf16_f32 v181, v18, v19
  v_exp_f32 v18, v158
  v_exp_f32 v19, v159
  v_add_f32 v0, v0, v16
  v_add_f32 v0, v0, v17
  v_cvt_pk_bf16_f32 v182, v16, v17
  v_add_f32 v0, v0, v18
  v_add_f32 v0, v0, v19
  v_cvt_pk_bf16_f32 v183, v18, v19
  s_waitcnt lgkmcnt(0)
  s_nop 1
  s_branch Lret_8
Lslow_9:
  s_nop 7
  v_max3_f32 v16, v160, v161, v162
  v_max3_f32 v16, v16, v163, v164
  v_max3_f32 v16, v16, v165, v166
  v_max3_f32 v16, v16, v167, v168
  v_max3_f32 v16, v16, v169, v170
  v_max3_f32 v16, v16, v171, v172
  v_max3_f32 v16, v16, v173, v174
  v_max_f32 v16, v16, v175
  v_mov_b32 v17, v16
  s_nop 1
  v_permlane32_swap_b32 v16, v17
  s_nop 1
  v_max_f32 v16, v16, v17
  v_ceil_f32 v16, v16
  v_max_f32 v16, s26, v16
  v_sub_f32 v9, v9, v16
  v_sub_f32 v160, v160, v16
  v_sub_f32 v161, v161, v16
  v_sub_f32 v162, v162, v16
  v_sub_f32 v163, v163, v16
  v_sub_f32 v164, v164, v16
  v_sub_f32 v165, v165, v16
  v_sub_f32 v166, v166, v16
  v_sub_f32 v167, v167, v16
  v_sub_f32 v168, v168, v16
  v_sub_f32 v169, v169, v16
  v_sub_f32 v170, v170, v16
  v_sub_f32 v171, v171, v16
  v_sub_f32 v172, v172, v16
  v_sub_f32 v173, v173, v16
  v_sub_f32 v174, v174, v16
  v_sub_f32 v175, v175, v16
  v_max_f32 v17, 0, v16
  v_exp_f32_e64 v17, -v17
  s_nop 1
  v_mul_f32 v4, v4, v17
  v_accvgpr_read_b32 v18, a0
  v_mul_f32 v18, v18, v17
  v_accvgpr_write_b32 a0, v18
  v_accvgpr_read_b32 v19, a1
  v_mul_f32 v19, v19, v17
  v_accvgpr_write_b32 a1, v19
  v_accvgpr_read_b32 v18, a2
  v_mul_f32 v18, v18, v17
  v_accvgpr_write_b32 a2, v18
  v_accvgpr_read_b32 v19, a3
  v_mul_f32 v19, v19, v17
  v_accvgpr_write_b32 a3, v19
  v_accvgpr_read_b32 v18, a4
  v_mul_f32 v18, v18, v17
  v_accvgpr_write_b32 a4, v18
  v_accvgpr_read_b32 v19, a5
  v_mul_f32 v19, v19, v17
  v_accvgpr_write_b32 a5, v19
  v_accvgpr_read_b32 v18, a6
  v_mul_f32 v18, v18, v17
  v_accvgpr_write_b32 a6, v18
  v_accvgpr_read_b32 v19, a7
  v_mul_f32 v19, v19, v17
  v_accvgpr_write_b32 a7, v19
  v_accvgpr_read_b32 v18, a8
  v_mul_f32 v18, v18, v17
  v_accvgpr_write_b32 a8, v18
  v_accvgpr_read_b32 v19, a9
  v_mul_f32 v19, v19, v17
  v_accvgpr_write_b32 a9, v19
  v_accvgpr_read_b32 v18, a10
  v_mul_f32 v18, v18, v17
  v_accvgpr_write_b32 a10, v18
  v_accvgpr_read_b32 v19, a11
  v_mul_f32 v19, v19, v17
  v_accvgpr_write_b32 a11, v19
  v_accvgpr_read_b32 v18, a12
  v_mul_f32 v18, v18, v17
  v_accvgpr_write_b32 a12, v18
  v_accvgpr_read_b32 v19, a13
  v_mul_f32 v19, v19, v17
  v_accvgpr_write_b32 a13, v19
  v_accvgpr_read_b32 v18, a14
  v_mul_f32 v18, v18, v17
  v_accvgpr_write_b32 a14, v18
  v_accvgpr_read_b32 v19, a15
  v_mul_f32 v19, v19, v17
  v_accvgpr_write_b32 a15, v19
  v_accvgpr_read_b32 v18, a16
  v_mul_f32 v18, v18, v17
  v_accvgpr_write_b32 a16, v18
  v_accvgpr_read_b32 v19, a17
  v_mul_f32 v19, v19, v17
  v_accvgpr_write_b32 a17, v19
  v_accvgpr_read_b32 v18, a18
  v_mul_f32 v18, v18, v17
  v_accvgpr_write_b32 a18, v18
  v_accvgpr_read_b32 v19, a19
  v_mul_f32 v19, v19, v17
  v_accvgpr_write_b32 a19, v19
  v_accvgpr_read_b32 v18, a20
  v_mul_f32 v18, v18, v17
  v_accvgpr_write_b32 a20, v18
  v_accvgpr_read_b32 v19, a21
  v_mul_f32 v19, v19, v17
  v_accvgpr_write_b32 a21, v19
  v_accvgpr_read_b32 v18, a22
  v_mul_f32 v18, v18, v17
  v_accvgpr_write_b32 a22, v18
  v_accvgpr_read_b32 v19, a23
  v_mul_f32 v19, v19, v17
  v_accvgpr_write_b32 a23, v19
  v_accvgpr_read_b32 v18, a24
  v_mul_f32 v18, v18, v17
  v_accvgpr_write_b32 a24, v18
  v_accvgpr_read_b32 v19, a25
  v_mul_f32 v19, v19, v17
  v_accvgpr_write_b32 a25, v19
  v_accvgpr_read_b32 v18, a26
  v_mul_f32 v18, v18, v17
  v_accvgpr_write_b32 a26, v18
  v_accvgpr_read_b32 v19, a27
  v_mul_f32 v19, v19, v17
  v_accvgpr_write_b32 a27, v19
  v_accvgpr_read_b32 v18, a28
  v_mul_f32 v18, v18, v17
  v_accvgpr_write_b32 a28, v18
  v_accvgpr_read_b32 v19, a29
  v_mul_f32 v19, v19, v17
  v_accvgpr_write_b32 a29, v19
  v_accvgpr_read_b32 v18, a30
  v_mul_f32 v18, v18, v17
  v_accvgpr_write_b32 a30, v18
  v_accvgpr_read_b32 v19, a31
  v_mul_f32 v19, v19, v17
  v_accvgpr_write_b32 a31, v19
  v_accvgpr_read_b32 v18, a32
  v_mul_f32 v18, v18, v17
  v_accvgpr_write_b32 a32, v18
  v_accvgpr_read_b32 v19, a33
  v_mul_f32 v19, v19, v17
  v_accvgpr_write_b32 a33, v19
  v_accvgpr_read_b32 v18, a34
  v_mul_f32 v18, v18, v17
  v_accvgpr_write_b32 a34, v18
  v_accvgpr_read_b32 v19, a35
  v_mul_f32 v19, v19, v17
  v_accvgpr_write_b32 a35, v19
  v_accvgpr_read_b32 v18, a36
  v_mul_f32 v18, v18, v17
  v_accvgpr_write_b32 a36, v18
  v_accvgpr_read_b32 v19, a37
  v_mul_f32 v19, v19, v17
  v_accvgpr_write_b32 a37, v19
  v_accvgpr_read_b32 v18, a38
  v_mul_f32 v18, v18, v17
  v_accvgpr_write_b32 a38, v18
  v_accvgpr_read_b32 v19, a39
  v_mul_f32 v19, v19, v17
  v_accvgpr_write_b32 a39, v19
  v_accvgpr_read_b32 v18, a40
  v_mul_f32 v18, v18, v17
  v_accvgpr_write_b32 a40, v18
  v_accvgpr_read_b32 v19, a41
  v_mul_f32 v19, v19, v17
  v_accvgpr_write_b32 a41, v19
  v_accvgpr_read_b32 v18, a42
  v_mul_f32 v18, v18, v17
  v_accvgpr_write_b32 a42, v18
  v_accvgpr_read_b32 v19, a43
  v_mul_f32 v19, v19, v17
  v_accvgpr_write_b32 a43, v19
  v_accvgpr_read_b32 v18, a44
  v_mul_f32 v18, v18, v17
  v_accvgpr_write_b32 a44, v18
  v_accvgpr_read_b32 v19, a45
  v_mul_f32 v19, v19, v17
  v_accvgpr_write_b32 a45, v19
  v_accvgpr_read_b32 v18, a46
  v_mul_f32 v18, v18, v17
  v_accvgpr_write_b32 a46, v18
  v_accvgpr_read_b32 v19, a47
  v_mul_f32 v19, v19, v17
  v_accvgpr_write_b32 a47, v19
  v_mov_b32 v20, v9
  v_mov_b32 v21, v9
  v_mov_b32 v22, v9
  v_mov_b32 v23, v9
  ds_write_b128 v3, v[20:23] offset:0
  v_exp_f32 v16, v160
  v_exp_f32 v17, v161
  v_exp_f32 v18, v162
  v_exp_f32 v19, v163
  v_add_f32 v0, v16, v17
  v_cvt_pk_bf16_f32 v184, v16, v17
  v_exp_f32 v16, v164
  v_exp_f32 v17, v165
  v_add_f32 v0, v0, v18
  v_add_f32 v0, v0, v19
  v_cvt_pk_bf16_f32 v185, v18, v19
  v_exp_f32 v18, v166
  v_exp_f32 v19, v167
  v_add_f32 v0, v0, v16
  v_add_f32 v0, v0, v17
  v_cvt_pk_bf16_f32 v186, v16, v17
  v_exp_f32 v16, v168
  v_exp_f32 v17, v169
  v_add_f32 v0, v0, v18
  v_add_f32 v0, v0, v19
  v_cvt_pk_bf16_f32 v187, v18, v19
  v_exp_f32 v18, v170
  v_exp_f32 v19, v171
  v_add_f32 v0, v0, v16
  v_add_f32 v0, v0, v17
  v_cvt_pk_bf16_f32 v188, v16, v17
  v_exp_f32 v16, v172
  v_exp_f32 v17, v173
  v_add_f32 v0, v0, v18
  v_add_f32 v0, v0, v19
  v_cvt_pk_bf16_f32 v189, v18, v19
  v_exp_f32 v18, v174
  v_exp_f32 v19, v175
  v_add_f32 v0, v0, v16
  v_add_f32 v0, v0, v17
  v_cvt_pk_bf16_f32 v190, v16, v17
  v_add_f32 v0, v0, v18
  v_add_f32 v0, v0, v19
  v_cvt_pk_bf16_f32 v191, v18, v19
  s_waitcnt lgkmcnt(0)
  s_nop 1
  s_branch Lret_9
Lslow_10:
  s_nop 7
  v_max3_f32 v16, v144, v145, v146
  v_max3_f32 v16, v16, v147, v148
  v_max3_f32 v16, v16, v149, v150
  v_max3_f32 v16, v16, v151, v152
  v_max3_f32 v16, v16, v153, v154
  v_max3_f32 v16, v16, v155, v156
  v_max3_f32 v16, v16, v157, v158
  v_max_f32 v16, v16, v159
  v_mov_b32 v17, v16
  s_nop 1
  v_permlane32_swap_b32 v16, v17
  s_nop 1
  v_max_f32 v16, v16, v17
  v_ceil_f32 v16, v16
  v_max_f32 v16, s26, v16
  v_sub_f32 v10, v10, v16
  v_sub_f32 v144, v144, v16
  v_sub_f32 v145, v145, v16
  v_sub_f32 v146, v146, v16
  v_sub_f32 v147, v147, v16
  v_sub_f32 v148, v148, v16
  v_sub_f32 v149, v149, v16
  v_sub_f32 v150, v150, v16
  v_sub_f32 v151, v151, v16
  v_sub_f32 v152, v152, v16
  v_sub_f32 v153, v153, v16
  v_sub_f32 v154, v154, v16
  v_sub_f32 v155, v155, v16
  v_sub_f32 v156, v156, v16
  v_sub_f32 v157, v157, v16
  v_sub_f32 v158, v158, v16
  v_sub_f32 v159, v159, v16
  v_max_f32 v17, 0, v16
  v_exp_f32_e64 v17, -v17
  s_nop 1
  v_mul_f32 v5, v5, v17
  v_accvgpr_read_b32 v18, a48
  v_mul_f32 v18, v18, v17
  v_accvgpr_write_b32 a48, v18
  v_accvgpr_read_b32 v19, a49
  v_mul_f32 v19, v19, v17
  v_accvgpr_write_b32 a49, v19
  v_accvgpr_read_b32 v18, a50
  v_mul_f32 v18, v18, v17
  v_accvgpr_write_b32 a50, v18
  v_accvgpr_read_b32 v19, a51
  v_mul_f32 v19, v19, v17
  v_accvgpr_write_b32 a51, v19
  v_accvgpr_read_b32 v18, a52
  v_mul_f32 v18, v18, v17
  v_accvgpr_write_b32 a52, v18
  v_accvgpr_read_b32 v19, a53
  v_mul_f32 v19, v19, v17
  v_accvgpr_write_b32 a53, v19
  v_accvgpr_read_b32 v18, a54
  v_mul_f32 v18, v18, v17
  v_accvgpr_write_b32 a54, v18
  v_accvgpr_read_b32 v19, a55
  v_mul_f32 v19, v19, v17
  v_accvgpr_write_b32 a55, v19
  v_accvgpr_read_b32 v18, a56
  v_mul_f32 v18, v18, v17
  v_accvgpr_write_b32 a56, v18
  v_accvgpr_read_b32 v19, a57
  v_mul_f32 v19, v19, v17
  v_accvgpr_write_b32 a57, v19
  v_accvgpr_read_b32 v18, a58
  v_mul_f32 v18, v18, v17
  v_accvgpr_write_b32 a58, v18
  v_accvgpr_read_b32 v19, a59
  v_mul_f32 v19, v19, v17
  v_accvgpr_write_b32 a59, v19
  v_accvgpr_read_b32 v18, a60
  v_mul_f32 v18, v18, v17
  v_accvgpr_write_b32 a60, v18
  v_accvgpr_read_b32 v19, a61
  v_mul_f32 v19, v19, v17
  v_accvgpr_write_b32 a61, v19
  v_accvgpr_read_b32 v18, a62
  v_mul_f32 v18, v18, v17
  v_accvgpr_write_b32 a62, v18
  v_accvgpr_read_b32 v19, a63
  v_mul_f32 v19, v19, v17
  v_accvgpr_write_b32 a63, v19
  v_accvgpr_read_b32 v18, a64
  v_mul_f32 v18, v18, v17
  v_accvgpr_write_b32 a64, v18
  v_accvgpr_read_b32 v19, a65
  v_mul_f32 v19, v19, v17
  v_accvgpr_write_b32 a65, v19
  v_accvgpr_read_b32 v18, a66
  v_mul_f32 v18, v18, v17
  v_accvgpr_write_b32 a66, v18
  v_accvgpr_read_b32 v19, a67
  v_mul_f32 v19, v19, v17
  v_accvgpr_write_b32 a67, v19
  v_accvgpr_read_b32 v18, a68
  v_mul_f32 v18, v18, v17
  v_accvgpr_write_b32 a68, v18
  v_accvgpr_read_b32 v19, a69
  v_mul_f32 v19, v19, v17
  v_accvgpr_write_b32 a69, v19
  v_accvgpr_read_b32 v18, a70
  v_mul_f32 v18, v18, v17
  v_accvgpr_write_b32 a70, v18
  v_accvgpr_read_b32 v19, a71
  v_mul_f32 v19, v19, v17
  v_accvgpr_write_b32 a71, v19
  v_accvgpr_read_b32 v18, a72
  v_mul_f32 v18, v18, v17
  v_accvgpr_write_b32 a72, v18
  v_accvgpr_read_b32 v19, a73
  v_mul_f32 v19, v19, v17
  v_accvgpr_write_b32 a73, v19
  v_accvgpr_read_b32 v18, a74
  v_mul_f32 v18, v18, v17
  v_accvgpr_write_b32 a74, v18
  v_accvgpr_read_b32 v19, a75
  v_mul_f32 v19, v19, v17
  v_accvgpr_write_b32 a75, v19
  v_accvgpr_read_b32 v18, a76
  v_mul_f32 v18, v18, v17
  v_accvgpr_write_b32 a76, v18
  v_accvgpr_read_b32 v19, a77
  v_mul_f32 v19, v19, v17
  v_accvgpr_write_b32 a77, v19
  v_accvgpr_read_b32 v18, a78
  v_mul_f32 v18, v18, v17
  v_accvgpr_write_b32 a78, v18
  v_accvgpr_read_b32 v19, a79
  v_mul_f32 v19, v19, v17
  v_accvgpr_write_b32 a79, v19
  v_accvgpr_read_b32 v18, a80
  v_mul_f32 v18, v18, v17
  v_accvgpr_write_b32 a80, v18
  v_accvgpr_read_b32 v19, a81
  v_mul_f32 v19, v19, v17
  v_accvgpr_write_b32 a81, v19
  v_accvgpr_read_b32 v18, a82
  v_mul_f32 v18, v18, v17
  v_accvgpr_write_b32 a82, v18
  v_accvgpr_read_b32 v19, a83
  v_mul_f32 v19, v19, v17
  v_accvgpr_write_b32 a83, v19
  v_accvgpr_read_b32 v18, a84
  v_mul_f32 v18, v18, v17
  v_accvgpr_write_b32 a84, v18
  v_accvgpr_read_b32 v19, a85
  v_mul_f32 v19, v19, v17
  v_accvgpr_write_b32 a85, v19
  v_accvgpr_read_b32 v18, a86
  v_mul_f32 v18, v18, v17
  v_accvgpr_write_b32 a86, v18
  v_accvgpr_read_b32 v19, a87
  v_mul_f32 v19, v19, v17
  v_accvgpr_write_b32 a87, v19
  v_accvgpr_read_b32 v18, a88
  v_mul_f32 v18, v18, v17
  v_accvgpr_write_b32 a88, v18
  v_accvgpr_read_b32 v19, a89
  v_mul_f32 v19, v19, v17
  v_accvgpr_write_b32 a89, v19
  v_accvgpr_read_b32 v18, a90
  v_mul_f32 v18, v18, v17
  v_accvgpr_write_b32 a90, v18
  v_accvgpr_read_b32 v19, a91
  v_mul_f32 v19, v19, v17
  v_accvgpr_write_b32 a91, v19
  v_accvgpr_read_b32 v18, a92
  v_mul_f32 v18, v18, v17
  v_accvgpr_write_b32 a92, v18
  v_accvgpr_read_b32 v19, a93
  v_mul_f32 v19, v19, v17
  v_accvgpr_write_b32 a93, v19
  v_accvgpr_read_b32 v18, a94
  v_mul_f32 v18, v18, v17
  v_accvgpr_write_b32 a94, v18
  v_accvgpr_read_b32 v19, a95
  v_mul_f32 v19, v19, v17
  v_accvgpr_write_b32 a95, v19
  v_mov_b32 v20, v10
  v_mov_b32 v21, v10
  v_mov_b32 v22, v10
  v_mov_b32 v23, v10
  ds_write_b128 v3, v[20:23] offset:1024
  v_exp_f32 v16, v144
  v_exp_f32 v17, v145
  v_exp_f32 v18, v146
  v_exp_f32 v19, v147
  v_add_f32 v0, v16, v17
  v_cvt_pk_bf16_f32 v176, v16, v17
  v_exp_f32 v16, v148
  v_exp_f32 v17, v149
  v_add_f32 v0, v0, v18
  v_add_f32 v0, v0, v19
  v_cvt_pk_bf16_f32 v177, v18, v19
  v_exp_f32 v18, v150
  v_exp_f32 v19, v151
  v_add_f32 v0, v0, v16
  v_add_f32 v0, v0, v17
  v_cvt_pk_bf16_f32 v178, v16, v17
  v_exp_f32 v16, v152
  v_exp_f32 v17, v153
  v_add_f32 v0, v0, v18
  v_add_f32 v0, v0, v19
  v_cvt_pk_bf16_f32 v179, v18, v19
  v_exp_f32 v18, v154
  v_exp_f32 v19, v155
  v_add_f32 v0, v0, v16
  v_add_f32 v0, v0, v17
  v_cvt_pk_bf16_f32 v180, v16, v17
  v_exp_f32 v16, v156
  v_exp_f32 v17, v157
  v_add_f32 v0, v0, v18
  v_add_f32 v0, v0, v19
  v_cvt_pk_bf16_f32 v181, v18, v19
  v_exp_f32 v18, v158
  v_exp_f32 v19, v159
  v_add_f32 v0, v0, v16
  v_add_f32 v0, v0, v17
  v_cvt_pk_bf16_f32 v182, v16, v17
  v_add_f32 v0, v0, v18
  v_add_f32 v0, v0, v19
  v_cvt_pk_bf16_f32 v183, v18, v19
  s_waitcnt lgkmcnt(0)
  s_nop 1
  s_branch Lret_10
Lslow_11:
  s_nop 7
  v_max3_f32 v16, v160, v161, v162
  v_max3_f32 v16, v16, v163, v164
  v_max3_f32 v16, v16, v165, v166
  v_max3_f32 v16, v16, v167, v168
  v_max3_f32 v16, v16, v169, v170
  v_max3_f32 v16, v16, v171, v172
  v_max3_f32 v16, v16, v173, v174
  v_max_f32 v16, v16, v175
  v_mov_b32 v17, v16
  s_nop 1
  v_permlane32_swap_b32 v16, v17
  s_nop 1
  v_max_f32 v16, v16, v17
  v_ceil_f32 v16, v16
  v_max_f32 v16, s26, v16
  v_sub_f32 v11, v11, v16
  v_sub_f32 v160, v160, v16
  v_sub_f32 v161, v161, v16
  v_sub_f32 v162, v162, v16
  v_sub_f32 v163, v163, v16
  v_sub_f32 v164, v164, v16
  v_sub_f32 v165, v165, v16
  v_sub_f32 v166, v166, v16
  v_sub_f32 v167, v167, v16
  v_sub_f32 v168, v168, v16
  v_sub_f32 v169, v169, v16
  v_sub_f32 v170, v170, v16
  v_sub_f32 v171, v171, v16
  v_sub_f32 v172, v172, v16
  v_sub_f32 v173, v173, v16
  v_sub_f32 v174, v174, v16
  v_sub_f32 v175, v175, v16
  v_max_f32 v17, 0, v16
  v_exp_f32_e64 v17, -v17
  s_nop 1
  v_mul_f32 v6, v6, v17
  v_accvgpr_read_b32 v18, a96
  v_mul_f32 v18, v18, v17
  v_accvgpr_write_b32 a96, v18
  v_accvgpr_read_b32 v19, a97
  v_mul_f32 v19, v19, v17
  v_accvgpr_write_b32 a97, v19
  v_accvgpr_read_b32 v18, a98
  v_mul_f32 v18, v18, v17
  v_accvgpr_write_b32 a98, v18
  v_accvgpr_read_b32 v19, a99
  v_mul_f32 v19, v19, v17
  v_accvgpr_write_b32 a99, v19
  v_accvgpr_read_b32 v18, a100
  v_mul_f32 v18, v18, v17
  v_accvgpr_write_b32 a100, v18
  v_accvgpr_read_b32 v19, a101
  v_mul_f32 v19, v19, v17
  v_accvgpr_write_b32 a101, v19
  v_accvgpr_read_b32 v18, a102
  v_mul_f32 v18, v18, v17
  v_accvgpr_write_b32 a102, v18
  v_accvgpr_read_b32 v19, a103
  v_mul_f32 v19, v19, v17
  v_accvgpr_write_b32 a103, v19
  v_accvgpr_read_b32 v18, a104
  v_mul_f32 v18, v18, v17
  v_accvgpr_write_b32 a104, v18
  v_accvgpr_read_b32 v19, a105
  v_mul_f32 v19, v19, v17
  v_accvgpr_write_b32 a105, v19
  v_accvgpr_read_b32 v18, a106
  v_mul_f32 v18, v18, v17
  v_accvgpr_write_b32 a106, v18
  v_accvgpr_read_b32 v19, a107
  v_mul_f32 v19, v19, v17
  v_accvgpr_write_b32 a107, v19
  v_accvgpr_read_b32 v18, a108
  v_mul_f32 v18, v18, v17
  v_accvgpr_write_b32 a108, v18
  v_accvgpr_read_b32 v19, a109
  v_mul_f32 v19, v19, v17
  v_accvgpr_write_b32 a109, v19
  v_accvgpr_read_b32 v18, a110
  v_mul_f32 v18, v18, v17
  v_accvgpr_write_b32 a110, v18
  v_accvgpr_read_b32 v19, a111
  v_mul_f32 v19, v19, v17
  v_accvgpr_write_b32 a111, v19
  v_accvgpr_read_b32 v18, a112
  v_mul_f32 v18, v18, v17
  v_accvgpr_write_b32 a112, v18
  v_accvgpr_read_b32 v19, a113
  v_mul_f32 v19, v19, v17
  v_accvgpr_write_b32 a113, v19
  v_accvgpr_read_b32 v18, a114
  v_mul_f32 v18, v18, v17
  v_accvgpr_write_b32 a114, v18
  v_accvgpr_read_b32 v19, a115
  v_mul_f32 v19, v19, v17
  v_accvgpr_write_b32 a115, v19
  v_accvgpr_read_b32 v18, a116
  v_mul_f32 v18, v18, v17
  v_accvgpr_write_b32 a116, v18
  v_accvgpr_read_b32 v19, a117
  v_mul_f32 v19, v19, v17
  v_accvgpr_write_b32 a117, v19
  v_accvgpr_read_b32 v18, a118
  v_mul_f32 v18, v18, v17
  v_accvgpr_write_b32 a118, v18
  v_accvgpr_read_b32 v19, a119
  v_mul_f32 v19, v19, v17
  v_accvgpr_write_b32 a119, v19
  v_accvgpr_read_b32 v18, a120
  v_mul_f32 v18, v18, v17
  v_accvgpr_write_b32 a120, v18
  v_accvgpr_read_b32 v19, a121
  v_mul_f32 v19, v19, v17
  v_accvgpr_write_b32 a121, v19
  v_accvgpr_read_b32 v18, a122
  v_mul_f32 v18, v18, v17
  v_accvgpr_write_b32 a122, v18
  v_accvgpr_read_b32 v19, a123
  v_mul_f32 v19, v19, v17
  v_accvgpr_write_b32 a123, v19
  v_accvgpr_read_b32 v18, a124
  v_mul_f32 v18, v18, v17
  v_accvgpr_write_b32 a124, v18
  v_accvgpr_read_b32 v19, a125
  v_mul_f32 v19, v19, v17
  v_accvgpr_write_b32 a125, v19
  v_accvgpr_read_b32 v18, a126
  v_mul_f32 v18, v18, v17
  v_accvgpr_write_b32 a126, v18
  v_accvgpr_read_b32 v19, a127
  v_mul_f32 v19, v19, v17
  v_accvgpr_write_b32 a127, v19
  v_accvgpr_read_b32 v18, a128
  v_mul_f32 v18, v18, v17
  v_accvgpr_write_b32 a128, v18
  v_accvgpr_read_b32 v19, a129
  v_mul_f32 v19, v19, v17
  v_accvgpr_write_b32 a129, v19
  v_accvgpr_read_b32 v18, a130
  v_mul_f32 v18, v18, v17
  v_accvgpr_write_b32 a130, v18
  v_accvgpr_read_b32 v19, a131
  v_mul_f32 v19, v19, v17
  v_accvgpr_write_b32 a131, v19
  v_accvgpr_read_b32 v18, a132
  v_mul_f32 v18, v18, v17
  v_accvgpr_write_b32 a132, v18
  v_accvgpr_read_b32 v19, a133
  v_mul_f32 v19, v19, v17
  v_accvgpr_write_b32 a133, v19
  v_accvgpr_read_b32 v18, a134
  v_mul_f32 v18, v18, v17
  v_accvgpr_write_b32 a134, v18
  v_accvgpr_read_b32 v19, a135
  v_mul_f32 v19, v19, v17
  v_accvgpr_write_b32 a135, v19
  v_accvgpr_read_b32 v18, a136
  v_mul_f32 v18, v18, v17
  v_accvgpr_write_b32 a136, v18
  v_accvgpr_read_b32 v19, a137
  v_mul_f32 v19, v19, v17
  v_accvgpr_write_b32 a137, v19
  v_accvgpr_read_b32 v18, a138
  v_mul_f32 v18, v18, v17
  v_accvgpr_write_b32 a138, v18
  v_accvgpr_read_b32 v19, a139
  v_mul_f32 v19, v19, v17
  v_accvgpr_write_b32 a139, v19
  v_accvgpr_read_b32 v18, a140
  v_mul_f32 v18, v18, v17
  v_accvgpr_write_b32 a140, v18
  v_accvgpr_read_b32 v19, a141
  v_mul_f32 v19, v19, v17
  v_accvgpr_write_b32 a141, v19
  v_accvgpr_read_b32 v18, a142
  v_mul_f32 v18, v18, v17
  v_accvgpr_write_b32 a142, v18
  v_accvgpr_read_b32 v19, a143
  v_mul_f32 v19, v19, v17
  v_accvgpr_write_b32 a143, v19
  v_mov_b32 v20, v11
  v_mov_b32 v21, v11
  v_mov_b32 v22, v11
  v_mov_b32 v23, v11
  ds_write_b128 v3, v[20:23] offset:2048
  v_exp_f32 v16, v160
  v_exp_f32 v17, v161
  v_exp_f32 v18, v162
  v_exp_f32 v19, v163
  v_add_f32 v0, v16, v17
  v_cvt_pk_bf16_f32 v184, v16, v17
  v_exp_f32 v16, v164
  v_exp_f32 v17, v165
  v_add_f32 v0, v0, v18
  v_add_f32 v0, v0, v19
  v_cvt_pk_bf16_f32 v185, v18, v19
  v_exp_f32 v18, v166
  v_exp_f32 v19, v167
  v_add_f32 v0, v0, v16
  v_add_f32 v0, v0, v17
  v_cvt_pk_bf16_f32 v186, v16, v17
  v_exp_f32 v16, v168
  v_exp_f32 v17, v169
  v_add_f32 v0, v0, v18
  v_add_f32 v0, v0, v19
  v_cvt_pk_bf16_f32 v187, v18, v19
  v_exp_f32 v18, v170
  v_exp_f32 v19, v171
  v_add_f32 v0, v0, v16
  v_add_f32 v0, v0, v17
  v_cvt_pk_bf16_f32 v188, v16, v17
  v_exp_f32 v16, v172
  v_exp_f32 v17, v173
  v_add_f32 v0, v0, v18
  v_add_f32 v0, v0, v19
  v_cvt_pk_bf16_f32 v189, v18, v19
  v_exp_f32 v18, v174
  v_exp_f32 v19, v175
  v_add_f32 v0, v0, v16
  v_add_f32 v0, v0, v17
  v_cvt_pk_bf16_f32 v190, v16, v17
  v_add_f32 v0, v0, v18
  v_add_f32 v0, v0, v19
  v_cvt_pk_bf16_f32 v191, v18, v19
  s_waitcnt lgkmcnt(0)
  s_nop 1
  s_branch Lret_11
Lslow_12:
  s_nop 7
  v_max3_f32 v16, v144, v145, v146
  v_max3_f32 v16, v16, v147, v148
  v_max3_f32 v16, v16, v149, v150
  v_max3_f32 v16, v16, v151, v152
  v_max3_f32 v16, v16, v153, v154
  v_max3_f32 v16, v16, v155, v156
  v_max3_f32 v16, v16, v157, v158
  v_max_f32 v16, v16, v159
  v_mov_b32 v17, v16
  s_nop 1
  v_permlane32_swap_b32 v16, v17
  s_nop 1
  v_max_f32 v16, v16, v17
  v_ceil_f32 v16, v16
  v_max_f32 v16, s26, v16
  v_sub_f32 v12, v12, v16
  v_sub_f32 v144, v144, v16
  v_sub_f32 v145, v145, v16
  v_sub_f32 v146, v146, v16
  v_sub_f32 v147, v147, v16
  v_sub_f32 v148, v148, v16
  v_sub_f32 v149, v149, v16
  v_sub_f32 v150, v150, v16
  v_sub_f32 v151, v151, v16
  v_sub_f32 v152, v152, v16
  v_sub_f32 v153, v153, v16
  v_sub_f32 v154, v154, v16
  v_sub_f32 v155, v155, v16
  v_sub_f32 v156, v156, v16
  v_sub_f32 v157, v157, v16
  v_sub_f32 v158, v158, v16
  v_sub_f32 v159, v159, v16
  v_max_f32 v17, 0, v16
  v_exp_f32_e64 v17, -v17
  s_nop 1
  v_mul_f32 v7, v7, v17
  v_accvgpr_read_b32 v18, a144
  v_mul_f32 v18, v18, v17
  v_accvgpr_write_b32 a144, v18
  v_accvgpr_read_b32 v19, a145
  v_mul_f32 v19, v19, v17
  v_accvgpr_write_b32 a145, v19
  v_accvgpr_read_b32 v18, a146
  v_mul_f32 v18, v18, v17
  v_accvgpr_write_b32 a146, v18
  v_accvgpr_read_b32 v19, a147
  v_mul_f32 v19, v19, v17
  v_accvgpr_write_b32 a147, v19
  v_accvgpr_read_b32 v18, a148
  v_mul_f32 v18, v18, v17
  v_accvgpr_write_b32 a148, v18
  v_accvgpr_read_b32 v19, a149
  v_mul_f32 v19, v19, v17
  v_accvgpr_write_b32 a149, v19
  v_accvgpr_read_b32 v18, a150
  v_mul_f32 v18, v18, v17
  v_accvgpr_write_b32 a150, v18
  v_accvgpr_read_b32 v19, a151
  v_mul_f32 v19, v19, v17
  v_accvgpr_write_b32 a151, v19
  v_accvgpr_read_b32 v18, a152
  v_mul_f32 v18, v18, v17
  v_accvgpr_write_b32 a152, v18
  v_accvgpr_read_b32 v19, a153
  v_mul_f32 v19, v19, v17
  v_accvgpr_write_b32 a153, v19
  v_accvgpr_read_b32 v18, a154
  v_mul_f32 v18, v18, v17
  v_accvgpr_write_b32 a154, v18
  v_accvgpr_read_b32 v19, a155
  v_mul_f32 v19, v19, v17
  v_accvgpr_write_b32 a155, v19
  v_accvgpr_read_b32 v18, a156
  v_mul_f32 v18, v18, v17
  v_accvgpr_write_b32 a156, v18
  v_accvgpr_read_b32 v19, a157
  v_mul_f32 v19, v19, v17
  v_accvgpr_write_b32 a157, v19
  v_accvgpr_read_b32 v18, a158
  v_mul_f32 v18, v18, v17
  v_accvgpr_write_b32 a158, v18
  v_accvgpr_read_b32 v19, a159
  v_mul_f32 v19, v19, v17
  v_accvgpr_write_b32 a159, v19
  v_accvgpr_read_b32 v18, a160
  v_mul_f32 v18, v18, v17
  v_accvgpr_write_b32 a160, v18
  v_accvgpr_read_b32 v19, a161
  v_mul_f32 v19, v19, v17
  v_accvgpr_write_b32 a161, v19
  v_accvgpr_read_b32 v18, a162
  v_mul_f32 v18, v18, v17
  v_accvgpr_write_b32 a162, v18
  v_accvgpr_read_b32 v19, a163
  v_mul_f32 v19, v19, v17
  v_accvgpr_write_b32 a163, v19
  v_accvgpr_read_b32 v18, a164
  v_mul_f32 v18, v18, v17
  v_accvgpr_write_b32 a164, v18
  v_accvgpr_read_b32 v19, a165
  v_mul_f32 v19, v19, v17
  v_accvgpr_write_b32 a165, v19
  v_accvgpr_read_b32 v18, a166
  v_mul_f32 v18, v18, v17
  v_accvgpr_write_b32 a166, v18
  v_accvgpr_read_b32 v19, a167
  v_mul_f32 v19, v19, v17
  v_accvgpr_write_b32 a167, v19
  v_accvgpr_read_b32 v18, a168
  v_mul_f32 v18, v18, v17
  v_accvgpr_write_b32 a168, v18
  v_accvgpr_read_b32 v19, a169
  v_mul_f32 v19, v19, v17
  v_accvgpr_write_b32 a169, v19
  v_accvgpr_read_b32 v18, a170
  v_mul_f32 v18, v18, v17
  v_accvgpr_write_b32 a170, v18
  v_accvgpr_read_b32 v19, a171
  v_mul_f32 v19, v19, v17
  v_accvgpr_write_b32 a171, v19
  v_accvgpr_read_b32 v18, a172
  v_mul_f32 v18, v18, v17
  v_accvgpr_write_b32 a172, v18
  v_accvgpr_read_b32 v19, a173
  v_mul_f32 v19, v19, v17
  v_accvgpr_write_b32 a173, v19
  v_accvgpr_read_b32 v18, a174
  v_mul_f32 v18, v18, v17
  v_accvgpr_write_b32 a174, v18
  v_accvgpr_read_b32 v19, a175
  v_mul_f32 v19, v19, v17
  v_accvgpr_write_b32 a175, v19
  v_accvgpr_read_b32 v18, a176
  v_mul_f32 v18, v18, v17
  v_accvgpr_write_b32 a176, v18
  v_accvgpr_read_b32 v19, a177
  v_mul_f32 v19, v19, v17
  v_accvgpr_write_b32 a177, v19
  v_accvgpr_read_b32 v18, a178
  v_mul_f32 v18, v18, v17
  v_accvgpr_write_b32 a178, v18
  v_accvgpr_read_b32 v19, a179
  v_mul_f32 v19, v19, v17
  v_accvgpr_write_b32 a179, v19
  v_accvgpr_read_b32 v18, a180
  v_mul_f32 v18, v18, v17
  v_accvgpr_write_b32 a180, v18
  v_accvgpr_read_b32 v19, a181
  v_mul_f32 v19, v19, v17
  v_accvgpr_write_b32 a181, v19
  v_accvgpr_read_b32 v18, a182
  v_mul_f32 v18, v18, v17
  v_accvgpr_write_b32 a182, v18
  v_accvgpr_read_b32 v19, a183
  v_mul_f32 v19, v19, v17
  v_accvgpr_write_b32 a183, v19
  v_accvgpr_read_b32 v18, a184
  v_mul_f32 v18, v18, v17
  v_accvgpr_write_b32 a184, v18
  v_accvgpr_read_b32 v19, a185
  v_mul_f32 v19, v19, v17
  v_accvgpr_write_b32 a185, v19
  v_accvgpr_read_b32 v18, a186
  v_mul_f32 v18, v18, v17
  v_accvgpr_write_b32 a186, v18
  v_accvgpr_read_b32 v19, a187
  v_mul_f32 v19, v19, v17
  v_accvgpr_write_b32 a187, v19
  v_accvgpr_read_b32 v18, a188
  v_mul_f32 v18, v18, v17
  v_accvgpr_write_b32 a188, v18
  v_accvgpr_read_b32 v19, a189
  v_mul_f32 v19, v19, v17
  v_accvgpr_write_b32 a189, v19
  v_accvgpr_read_b32 v18, a190
  v_mul_f32 v18, v18, v17
  v_accvgpr_write_b32 a190, v18
  v_accvgpr_read_b32 v19, a191
  v_mul_f32 v19, v19, v17
  v_accvgpr_write_b32 a191, v19
  v_mov_b32 v20, v12
  v_mov_b32 v21, v12
  v_mov_b32 v22, v12
  v_mov_b32 v23, v12
  ds_write_b128 v3, v[20:23] offset:3072
  v_exp_f32 v16, v144
  v_exp_f32 v17, v145
  v_exp_f32 v18, v146
  v_exp_f32 v19, v147
  v_add_f32 v0, v16, v17
  v_cvt_pk_bf16_f32 v176, v16, v17
  v_exp_f32 v16, v148
  v_exp_f32 v17, v149
  v_add_f32 v0, v0, v18
  v_add_f32 v0, v0, v19
  v_cvt_pk_bf16_f32 v177, v18, v19
  v_exp_f32 v18, v150
  v_exp_f32 v19, v151
  v_add_f32 v0, v0, v16
  v_add_f32 v0, v0, v17
  v_cvt_pk_bf16_f32 v178, v16, v17
  v_exp_f32 v16, v152
  v_exp_f32 v17, v153
  v_add_f32 v0, v0, v18
  v_add_f32 v0, v0, v19
  v_cvt_pk_bf16_f32 v179, v18, v19
  v_exp_f32 v18, v154
  v_exp_f32 v19, v155
  v_add_f32 v0, v0, v16
  v_add_f32 v0, v0, v17
  v_cvt_pk_bf16_f32 v180, v16, v17
  v_exp_f32 v16, v156
  v_exp_f32 v17, v157
  v_add_f32 v0, v0, v18
  v_add_f32 v0, v0, v19
  v_cvt_pk_bf16_f32 v181, v18, v19
  v_exp_f32 v18, v158
  v_exp_f32 v19, v159
  v_add_f32 v0, v0, v16
  v_add_f32 v0, v0, v17
  v_cvt_pk_bf16_f32 v182, v16, v17
  v_add_f32 v0, v0, v18
  v_add_f32 v0, v0, v19
  v_cvt_pk_bf16_f32 v183, v18, v19
  s_waitcnt lgkmcnt(0)
  s_nop 1
  s_branch Lret_12
Lslow_13:
  s_nop 7
  v_max3_f32 v16, v160, v161, v162
  v_max3_f32 v16, v16, v163, v164
  v_max3_f32 v16, v16, v165, v166
  v_max3_f32 v16, v16, v167, v168
  v_max3_f32 v16, v16, v169, v170
  v_max3_f32 v16, v16, v171, v172
  v_max3_f32 v16, v16, v173, v174
  v_max_f32 v16, v16, v175
  v_mov_b32 v17, v16
  s_nop 1
  v_permlane32_swap_b32 v16, v17
  s_nop 1
  v_max_f32 v16, v16, v17
  v_ceil_f32 v16, v16
  v_max_f32 v16, s26, v16
  v_sub_f32 v13, v13, v16
  v_sub_f32 v160, v160, v16
  v_sub_f32 v161, v161, v16
  v_sub_f32 v162, v162, v16
  v_sub_f32 v163, v163, v16
  v_sub_f32 v164, v164, v16
  v_sub_f32 v165, v165, v16
  v_sub_f32 v166, v166, v16
  v_sub_f32 v167, v167, v16
  v_sub_f32 v168, v168, v16
  v_sub_f32 v169, v169, v16
  v_sub_f32 v170, v170, v16
  v_sub_f32 v171, v171, v16
  v_sub_f32 v172, v172, v16
  v_sub_f32 v173, v173, v16
  v_sub_f32 v174, v174, v16
  v_sub_f32 v175, v175, v16
  v_max_f32 v17, 0, v16
  v_exp_f32_e64 v17, -v17
  s_nop 1
  v_mul_f32 v8, v8, v17
  v_accvgpr_read_b32 v18, a192
  v_mul_f32 v18, v18, v17
  v_accvgpr_write_b32 a192, v18
  v_accvgpr_read_b32 v19, a193
  v_mul_f32 v19, v19, v17
  v_accvgpr_write_b32 a193, v19
  v_accvgpr_read_b32 v18, a194
  v_mul_f32 v18, v18, v17
  v_accvgpr_write_b32 a194, v18
  v_accvgpr_read_b32 v19, a195
  v_mul_f32 v19, v19, v17
  v_accvgpr_write_b32 a195, v19
  v_accvgpr_read_b32 v18, a196
  v_mul_f32 v18, v18, v17
  v_accvgpr_write_b32 a196, v18
  v_accvgpr_read_b32 v19, a197
  v_mul_f32 v19, v19, v17
  v_accvgpr_write_b32 a197, v19
  v_accvgpr_read_b32 v18, a198
  v_mul_f32 v18, v18, v17
  v_accvgpr_write_b32 a198, v18
  v_accvgpr_read_b32 v19, a199
  v_mul_f32 v19, v19, v17
  v_accvgpr_write_b32 a199, v19
  v_accvgpr_read_b32 v18, a200
  v_mul_f32 v18, v18, v17
  v_accvgpr_write_b32 a200, v18
  v_accvgpr_read_b32 v19, a201
  v_mul_f32 v19, v19, v17
  v_accvgpr_write_b32 a201, v19
  v_accvgpr_read_b32 v18, a202
  v_mul_f32 v18, v18, v17
  v_accvgpr_write_b32 a202, v18
  v_accvgpr_read_b32 v19, a203
  v_mul_f32 v19, v19, v17
  v_accvgpr_write_b32 a203, v19
  v_accvgpr_read_b32 v18, a204
  v_mul_f32 v18, v18, v17
  v_accvgpr_write_b32 a204, v18
  v_accvgpr_read_b32 v19, a205
  v_mul_f32 v19, v19, v17
  v_accvgpr_write_b32 a205, v19
  v_accvgpr_read_b32 v18, a206
  v_mul_f32 v18, v18, v17
  v_accvgpr_write_b32 a206, v18
  v_accvgpr_read_b32 v19, a207
  v_mul_f32 v19, v19, v17
  v_accvgpr_write_b32 a207, v19
  v_accvgpr_read_b32 v18, a208
  v_mul_f32 v18, v18, v17
  v_accvgpr_write_b32 a208, v18
  v_accvgpr_read_b32 v19, a209
  v_mul_f32 v19, v19, v17
  v_accvgpr_write_b32 a209, v19
  v_accvgpr_read_b32 v18, a210
  v_mul_f32 v18, v18, v17
  v_accvgpr_write_b32 a210, v18
  v_accvgpr_read_b32 v19, a211
  v_mul_f32 v19, v19, v17
  v_accvgpr_write_b32 a211, v19
  v_accvgpr_read_b32 v18, a212
  v_mul_f32 v18, v18, v17
  v_accvgpr_write_b32 a212, v18
  v_accvgpr_read_b32 v19, a213
  v_mul_f32 v19, v19, v17
  v_accvgpr_write_b32 a213, v19
  v_accvgpr_read_b32 v18, a214
  v_mul_f32 v18, v18, v17
  v_accvgpr_write_b32 a214, v18
  v_accvgpr_read_b32 v19, a215
  v_mul_f32 v19, v19, v17
  v_accvgpr_write_b32 a215, v19
  v_accvgpr_read_b32 v18, a216
  v_mul_f32 v18, v18, v17
  v_accvgpr_write_b32 a216, v18
  v_accvgpr_read_b32 v19, a217
  v_mul_f32 v19, v19, v17
  v_accvgpr_write_b32 a217, v19
  v_accvgpr_read_b32 v18, a218
  v_mul_f32 v18, v18, v17
  v_accvgpr_write_b32 a218, v18
  v_accvgpr_read_b32 v19, a219
  v_mul_f32 v19, v19, v17
  v_accvgpr_write_b32 a219, v19
  v_accvgpr_read_b32 v18, a220
  v_mul_f32 v18, v18, v17
  v_accvgpr_write_b32 a220, v18
  v_accvgpr_read_b32 v19, a221
  v_mul_f32 v19, v19, v17
  v_accvgpr_write_b32 a221, v19
  v_accvgpr_read_b32 v18, a222
  v_mul_f32 v18, v18, v17
  v_accvgpr_write_b32 a222, v18
  v_accvgpr_read_b32 v19, a223
  v_mul_f32 v19, v19, v17
  v_accvgpr_write_b32 a223, v19
  v_accvgpr_read_b32 v18, a224
  v_mul_f32 v18, v18, v17
  v_accvgpr_write_b32 a224, v18
  v_accvgpr_read_b32 v19, a225
  v_mul_f32 v19, v19, v17
  v_accvgpr_write_b32 a225, v19
  v_accvgpr_read_b32 v18, a226
  v_mul_f32 v18, v18, v17
  v_accvgpr_write_b32 a226, v18
  v_accvgpr_read_b32 v19, a227
  v_mul_f32 v19, v19, v17
  v_accvgpr_write_b32 a227, v19
  v_accvgpr_read_b32 v18, a228
  v_mul_f32 v18, v18, v17
  v_accvgpr_write_b32 a228, v18
  v_accvgpr_read_b32 v19, a229
  v_mul_f32 v19, v19, v17
  v_accvgpr_write_b32 a229, v19
  v_accvgpr_read_b32 v18, a230
  v_mul_f32 v18, v18, v17
  v_accvgpr_write_b32 a230, v18
  v_accvgpr_read_b32 v19, a231
  v_mul_f32 v19, v19, v17
  v_accvgpr_write_b32 a231, v19
  v_accvgpr_read_b32 v18, a232
  v_mul_f32 v18, v18, v17
  v_accvgpr_write_b32 a232, v18
  v_accvgpr_read_b32 v19, a233
  v_mul_f32 v19, v19, v17
  v_accvgpr_write_b32 a233, v19
  v_accvgpr_read_b32 v18, a234
  v_mul_f32 v18, v18, v17
  v_accvgpr_write_b32 a234, v18
  v_accvgpr_read_b32 v19, a235
  v_mul_f32 v19, v19, v17
  v_accvgpr_write_b32 a235, v19
  v_accvgpr_read_b32 v18, a236
  v_mul_f32 v18, v18, v17
  v_accvgpr_write_b32 a236, v18
  v_accvgpr_read_b32 v19, a237
  v_mul_f32 v19, v19, v17
  v_accvgpr_write_b32 a237, v19
  v_accvgpr_read_b32 v18, a238
  v_mul_f32 v18, v18, v17
  v_accvgpr_write_b32 a238, v18
  v_accvgpr_read_b32 v19, a239
  v_mul_f32 v19, v19, v17
  v_accvgpr_write_b32 a239, v19
  v_mov_b32 v20, v13
  v_mov_b32 v21, v13
  v_mov_b32 v22, v13
  v_mov_b32 v23, v13
  ds_write_b128 v3, v[20:23] offset:4096
  v_exp_f32 v16, v160
  v_exp_f32 v17, v161
  v_exp_f32 v18, v162
  v_exp_f32 v19, v163
  v_add_f32 v0, v16, v17
  v_cvt_pk_bf16_f32 v184, v16, v17
  v_exp_f32 v16, v164
  v_exp_f32 v17, v165
  v_add_f32 v0, v0, v18
  v_add_f32 v0, v0, v19
  v_cvt_pk_bf16_f32 v185, v18, v19
  v_exp_f32 v18, v166
  v_exp_f32 v19, v167
  v_add_f32 v0, v0, v16
  v_add_f32 v0, v0, v17
  v_cvt_pk_bf16_f32 v186, v16, v17
  v_exp_f32 v16, v168
  v_exp_f32 v17, v169
  v_add_f32 v0, v0, v18
  v_add_f32 v0, v0, v19
  v_cvt_pk_bf16_f32 v187, v18, v19
  v_exp_f32 v18, v170
  v_exp_f32 v19, v171
  v_add_f32 v0, v0, v16
  v_add_f32 v0, v0, v17
  v_cvt_pk_bf16_f32 v188, v16, v17
  v_exp_f32 v16, v172
  v_exp_f32 v17, v173
  v_add_f32 v0, v0, v18
  v_add_f32 v0, v0, v19
  v_cvt_pk_bf16_f32 v189, v18, v19
  v_exp_f32 v18, v174
  v_exp_f32 v19, v175
  v_add_f32 v0, v0, v16
  v_add_f32 v0, v0, v17
  v_cvt_pk_bf16_f32 v190, v16, v17
  v_add_f32 v0, v0, v18
  v_add_f32 v0, v0, v19
  v_cvt_pk_bf16_f32 v191, v18, v19
  s_waitcnt lgkmcnt(0)
  s_nop 1
  s_branch Lret_13
Lslow_14:
  s_nop 7
  v_max3_f32 v16, v144, v145, v146
  v_max3_f32 v16, v16, v147, v148
  v_max3_f32 v16, v16, v149, v150
  v_max3_f32 v16, v16, v151, v152
  v_max3_f32 v16, v16, v153, v154
  v_max3_f32 v16, v16, v155, v156
  v_max3_f32 v16, v16, v157, v158
  v_max_f32 v16, v16, v159
  v_mov_b32 v17, v16
  s_nop 1
  v_permlane32_swap_b32 v16, v17
  s_nop 1
  v_max_f32 v16, v16, v17
  v_ceil_f32 v16, v16
  v_max_f32 v16, 0, v16
  v_sub_f32 v9, v9, v16
  v_sub_f32 v144, v144, v16
  v_sub_f32 v145, v145, v16
  v_sub_f32 v146, v146, v16
  v_sub_f32 v147, v147, v16
  v_sub_f32 v148, v148, v16
  v_sub_f32 v149, v149, v16
  v_sub_f32 v150, v150, v16
  v_sub_f32 v151, v151, v16
  v_sub_f32 v152, v152, v16
  v_sub_f32 v153, v153, v16
  v_sub_f32 v154, v154, v16
  v_sub_f32 v155, v155, v16
  v_sub_f32 v156, v156, v16
  v_sub_f32 v157, v157, v16
  v_sub_f32 v158, v158, v16
  v_sub_f32 v159, v159, v16
  v_max_f32 v17, 0, v16
  v_exp_f32_e64 v17, -v17
  s_nop 1
  v_mul_f32 v4, v4, v17
  v_accvgpr_read_b32 v18, a0
  v_mul_f32 v18, v18, v17
  v_accvgpr_write_b32 a0, v18
  v_accvgpr_read_b32 v19, a1
  v_mul_f32 v19, v19, v17
  v_accvgpr_write_b32 a1, v19
  v_accvgpr_read_b32 v18, a2
  v_mul_f32 v18, v18, v17
  v_accvgpr_write_b32 a2, v18
  v_accvgpr_read_b32 v19, a3
  v_mul_f32 v19, v19, v17
  v_accvgpr_write_b32 a3, v19
  v_accvgpr_read_b32 v18, a4
  v_mul_f32 v18, v18, v17
  v_accvgpr_write_b32 a4, v18
  v_accvgpr_read_b32 v19, a5
  v_mul_f32 v19, v19, v17
  v_accvgpr_write_b32 a5, v19
  v_accvgpr_read_b32 v18, a6
  v_mul_f32 v18, v18, v17
  v_accvgpr_write_b32 a6, v18
  v_accvgpr_read_b32 v19, a7
  v_mul_f32 v19, v19, v17
  v_accvgpr_write_b32 a7, v19
  v_accvgpr_read_b32 v18, a8
  v_mul_f32 v18, v18, v17
  v_accvgpr_write_b32 a8, v18
  v_accvgpr_read_b32 v19, a9
  v_mul_f32 v19, v19, v17
  v_accvgpr_write_b32 a9, v19
  v_accvgpr_read_b32 v18, a10
  v_mul_f32 v18, v18, v17
  v_accvgpr_write_b32 a10, v18
  v_accvgpr_read_b32 v19, a11
  v_mul_f32 v19, v19, v17
  v_accvgpr_write_b32 a11, v19
  v_accvgpr_read_b32 v18, a12
  v_mul_f32 v18, v18, v17
  v_accvgpr_write_b32 a12, v18
  v_accvgpr_read_b32 v19, a13
  v_mul_f32 v19, v19, v17
  v_accvgpr_write_b32 a13, v19
  v_accvgpr_read_b32 v18, a14
  v_mul_f32 v18, v18, v17
  v_accvgpr_write_b32 a14, v18
  v_accvgpr_read_b32 v19, a15
  v_mul_f32 v19, v19, v17
  v_accvgpr_write_b32 a15, v19
  v_accvgpr_read_b32 v18, a16
  v_mul_f32 v18, v18, v17
  v_accvgpr_write_b32 a16, v18
  v_accvgpr_read_b32 v19, a17
  v_mul_f32 v19, v19, v17
  v_accvgpr_write_b32 a17, v19
  v_accvgpr_read_b32 v18, a18
  v_mul_f32 v18, v18, v17
  v_accvgpr_write_b32 a18, v18
  v_accvgpr_read_b32 v19, a19
  v_mul_f32 v19, v19, v17
  v_accvgpr_write_b32 a19, v19
  v_accvgpr_read_b32 v18, a20
  v_mul_f32 v18, v18, v17
  v_accvgpr_write_b32 a20, v18
  v_accvgpr_read_b32 v19, a21
  v_mul_f32 v19, v19, v17
  v_accvgpr_write_b32 a21, v19
  v_accvgpr_read_b32 v18, a22
  v_mul_f32 v18, v18, v17
  v_accvgpr_write_b32 a22, v18
  v_accvgpr_read_b32 v19, a23
  v_mul_f32 v19, v19, v17
  v_accvgpr_write_b32 a23, v19
  v_accvgpr_read_b32 v18, a24
  v_mul_f32 v18, v18, v17
  v_accvgpr_write_b32 a24, v18
  v_accvgpr_read_b32 v19, a25
  v_mul_f32 v19, v19, v17
  v_accvgpr_write_b32 a25, v19
  v_accvgpr_read_b32 v18, a26
  v_mul_f32 v18, v18, v17
  v_accvgpr_write_b32 a26, v18
  v_accvgpr_read_b32 v19, a27
  v_mul_f32 v19, v19, v17
  v_accvgpr_write_b32 a27, v19
  v_accvgpr_read_b32 v18, a28
  v_mul_f32 v18, v18, v17
  v_accvgpr_write_b32 a28, v18
  v_accvgpr_read_b32 v19, a29
  v_mul_f32 v19, v19, v17
  v_accvgpr_write_b32 a29, v19
  v_accvgpr_read_b32 v18, a30
  v_mul_f32 v18, v18, v17
  v_accvgpr_write_b32 a30, v18
  v_accvgpr_read_b32 v19, a31
  v_mul_f32 v19, v19, v17
  v_accvgpr_write_b32 a31, v19
  v_accvgpr_read_b32 v18, a32
  v_mul_f32 v18, v18, v17
  v_accvgpr_write_b32 a32, v18
  v_accvgpr_read_b32 v19, a33
  v_mul_f32 v19, v19, v17
  v_accvgpr_write_b32 a33, v19
  v_accvgpr_read_b32 v18, a34
  v_mul_f32 v18, v18, v17
  v_accvgpr_write_b32 a34, v18
  v_accvgpr_read_b32 v19, a35
  v_mul_f32 v19, v19, v17
  v_accvgpr_write_b32 a35, v19
  v_accvgpr_read_b32 v18, a36
  v_mul_f32 v18, v18, v17
  v_accvgpr_write_b32 a36, v18
  v_accvgpr_read_b32 v19, a37
  v_mul_f32 v19, v19, v17
  v_accvgpr_write_b32 a37, v19
  v_accvgpr_read_b32 v18, a38
  v_mul_f32 v18, v18, v17
  v_accvgpr_write_b32 a38, v18
  v_accvgpr_read_b32 v19, a39
  v_mul_f32 v19, v19, v17
  v_accvgpr_write_b32 a39, v19
  v_accvgpr_read_b32 v18, a40
  v_mul_f32 v18, v18, v17
  v_accvgpr_write_b32 a40, v18
  v_accvgpr_read_b32 v19, a41
  v_mul_f32 v19, v19, v17
  v_accvgpr_write_b32 a41, v19
  v_accvgpr_read_b32 v18, a42
  v_mul_f32 v18, v18, v17
  v_accvgpr_write_b32 a42, v18
  v_accvgpr_read_b32 v19, a43
  v_mul_f32 v19, v19, v17
  v_accvgpr_write_b32 a43, v19
  v_accvgpr_read_b32 v18, a44
  v_mul_f32 v18, v18, v17
  v_accvgpr_write_b32 a44, v18
  v_accvgpr_read_b32 v19, a45
  v_mul_f32 v19, v19, v17
  v_accvgpr_write_b32 a45, v19
  v_accvgpr_read_b32 v18, a46
  v_mul_f32 v18, v18, v17
  v_accvgpr_write_b32 a46, v18
  v_accvgpr_read_b32 v19, a47
  v_mul_f32 v19, v19, v17
  v_accvgpr_write_b32 a47, v19
  v_mov_b32 v20, v9
  v_mov_b32 v21, v9
  v_mov_b32 v22, v9
  v_mov_b32 v23, v9
  ds_write_b128 v3, v[20:23] offset:0
  v_exp_f32 v16, v144
  v_exp_f32 v17, v145
  v_exp_f32 v18, v146
  v_exp_f32 v19, v147
  v_add_f32 v0, v16, v17
  v_cvt_pk_bf16_f32 v176, v16, v17
  v_exp_f32 v16, v148
  v_exp_f32 v17, v149
  v_add_f32 v0, v0, v18
  v_add_f32 v0, v0, v19
  v_cvt_pk_bf16_f32 v177, v18, v19
  v_exp_f32 v18, v150
  v_exp_f32 v19, v151
  v_add_f32 v0, v0, v16
  v_add_f32 v0, v0, v17
  v_cvt_pk_bf16_f32 v178, v16, v17
  v_exp_f32 v16, v152
  v_exp_f32 v17, v153
  v_add_f32 v0, v0, v18
  v_add_f32 v0, v0, v19
  v_cvt_pk_bf16_f32 v179, v18, v19
  v_exp_f32 v18, v154
  v_exp_f32 v19, v155
  v_add_f32 v0, v0, v16
  v_add_f32 v0, v0, v17
  v_cvt_pk_bf16_f32 v180, v16, v17
  v_exp_f32 v16, v156
  v_exp_f32 v17, v157
  v_add_f32 v0, v0, v18
  v_add_f32 v0, v0, v19
  v_cvt_pk_bf16_f32 v181, v18, v19
  v_exp_f32 v18, v158
  v_exp_f32 v19, v159
  v_add_f32 v0, v0, v16
  v_add_f32 v0, v0, v17
  v_cvt_pk_bf16_f32 v182, v16, v17
  v_add_f32 v0, v0, v18
  v_add_f32 v0, v0, v19
  v_cvt_pk_bf16_f32 v183, v18, v19
  s_waitcnt lgkmcnt(0)
  s_nop 1
  s_branch Lret_14
Lslow_15:
  s_nop 7
  v_max3_f32 v16, v160, v161, v162
  v_max3_f32 v16, v16, v163, v164
  v_max3_f32 v16, v16, v165, v166
  v_max3_f32 v16, v16, v167, v168
  v_max3_f32 v16, v16, v169, v170
  v_max3_f32 v16, v16, v171, v172
  v_max3_f32 v16, v16, v173, v174
  v_max_f32 v16, v16, v175
  v_mov_b32 v17, v16
  s_nop 1
  v_permlane32_swap_b32 v16, v17
  s_nop 1
  v_max_f32 v16, v16, v17
  v_ceil_f32 v16, v16
  v_max_f32 v16, 0, v16
  v_sub_f32 v10, v10, v16
  v_sub_f32 v160, v160, v16
  v_sub_f32 v161, v161, v16
  v_sub_f32 v162, v162, v16
  v_sub_f32 v163, v163, v16
  v_sub_f32 v164, v164, v16
  v_sub_f32 v165, v165, v16
  v_sub_f32 v166, v166, v16
  v_sub_f32 v167, v167, v16
  v_sub_f32 v168, v168, v16
  v_sub_f32 v169, v169, v16
  v_sub_f32 v170, v170, v16
  v_sub_f32 v171, v171, v16
  v_sub_f32 v172, v172, v16
  v_sub_f32 v173, v173, v16
  v_sub_f32 v174, v174, v16
  v_sub_f32 v175, v175, v16
  v_max_f32 v17, 0, v16
  v_exp_f32_e64 v17, -v17
  s_nop 1
  v_mul_f32 v5, v5, v17
  v_accvgpr_read_b32 v18, a48
  v_mul_f32 v18, v18, v17
  v_accvgpr_write_b32 a48, v18
  v_accvgpr_read_b32 v19, a49
  v_mul_f32 v19, v19, v17
  v_accvgpr_write_b32 a49, v19
  v_accvgpr_read_b32 v18, a50
  v_mul_f32 v18, v18, v17
  v_accvgpr_write_b32 a50, v18
  v_accvgpr_read_b32 v19, a51
  v_mul_f32 v19, v19, v17
  v_accvgpr_write_b32 a51, v19
  v_accvgpr_read_b32 v18, a52
  v_mul_f32 v18, v18, v17
  v_accvgpr_write_b32 a52, v18
  v_accvgpr_read_b32 v19, a53
  v_mul_f32 v19, v19, v17
  v_accvgpr_write_b32 a53, v19
  v_accvgpr_read_b32 v18, a54
  v_mul_f32 v18, v18, v17
  v_accvgpr_write_b32 a54, v18
  v_accvgpr_read_b32 v19, a55
  v_mul_f32 v19, v19, v17
  v_accvgpr_write_b32 a55, v19
  v_accvgpr_read_b32 v18, a56
  v_mul_f32 v18, v18, v17
  v_accvgpr_write_b32 a56, v18
  v_accvgpr_read_b32 v19, a57
  v_mul_f32 v19, v19, v17
  v_accvgpr_write_b32 a57, v19
  v_accvgpr_read_b32 v18, a58
  v_mul_f32 v18, v18, v17
  v_accvgpr_write_b32 a58, v18
  v_accvgpr_read_b32 v19, a59
  v_mul_f32 v19, v19, v17
  v_accvgpr_write_b32 a59, v19
  v_accvgpr_read_b32 v18, a60
  v_mul_f32 v18, v18, v17
  v_accvgpr_write_b32 a60, v18
  v_accvgpr_read_b32 v19, a61
  v_mul_f32 v19, v19, v17
  v_accvgpr_write_b32 a61, v19
  v_accvgpr_read_b32 v18, a62
  v_mul_f32 v18, v18, v17
  v_accvgpr_write_b32 a62, v18
  v_accvgpr_read_b32 v19, a63
  v_mul_f32 v19, v19, v17
  v_accvgpr_write_b32 a63, v19
  v_accvgpr_read_b32 v18, a64
  v_mul_f32 v18, v18, v17
  v_accvgpr_write_b32 a64, v18
  v_accvgpr_read_b32 v19, a65
  v_mul_f32 v19, v19, v17
  v_accvgpr_write_b32 a65, v19
  v_accvgpr_read_b32 v18, a66
  v_mul_f32 v18, v18, v17
  v_accvgpr_write_b32 a66, v18
  v_accvgpr_read_b32 v19, a67
  v_mul_f32 v19, v19, v17
  v_accvgpr_write_b32 a67, v19
  v_accvgpr_read_b32 v18, a68
  v_mul_f32 v18, v18, v17
  v_accvgpr_write_b32 a68, v18
  v_accvgpr_read_b32 v19, a69
  v_mul_f32 v19, v19, v17
  v_accvgpr_write_b32 a69, v19
  v_accvgpr_read_b32 v18, a70
  v_mul_f32 v18, v18, v17
  v_accvgpr_write_b32 a70, v18
  v_accvgpr_read_b32 v19, a71
  v_mul_f32 v19, v19, v17
  v_accvgpr_write_b32 a71, v19
  v_accvgpr_read_b32 v18, a72
  v_mul_f32 v18, v18, v17
  v_accvgpr_write_b32 a72, v18
  v_accvgpr_read_b32 v19, a73
  v_mul_f32 v19, v19, v17
  v_accvgpr_write_b32 a73, v19
  v_accvgpr_read_b32 v18, a74
  v_mul_f32 v18, v18, v17
  v_accvgpr_write_b32 a74, v18
  v_accvgpr_read_b32 v19, a75
  v_mul_f32 v19, v19, v17
  v_accvgpr_write_b32 a75, v19
  v_accvgpr_read_b32 v18, a76
  v_mul_f32 v18, v18, v17
  v_accvgpr_write_b32 a76, v18
  v_accvgpr_read_b32 v19, a77
  v_mul_f32 v19, v19, v17
  v_accvgpr_write_b32 a77, v19
  v_accvgpr_read_b32 v18, a78
  v_mul_f32 v18, v18, v17
  v_accvgpr_write_b32 a78, v18
  v_accvgpr_read_b32 v19, a79
  v_mul_f32 v19, v19, v17
  v_accvgpr_write_b32 a79, v19
  v_accvgpr_read_b32 v18, a80
  v_mul_f32 v18, v18, v17
  v_accvgpr_write_b32 a80, v18
  v_accvgpr_read_b32 v19, a81
  v_mul_f32 v19, v19, v17
  v_accvgpr_write_b32 a81, v19
  v_accvgpr_read_b32 v18, a82
  v_mul_f32 v18, v18, v17
  v_accvgpr_write_b32 a82, v18
  v_accvgpr_read_b32 v19, a83
  v_mul_f32 v19, v19, v17
  v_accvgpr_write_b32 a83, v19
  v_accvgpr_read_b32 v18, a84
  v_mul_f32 v18, v18, v17
  v_accvgpr_write_b32 a84, v18
  v_accvgpr_read_b32 v19, a85
  v_mul_f32 v19, v19, v17
  v_accvgpr_write_b32 a85, v19
  v_accvgpr_read_b32 v18, a86
  v_mul_f32 v18, v18, v17
  v_accvgpr_write_b32 a86, v18
  v_accvgpr_read_b32 v19, a87
  v_mul_f32 v19, v19, v17
  v_accvgpr_write_b32 a87, v19
  v_accvgpr_read_b32 v18, a88
  v_mul_f32 v18, v18, v17
  v_accvgpr_write_b32 a88, v18
  v_accvgpr_read_b32 v19, a89
  v_mul_f32 v19, v19, v17
  v_accvgpr_write_b32 a89, v19
  v_accvgpr_read_b32 v18, a90
  v_mul_f32 v18, v18, v17
  v_accvgpr_write_b32 a90, v18
  v_accvgpr_read_b32 v19, a91
  v_mul_f32 v19, v19, v17
  v_accvgpr_write_b32 a91, v19
  v_accvgpr_read_b32 v18, a92
  v_mul_f32 v18, v18, v17
  v_accvgpr_write_b32 a92, v18
  v_accvgpr_read_b32 v19, a93
  v_mul_f32 v19, v19, v17
  v_accvgpr_write_b32 a93, v19
  v_accvgpr_read_b32 v18, a94
  v_mul_f32 v18, v18, v17
  v_accvgpr_write_b32 a94, v18
  v_accvgpr_read_b32 v19, a95
  v_mul_f32 v19, v19, v17
  v_accvgpr_write_b32 a95, v19
  v_mov_b32 v20, v10
  v_mov_b32 v21, v10
  v_mov_b32 v22, v10
  v_mov_b32 v23, v10
  ds_write_b128 v3, v[20:23] offset:1024
  v_exp_f32 v16, v160
  v_exp_f32 v17, v161
  v_exp_f32 v18, v162
  v_exp_f32 v19, v163
  v_add_f32 v0, v16, v17
  v_cvt_pk_bf16_f32 v184, v16, v17
  v_exp_f32 v16, v164
  v_exp_f32 v17, v165
  v_add_f32 v0, v0, v18
  v_add_f32 v0, v0, v19
  v_cvt_pk_bf16_f32 v185, v18, v19
  v_exp_f32 v18, v166
  v_exp_f32 v19, v167
  v_add_f32 v0, v0, v16
  v_add_f32 v0, v0, v17
  v_cvt_pk_bf16_f32 v186, v16, v17
  v_exp_f32 v16, v168
  v_exp_f32 v17, v169
  v_add_f32 v0, v0, v18
  v_add_f32 v0, v0, v19
  v_cvt_pk_bf16_f32 v187, v18, v19
  v_exp_f32 v18, v170
  v_exp_f32 v19, v171
  v_add_f32 v0, v0, v16
  v_add_f32 v0, v0, v17
  v_cvt_pk_bf16_f32 v188, v16, v17
  v_exp_f32 v16, v172
  v_exp_f32 v17, v173
  v_add_f32 v0, v0, v18
  v_add_f32 v0, v0, v19
  v_cvt_pk_bf16_f32 v189, v18, v19
  v_exp_f32 v18, v174
  v_exp_f32 v19, v175
  v_add_f32 v0, v0, v16
  v_add_f32 v0, v0, v17
  v_cvt_pk_bf16_f32 v190, v16, v17
  v_add_f32 v0, v0, v18
  v_add_f32 v0, v0, v19
  v_cvt_pk_bf16_f32 v191, v18, v19
  s_waitcnt lgkmcnt(0)
  s_nop 1
  s_branch Lret_15
Lslow_16:
  s_nop 7
  v_max3_f32 v16, v144, v145, v146
  v_max3_f32 v16, v16, v147, v148
  v_max3_f32 v16, v16, v149, v150
  v_max3_f32 v16, v16, v151, v152
  v_max3_f32 v16, v16, v153, v154
  v_max3_f32 v16, v16, v155, v156
  v_max3_f32 v16, v16, v157, v158
  v_max_f32 v16, v16, v159
  v_mov_b32 v17, v16
  s_nop 1
  v_permlane32_swap_b32 v16, v17
  s_nop 1
  v_max_f32 v16, v16, v17
  v_ceil_f32 v16, v16
  v_max_f32 v16, 0, v16
  v_sub_f32 v11, v11, v16
  v_sub_f32 v144, v144, v16
  v_sub_f32 v145, v145, v16
  v_sub_f32 v146, v146, v16
  v_sub_f32 v147, v147, v16
  v_sub_f32 v148, v148, v16
  v_sub_f32 v149, v149, v16
  v_sub_f32 v150, v150, v16
  v_sub_f32 v151, v151, v16
  v_sub_f32 v152, v152, v16
  v_sub_f32 v153, v153, v16
  v_sub_f32 v154, v154, v16
  v_sub_f32 v155, v155, v16
  v_sub_f32 v156, v156, v16
  v_sub_f32 v157, v157, v16
  v_sub_f32 v158, v158, v16
  v_sub_f32 v159, v159, v16
  v_max_f32 v17, 0, v16
  v_exp_f32_e64 v17, -v17
  s_nop 1
  v_mul_f32 v6, v6, v17
  v_accvgpr_read_b32 v18, a96
  v_mul_f32 v18, v18, v17
  v_accvgpr_write_b32 a96, v18
  v_accvgpr_read_b32 v19, a97
  v_mul_f32 v19, v19, v17
  v_accvgpr_write_b32 a97, v19
  v_accvgpr_read_b32 v18, a98
  v_mul_f32 v18, v18, v17
  v_accvgpr_write_b32 a98, v18
  v_accvgpr_read_b32 v19, a99
  v_mul_f32 v19, v19, v17
  v_accvgpr_write_b32 a99, v19
  v_accvgpr_read_b32 v18, a100
  v_mul_f32 v18, v18, v17
  v_accvgpr_write_b32 a100, v18
  v_accvgpr_read_b32 v19, a101
  v_mul_f32 v19, v19, v17
  v_accvgpr_write_b32 a101, v19
  v_accvgpr_read_b32 v18, a102
  v_mul_f32 v18, v18, v17
  v_accvgpr_write_b32 a102, v18
  v_accvgpr_read_b32 v19, a103
  v_mul_f32 v19, v19, v17
  v_accvgpr_write_b32 a103, v19
  v_accvgpr_read_b32 v18, a104
  v_mul_f32 v18, v18, v17
  v_accvgpr_write_b32 a104, v18
  v_accvgpr_read_b32 v19, a105
  v_mul_f32 v19, v19, v17
  v_accvgpr_write_b32 a105, v19
  v_accvgpr_read_b32 v18, a106
  v_mul_f32 v18, v18, v17
  v_accvgpr_write_b32 a106, v18
  v_accvgpr_read_b32 v19, a107
  v_mul_f32 v19, v19, v17
  v_accvgpr_write_b32 a107, v19
  v_accvgpr_read_b32 v18, a108
  v_mul_f32 v18, v18, v17
  v_accvgpr_write_b32 a108, v18
  v_accvgpr_read_b32 v19, a109
  v_mul_f32 v19, v19, v17
  v_accvgpr_write_b32 a109, v19
  v_accvgpr_read_b32 v18, a110
  v_mul_f32 v18, v18, v17
  v_accvgpr_write_b32 a110, v18
  v_accvgpr_read_b32 v19, a111
  v_mul_f32 v19, v19, v17
  v_accvgpr_write_b32 a111, v19
  v_accvgpr_read_b32 v18, a112
  v_mul_f32 v18, v18, v17
  v_accvgpr_write_b32 a112, v18
  v_accvgpr_read_b32 v19, a113
  v_mul_f32 v19, v19, v17
  v_accvgpr_write_b32 a113, v19
  v_accvgpr_read_b32 v18, a114
  v_mul_f32 v18, v18, v17
  v_accvgpr_write_b32 a114, v18
  v_accvgpr_read_b32 v19, a115
  v_mul_f32 v19, v19, v17
  v_accvgpr_write_b32 a115, v19
  v_accvgpr_read_b32 v18, a116
  v_mul_f32 v18, v18, v17
  v_accvgpr_write_b32 a116, v18
  v_accvgpr_read_b32 v19, a117
  v_mul_f32 v19, v19, v17
  v_accvgpr_write_b32 a117, v19
  v_accvgpr_read_b32 v18, a118
  v_mul_f32 v18, v18, v17
  v_accvgpr_write_b32 a118, v18
  v_accvgpr_read_b32 v19, a119
  v_mul_f32 v19, v19, v17
  v_accvgpr_write_b32 a119, v19
  v_accvgpr_read_b32 v18, a120
  v_mul_f32 v18, v18, v17
  v_accvgpr_write_b32 a120, v18
  v_accvgpr_read_b32 v19, a121
  v_mul_f32 v19, v19, v17
  v_accvgpr_write_b32 a121, v19
  v_accvgpr_read_b32 v18, a122
  v_mul_f32 v18, v18, v17
  v_accvgpr_write_b32 a122, v18
  v_accvgpr_read_b32 v19, a123
  v_mul_f32 v19, v19, v17
  v_accvgpr_write_b32 a123, v19
  v_accvgpr_read_b32 v18, a124
  v_mul_f32 v18, v18, v17
  v_accvgpr_write_b32 a124, v18
  v_accvgpr_read_b32 v19, a125
  v_mul_f32 v19, v19, v17
  v_accvgpr_write_b32 a125, v19
  v_accvgpr_read_b32 v18, a126
  v_mul_f32 v18, v18, v17
  v_accvgpr_write_b32 a126, v18
  v_accvgpr_read_b32 v19, a127
  v_mul_f32 v19, v19, v17
  v_accvgpr_write_b32 a127, v19
  v_accvgpr_read_b32 v18, a128
  v_mul_f32 v18, v18, v17
  v_accvgpr_write_b32 a128, v18
  v_accvgpr_read_b32 v19, a129
  v_mul_f32 v19, v19, v17
  v_accvgpr_write_b32 a129, v19
  v_accvgpr_read_b32 v18, a130
  v_mul_f32 v18, v18, v17
  v_accvgpr_write_b32 a130, v18
  v_accvgpr_read_b32 v19, a131
  v_mul_f32 v19, v19, v17
  v_accvgpr_write_b32 a131, v19
  v_accvgpr_read_b32 v18, a132
  v_mul_f32 v18, v18, v17
  v_accvgpr_write_b32 a132, v18
  v_accvgpr_read_b32 v19, a133
  v_mul_f32 v19, v19, v17
  v_accvgpr_write_b32 a133, v19
  v_accvgpr_read_b32 v18, a134
  v_mul_f32 v18, v18, v17
  v_accvgpr_write_b32 a134, v18
  v_accvgpr_read_b32 v19, a135
  v_mul_f32 v19, v19, v17
  v_accvgpr_write_b32 a135, v19
  v_accvgpr_read_b32 v18, a136
  v_mul_f32 v18, v18, v17
  v_accvgpr_write_b32 a136, v18
  v_accvgpr_read_b32 v19, a137
  v_mul_f32 v19, v19, v17
  v_accvgpr_write_b32 a137, v19
  v_accvgpr_read_b32 v18, a138
  v_mul_f32 v18, v18, v17
  v_accvgpr_write_b32 a138, v18
  v_accvgpr_read_b32 v19, a139
  v_mul_f32 v19, v19, v17
  v_accvgpr_write_b32 a139, v19
  v_accvgpr_read_b32 v18, a140
  v_mul_f32 v18, v18, v17
  v_accvgpr_write_b32 a140, v18
  v_accvgpr_read_b32 v19, a141
  v_mul_f32 v19, v19, v17
  v_accvgpr_write_b32 a141, v19
  v_accvgpr_read_b32 v18, a142
  v_mul_f32 v18, v18, v17
  v_accvgpr_write_b32 a142, v18
  v_accvgpr_read_b32 v19, a143
  v_mul_f32 v19, v19, v17
  v_accvgpr_write_b32 a143, v19
  v_mov_b32 v20, v11
  v_mov_b32 v21, v11
  v_mov_b32 v22, v11
  v_mov_b32 v23, v11
  ds_write_b128 v3, v[20:23] offset:2048
  v_exp_f32 v16, v144
  v_exp_f32 v17, v145
  v_exp_f32 v18, v146
  v_exp_f32 v19, v147
  v_add_f32 v0, v16, v17
  v_cvt_pk_bf16_f32 v176, v16, v17
  v_exp_f32 v16, v148
  v_exp_f32 v17, v149
  v_add_f32 v0, v0, v18
  v_add_f32 v0, v0, v19
  v_cvt_pk_bf16_f32 v177, v18, v19
  v_exp_f32 v18, v150
  v_exp_f32 v19, v151
  v_add_f32 v0, v0, v16
  v_add_f32 v0, v0, v17
  v_cvt_pk_bf16_f32 v178, v16, v17
  v_exp_f32 v16, v152
  v_exp_f32 v17, v153
  v_add_f32 v0, v0, v18
  v_add_f32 v0, v0, v19
  v_cvt_pk_bf16_f32 v179, v18, v19
  v_exp_f32 v18, v154
  v_exp_f32 v19, v155
  v_add_f32 v0, v0, v16
  v_add_f32 v0, v0, v17
  v_cvt_pk_bf16_f32 v180, v16, v17
  v_exp_f32 v16, v156
  v_exp_f32 v17, v157
  v_add_f32 v0, v0, v18
  v_add_f32 v0, v0, v19
  v_cvt_pk_bf16_f32 v181, v18, v19
  v_exp_f32 v18, v158
  v_exp_f32 v19, v159
  v_add_f32 v0, v0, v16
  v_add_f32 v0, v0, v17
  v_cvt_pk_bf16_f32 v182, v16, v17
  v_add_f32 v0, v0, v18
  v_add_f32 v0, v0, v19
  v_cvt_pk_bf16_f32 v183, v18, v19
  s_waitcnt lgkmcnt(0)
  s_nop 1
  s_branch Lret_16
Lslow_17:
  s_nop 7
  v_max3_f32 v16, v160, v161, v162
  v_max3_f32 v16, v16, v163, v164
  v_max3_f32 v16, v16, v165, v166
  v_max3_f32 v16, v16, v167, v168
  v_max3_f32 v16, v16, v169, v170
  v_max3_f32 v16, v16, v171, v172
  v_max3_f32 v16, v16, v173, v174
  v_max_f32 v16, v16, v175
  v_mov_b32 v17, v16
  s_nop 1
  v_permlane32_swap_b32 v16, v17
  s_nop 1
  v_max_f32 v16, v16, v17
  v_ceil_f32 v16, v16
  v_max_f32 v16, 0, v16
  v_sub_f32 v12, v12, v16
  v_sub_f32 v160, v160, v16
  v_sub_f32 v161, v161, v16
  v_sub_f32 v162, v162, v16
  v_sub_f32 v163, v163, v16
  v_sub_f32 v164, v164, v16
  v_sub_f32 v165, v165, v16
  v_sub_f32 v166, v166, v16
  v_sub_f32 v167, v167, v16
  v_sub_f32 v168, v168, v16
  v_sub_f32 v169, v169, v16
  v_sub_f32 v170, v170, v16
  v_sub_f32 v171, v171, v16
  v_sub_f32 v172, v172, v16
  v_sub_f32 v173, v173, v16
  v_sub_f32 v174, v174, v16
  v_sub_f32 v175, v175, v16
  v_max_f32 v17, 0, v16
  v_exp_f32_e64 v17, -v17
  s_nop 1
  v_mul_f32 v7, v7, v17
  v_accvgpr_read_b32 v18, a144
  v_mul_f32 v18, v18, v17
  v_accvgpr_write_b32 a144, v18
  v_accvgpr_read_b32 v19, a145
  v_mul_f32 v19, v19, v17
  v_accvgpr_write_b32 a145, v19
  v_accvgpr_read_b32 v18, a146
  v_mul_f32 v18, v18, v17
  v_accvgpr_write_b32 a146, v18
  v_accvgpr_read_b32 v19, a147
  v_mul_f32 v19, v19, v17
  v_accvgpr_write_b32 a147, v19
  v_accvgpr_read_b32 v18, a148
  v_mul_f32 v18, v18, v17
  v_accvgpr_write_b32 a148, v18
  v_accvgpr_read_b32 v19, a149
  v_mul_f32 v19, v19, v17
  v_accvgpr_write_b32 a149, v19
  v_accvgpr_read_b32 v18, a150
  v_mul_f32 v18, v18, v17
  v_accvgpr_write_b32 a150, v18
  v_accvgpr_read_b32 v19, a151
  v_mul_f32 v19, v19, v17
  v_accvgpr_write_b32 a151, v19
  v_accvgpr_read_b32 v18, a152
  v_mul_f32 v18, v18, v17
  v_accvgpr_write_b32 a152, v18
  v_accvgpr_read_b32 v19, a153
  v_mul_f32 v19, v19, v17
  v_accvgpr_write_b32 a153, v19
  v_accvgpr_read_b32 v18, a154
  v_mul_f32 v18, v18, v17
  v_accvgpr_write_b32 a154, v18
  v_accvgpr_read_b32 v19, a155
  v_mul_f32 v19, v19, v17
  v_accvgpr_write_b32 a155, v19
  v_accvgpr_read_b32 v18, a156
  v_mul_f32 v18, v18, v17
  v_accvgpr_write_b32 a156, v18
  v_accvgpr_read_b32 v19, a157
  v_mul_f32 v19, v19, v17
  v_accvgpr_write_b32 a157, v19
  v_accvgpr_read_b32 v18, a158
  v_mul_f32 v18, v18, v17
  v_accvgpr_write_b32 a158, v18
  v_accvgpr_read_b32 v19, a159
  v_mul_f32 v19, v19, v17
  v_accvgpr_write_b32 a159, v19
  v_accvgpr_read_b32 v18, a160
  v_mul_f32 v18, v18, v17
  v_accvgpr_write_b32 a160, v18
  v_accvgpr_read_b32 v19, a161
  v_mul_f32 v19, v19, v17
  v_accvgpr_write_b32 a161, v19
  v_accvgpr_read_b32 v18, a162
  v_mul_f32 v18, v18, v17
  v_accvgpr_write_b32 a162, v18
  v_accvgpr_read_b32 v19, a163
  v_mul_f32 v19, v19, v17
  v_accvgpr_write_b32 a163, v19
  v_accvgpr_read_b32 v18, a164
  v_mul_f32 v18, v18, v17
  v_accvgpr_write_b32 a164, v18
  v_accvgpr_read_b32 v19, a165
  v_mul_f32 v19, v19, v17
  v_accvgpr_write_b32 a165, v19
  v_accvgpr_read_b32 v18, a166
  v_mul_f32 v18, v18, v17
  v_accvgpr_write_b32 a166, v18
  v_accvgpr_read_b32 v19, a167
  v_mul_f32 v19, v19, v17
  v_accvgpr_write_b32 a167, v19
  v_accvgpr_read_b32 v18, a168
  v_mul_f32 v18, v18, v17
  v_accvgpr_write_b32 a168, v18
  v_accvgpr_read_b32 v19, a169
  v_mul_f32 v19, v19, v17
  v_accvgpr_write_b32 a169, v19
  v_accvgpr_read_b32 v18, a170
  v_mul_f32 v18, v18, v17
  v_accvgpr_write_b32 a170, v18
  v_accvgpr_read_b32 v19, a171
  v_mul_f32 v19, v19, v17
  v_accvgpr_write_b32 a171, v19
  v_accvgpr_read_b32 v18, a172
  v_mul_f32 v18, v18, v17
  v_accvgpr_write_b32 a172, v18
  v_accvgpr_read_b32 v19, a173
  v_mul_f32 v19, v19, v17
  v_accvgpr_write_b32 a173, v19
  v_accvgpr_read_b32 v18, a174
  v_mul_f32 v18, v18, v17
  v_accvgpr_write_b32 a174, v18
  v_accvgpr_read_b32 v19, a175
  v_mul_f32 v19, v19, v17
  v_accvgpr_write_b32 a175, v19
  v_accvgpr_read_b32 v18, a176
  v_mul_f32 v18, v18, v17
  v_accvgpr_write_b32 a176, v18
  v_accvgpr_read_b32 v19, a177
  v_mul_f32 v19, v19, v17
  v_accvgpr_write_b32 a177, v19
  v_accvgpr_read_b32 v18, a178
  v_mul_f32 v18, v18, v17
  v_accvgpr_write_b32 a178, v18
  v_accvgpr_read_b32 v19, a179
  v_mul_f32 v19, v19, v17
  v_accvgpr_write_b32 a179, v19
  v_accvgpr_read_b32 v18, a180
  v_mul_f32 v18, v18, v17
  v_accvgpr_write_b32 a180, v18
  v_accvgpr_read_b32 v19, a181
  v_mul_f32 v19, v19, v17
  v_accvgpr_write_b32 a181, v19
  v_accvgpr_read_b32 v18, a182
  v_mul_f32 v18, v18, v17
  v_accvgpr_write_b32 a182, v18
  v_accvgpr_read_b32 v19, a183
  v_mul_f32 v19, v19, v17
  v_accvgpr_write_b32 a183, v19
  v_accvgpr_read_b32 v18, a184
  v_mul_f32 v18, v18, v17
  v_accvgpr_write_b32 a184, v18
  v_accvgpr_read_b32 v19, a185
  v_mul_f32 v19, v19, v17
  v_accvgpr_write_b32 a185, v19
  v_accvgpr_read_b32 v18, a186
  v_mul_f32 v18, v18, v17
  v_accvgpr_write_b32 a186, v18
  v_accvgpr_read_b32 v19, a187
  v_mul_f32 v19, v19, v17
  v_accvgpr_write_b32 a187, v19
  v_accvgpr_read_b32 v18, a188
  v_mul_f32 v18, v18, v17
  v_accvgpr_write_b32 a188, v18
  v_accvgpr_read_b32 v19, a189
  v_mul_f32 v19, v19, v17
  v_accvgpr_write_b32 a189, v19
  v_accvgpr_read_b32 v18, a190
  v_mul_f32 v18, v18, v17
  v_accvgpr_write_b32 a190, v18
  v_accvgpr_read_b32 v19, a191
  v_mul_f32 v19, v19, v17
  v_accvgpr_write_b32 a191, v19
  v_mov_b32 v20, v12
  v_mov_b32 v21, v12
  v_mov_b32 v22, v12
  v_mov_b32 v23, v12
  ds_write_b128 v3, v[20:23] offset:3072
  v_exp_f32 v16, v160
  v_exp_f32 v17, v161
  v_exp_f32 v18, v162
  v_exp_f32 v19, v163
  v_add_f32 v0, v16, v17
  v_cvt_pk_bf16_f32 v184, v16, v17
  v_exp_f32 v16, v164
  v_exp_f32 v17, v165
  v_add_f32 v0, v0, v18
  v_add_f32 v0, v0, v19
  v_cvt_pk_bf16_f32 v185, v18, v19
  v_exp_f32 v18, v166
  v_exp_f32 v19, v167
  v_add_f32 v0, v0, v16
  v_add_f32 v0, v0, v17
  v_cvt_pk_bf16_f32 v186, v16, v17
  v_exp_f32 v16, v168
  v_exp_f32 v17, v169
  v_add_f32 v0, v0, v18
  v_add_f32 v0, v0, v19
  v_cvt_pk_bf16_f32 v187, v18, v19
  v_exp_f32 v18, v170
  v_exp_f32 v19, v171
  v_add_f32 v0, v0, v16
  v_add_f32 v0, v0, v17
  v_cvt_pk_bf16_f32 v188, v16, v17
  v_exp_f32 v16, v172
  v_exp_f32 v17, v173
  v_add_f32 v0, v0, v18
  v_add_f32 v0, v0, v19
  v_cvt_pk_bf16_f32 v189, v18, v19
  v_exp_f32 v18, v174
  v_exp_f32 v19, v175
  v_add_f32 v0, v0, v16
  v_add_f32 v0, v0, v17
  v_cvt_pk_bf16_f32 v190, v16, v17
  v_add_f32 v0, v0, v18
  v_add_f32 v0, v0, v19
  v_cvt_pk_bf16_f32 v191, v18, v19
  s_waitcnt lgkmcnt(0)
  s_nop 1
  s_branch Lret_17
.section .rodata,"a"
.p2align 6
.amdhsa_kernel k_attn_kernel
  .amdhsa_next_free_vgpr 512
  .amdhsa_next_free_sgpr 48
  .amdhsa_accum_offset 256
  .amdhsa_group_segment_fixed_size 0
  .amdhsa_kernarg_size 56
  .amdhsa_user_sgpr_count 2
  .amdhsa_user_sgpr_kernarg_segment_ptr 1
  .amdhsa_system_sgpr_workgroup_id_x 1
.end_amdhsa_kernel
.text
```
